```python
import torch

def _softmax(x, axis=-1):
    return torch.softmax(x, dim=axis)
def _gelu(x):
    return torch.nn.functional.gelu(x, approximate="tanh")
def _silu(x):
    return torch.nn.functional.silu(x)
def _sigmoid(x):
    return torch.sigmoid(x)
def _layernorm(x, axis=-1, eps=1e-5):
    m = x.mean(dim=axis, keepdim=True)
    v = x.var(dim=axis, keepdim=True, unbiased=False)
    return (x - m) / torch.sqrt(v + eps)
def _scatter_add(tgt, idx, src, axis=0):
    return tgt.clone().index_add_(axis, idx, src)
def _segment_sum(src, seg, n):
    out = torch.zeros((n,) + src.shape[1:], dtype=src.dtype)
    return out.index_add_(0, seg, src)
def _pad(x, pw):
    flat = tuple(v for pair in reversed(pw) for v in pair)
    return torch.nn.functional.pad(x, flat)

kernel_name = 'recurrent_scan__sliding_local_dilated__swiglu_ffn__prompt'

def setup_inputs():

    _w = (lambda a: (lambda t: t.to(torch.bfloat16) if t.is_floating_point() else t)(torch.as_tensor(a)))
    def _A_setup():
        B, S, D = 1, 2048, 1024
        return {
            "x": _w((lambda *s: torch.randn(*s, dtype=torch.bfloat16) * 0.05)(B, S, D)),
            "wqkv": _w((lambda *s: torch.randn(*s, dtype=torch.bfloat16) * 0.05)(D, 3 * D)),
            "wo": _w((lambda *s: torch.randn(*s, dtype=torch.bfloat16) * 0.05)(D, D)),
        }
    _A_in = _A_setup()

    def _B_setup():
        B, S, D, F = 1, 2048, 1024, 3584
        return {
            "x": _w((lambda *s: torch.randn(*s, dtype=torch.bfloat16) * 0.05)(B, S, D)),
            "w_gate": _w((lambda *s: torch.randn(*s, dtype=torch.bfloat16) * 0.05)(D, F)),
            "w_up": _w((lambda *s: torch.randn(*s, dtype=torch.bfloat16) * 0.05)(D, F)),
            "w_down": _w((lambda *s: torch.randn(*s, dtype=torch.bfloat16) * 0.05)(F, D)),
        }
    _B_in = _B_setup()

    return {
        "A_x": _A_in["x"],
        "A_wqkv": _A_in["wqkv"],
        "A_wo": _A_in["wo"],
        "B_x": _B_in["x"],
        "B_w_gate": _B_in["w_gate"],
        "B_w_up": _B_in["w_up"],
        "B_w_down": _B_in["w_down"],
    }

def reference(A_x, A_wqkv, A_wo, B_x, B_w_gate, B_w_up, B_w_down):
    def _A_ref(x, wqkv, wo):
        B, S, D = x.shape
        H = 32; Dh = D // H
        W, dil = 8, 2
        qkv = (lambda x, *d: x.permute(*d))((x @ wqkv).reshape(B, S, 3, H, Dh), 2, 0, 3, 1, 4)
        q, k, v = qkv[0], qkv[1], qkv[2]
        scale = Dh ** -0.5
        pos = torch.arange(S)
        off = torch.arange(W) * dil
        idx = pos[:, None] - off[None, :]
        mask = idx >= 0
        idx_c = torch.where(mask, idx, 0).reshape(-1)
        kg = k[:, :, idx_c, :].reshape(B, H, S, W, Dh)
        vg = v[:, :, idx_c, :].reshape(B, H, S, W, Dh)
        logits = torch.einsum("bhsd,bhswd->bhsw", q, kg) * scale
        logits = torch.where(mask[None, None, :, :], logits, -1e9)
        attn = _softmax(logits, axis=-1)
        o = torch.einsum("bhsw,bhswd->bhsd", attn, vg)
        return (lambda x, *d: x.permute(*d))(o, 0, 2, 1, 3).reshape(B, S, D) @ wo

    def _B_ref(x, w_gate, w_up, w_down):
        g = _silu(x @ w_gate)
        u = x @ w_up
        return (g * u) @ w_down

    x = A_x
    xn = _layernorm(x, axis=-1)
    s = _A_ref(xn, A_wqkv, A_wo)
    g = _silu(_B_ref(xn, B_w_gate, B_w_up, B_w_down))
    return x + s * g
```

```asm
; @launch grid=(256,1,1) block=(256,1,1) lds=163840
.amdgcn_target "amdgcn-amd-amdhsa--gfx950"
.text
.globl recurrent_scan__sliding_local_dilated__swiglu_ffn__prompt_kernel
.p2align 8
.type recurrent_scan__sliding_local_dilated__swiglu_ffn__prompt_kernel,@function
recurrent_scan__sliding_local_dilated__swiglu_ffn__prompt_kernel:
    s_cmp_ge_u32 s2, 256
    s_cbranch_scc1 L_end
    s_load_dwordx16 s[64:79], s[0:1], 0
    s_load_dwordx4 s[80:83], s[0:1], 64
    s_getpc_b64 s[4:5]
L_pc:
    v_and_b32 v17, 63, v0
    s_mov_b32 s6, L_end-L_pc
    s_mov_b32 s7, 0x20000
    v_lshlrev_b32 v1, 7, v17
    s_bfe_u32 s3, s2, 0x30003
    s_lshl_b32 s3, s3, 13
    buffer_load_dword v29, v1, s[4:7], s3 offen
    v_lshrrev_b32 v16, 6, v0
    v_lshrrev_b32 v18, 3, v17
    v_and_b32 v19, 7, v17
    v_readfirstlane_b32 s32, v16
    v_lshlrev_b32 v20, 11, v18
    v_lshl_add_u32 v20, v16, 9, v20
    v_lshl_add_u32 v20, v19, 4, v20
    s_and_b32 s34, s2, 7
    s_bfe_u32 s35, s2, 0x20003
    s_lshl2_add_u32 s34, s34, s35
    s_lshr_b32 s33, s2, 5
    s_lshl_b32 s36, s33, 5
    s_add_u32 s36, s36, s34
    s_lshl_b32 s37, s36, 14
    v_mov_b32 v6, 0
    s_mov_b32 s50, 4194304
    s_mov_b32 s51, 0x20000
    s_waitcnt lgkmcnt(0)
    s_mov_b64 s[48:49], s[64:65]
    buffer_load_dwordx4 v[32:35], v20, s[48:51], s37 offen offset:0
    buffer_load_dwordx4 v[36:39], v20, s[48:51], s37 offen offset:128
    buffer_load_dwordx4 v[40:43], v20, s[48:51], s37 offen offset:256
    buffer_load_dwordx4 v[44:47], v20, s[48:51], s37 offen offset:384
    s_add_u32 s84, s82, 0x3000000
    s_addc_u32 s85, s83, 0
    s_mov_b32 s86, 0x100000
    s_mov_b32 s87, 0x20000
    s_mov_b32 s3, 65536
    buffer_load_dword v7, v6, s[84:87], s3 offen
    s_and_b32 s80, s2, 7
    s_lshl_b32 s80, s80, 1
    s_mov_b32 s81, s80
    s_and_b32 s57, s34, 1
    s_lshr_b32 s58, s34, 1
    s_mul_i32 s58, s58, 448
    s_cmp_eq_u32 s32, 1
    s_cselect_b64 s[88:89], s[74:75], s[72:73]
    s_cmp_eq_u32 s32, 3
    s_cbranch_scc1 L_t3
    s_and_b32 s93, s2, 7
    s_mul_i32 s3, s93, 896
    s_movk_i32 s92, 7168
    v_lshl_add_u32 v23, v19, 7, s3
    s_movk_i32 s95, 6
    s_cmp_eq_u32 s32, 2
    s_cbranch_scc0 L_t01
    s_mov_b64 s[88:89], s[66:67]
    s_lshl_b32 s3, s93, 8
    s_movk_i32 s92, 6144
    v_and_b32 v22, 1, v17
    v_lshl_add_u32 v23, v22, 7, s3
    v_lshrrev_b32 v22, 1, v19
    v_lshl_add_u32 v23, v22, 11, v23
    s_movk_i32 s95, 5
L_t01:
    s_lshl_b32 s90, s92, 10
    v_and_b32 v21, 1, v18
    v_and_b32 v22, 32, v17
    v_lshl_add_u32 v21, v22, 1, v21
    v_mad_u32_u24 v30, v21, s92, v23
    v_and_b32 v22, 23, v17
    v_cmp_lt_u32 vcc, s95, v22
    v_mov_b32 v23, 1073741824
    s_lshr_b32 s94, s2, 3
    s_lshl_b32 s3, s80, 5
    s_add_u32 s94, s94, s3
    s_lshl_b32 s94, s94, 1
    v_cndmask_b32 v30, v30, v23, vcc
    v_mov_b32 v25, v30
    s_mul_i32 s94, s94, s92
    s_lshl_b32 s95, s92, 7
    s_branch L_td
L_t3:
    s_mov_b64 s[88:89], s[76:77]
    v_lshlrev_b32 v30, 7, v17
    s_bfe_u32 s3, s2, 0x20001
    s_add_u32 s3, s3, 1
    s_mul_i32 s90, s3, 1835008
    s_lshr_b32 s94, s2, 3
    s_lshl_b32 s94, s94, 13
    s_add_u32 s94, s94, s90
    s_sub_u32 s94, s94, 262144
    s_mov_b32 s95, 0
    s_and_b32 s3, s2, 1
    s_lshl_b32 s3, s3, 4
    v_and_b32 v21, 16, v17
    v_xor_b32 v21, s3, v21
    v_lshl_add_u32 v30, v21, 26, v30
    v_mov_b32 v25, v30
    v_mov_b32 v30, 1073741824
L_td:
    s_mov_b32 s91, 0x20000
    buffer_load_dword v29, v30, s[88:91], s94 offen
    s_add_u32 s94, s94, s95
    s_cmp_ge_u32 s94, s90
    s_cselect_b32 s3, s90, 0
    s_sub_u32 s94, s94, s3
    v_lshlrev_b32 v21, 17, v16
    v_lshrrev_b32 v22, 2, v19
    v_lshl_add_u32 v21, v22, 10, v21
    v_and_b32 v22, 3, v19
    v_lshl_add_u32 v21, v22, 8, v21
    v_lshl_add_u32 v28, v18, 4, v21
    s_lshl_b32 s60, s33, 19
    s_lshr_b32 s51, s34, 1
    s_lshl_b32 s51, s51, 11
    s_add_u32 s50, s60, s51
    s_lshl_b32 s51, s57, 7
    s_add_u32 s50, s50, s51
    s_add_u32 s51, s50, 32768
    s_add_u32 s52, s50, 65536
    s_add_u32 s53, s50, 98304
    v_lshlrev_b32 v26, 5, v18
    v_add_u32 v26, 155648, v26
    v_lshl_add_u32 v27, v16, 3, v26
    s_mov_b64 s[24:25], s[82:83]
    s_add_u32 s26, s60, 0x80000
    s_mov_b32 s27, 0x20000
    s_mov_b32 s54, 0xffff0000
    s_lshl_b32 s92, s36, 7
    s_lshl_b32 s3, s32, 28
    s_add_u32 s92, s92, s3
    s_mov_b32 s3, 0x3f803f80
    v_mov_b32 v116, s3
    s_max_u32 s61, s33, 1
    s_sub_u32 s61, s61, 1
    s_lshl_b32 s59, s61, 12
    s_add_u32 s59, s59, 3840
    s_lshl_b32 s3, s33, 12
    s_lshl_b32 s48, s32, 10
    s_add_u32 s3, s3, s48
    v_and_b32 v21, 0, v17
    v_lshlrev_b32 v21, 2, v21
    v_lshrrev_b32 v20, 2, v17
    v_lshl_add_u32 v20, v20, 7, v21
    v_and_b32 v21, 140, v20
    v_add_u32 v20, s3, v20
    v_add_u32 v21, s59, v21
    v_cmp_gt_u32 vcc, 32, v17
    v_mov_b32 v22, 1073741824
    v_lshlrev_b32 v15, 4, v17
    v_cndmask_b32 v254, v21, v20, vcc
    v_cndmask_b32 v121, v22, v25, vcc
    v_cndmask_b32 v122, v25, v22, vcc
    s_mul_i32 s56, s32, 192
    s_lshl_b32 s59, s34, 6
    s_movk_i32 s40, 4682
    s_movk_i32 s41, 5462
    s_movk_i32 s62, 7168
    s_movk_i32 s63, 6144
    s_mul_i32 s48, s57, 14
    s_add_u32 s3, s56, 0
    v_add_u32 v20, s3, v17
    v_mul_u32_u24 v21, s40, v20
    v_lshrrev_b32 v21, 16, v21
    v_mul_u32_u24 v22, 14, v21
    v_sub_u32 v22, v20, v22
    v_add_u32 v22, s48, v22
    v_lshrrev_b32 v23, 1, v22
    v_xor_b32 v23, v23, v22
    v_and_b32 v23, 1, v23
    v_mul_u32_u24 v23, 3, v23
    v_xor_b32 v22, v22, v23
    v_and_b32 v24, 35, v21
    v_bfe_u32 v23, v21, 2, 2
    v_lshl_or_b32 v24, v23, 3, v24
    v_bfe_u32 v23, v21, 4, 1
    v_lshl_or_b32 v24, v23, 2, v24
    s_sub_u32 s3, s58, 0
    v_lshl_add_u32 v22, v22, 4, s3
    v_mad_u32_u24 v8, v24, s62, v22
    v_mul_u32_u24 v21, s41, v20
    v_lshrrev_b32 v21, 16, v21
    v_mul_u32_u24 v22, 12, v21
    v_sub_u32 v22, v20, v22
    v_lshrrev_b32 v23, 1, v21
    v_and_b32 v23, 2, v23
    v_xor_b32 v22, v22, v23
    v_lshrrev_b32 v25, 2, v22
    v_and_b32 v22, 3, v22
    s_sub_u32 s3, s59, 0
    v_lshl_add_u32 v22, v22, 4, s3
    v_lshl_add_u32 v22, v25, 11, v22
    v_and_b32 v24, 35, v21
    v_bfe_u32 v23, v21, 2, 2
    v_lshl_or_b32 v24, v23, 3, v24
    v_bfe_u32 v23, v21, 4, 1
    v_lshl_or_b32 v24, v23, 2, v24
    v_mad_u32_u24 v11, v24, s63, v22
    s_add_u32 s3, s56, 64
    v_add_u32 v20, s3, v17
    v_mul_u32_u24 v21, s40, v20
    v_lshrrev_b32 v21, 16, v21
    v_mul_u32_u24 v22, 14, v21
    v_sub_u32 v22, v20, v22
    v_add_u32 v22, s48, v22
    v_lshrrev_b32 v23, 1, v22
    v_xor_b32 v23, v23, v22
    v_and_b32 v23, 1, v23
    v_mul_u32_u24 v23, 3, v23
    v_xor_b32 v22, v22, v23
    v_and_b32 v24, 35, v21
    v_bfe_u32 v23, v21, 2, 2
    v_lshl_or_b32 v24, v23, 3, v24
    v_bfe_u32 v23, v21, 4, 1
    v_lshl_or_b32 v24, v23, 2, v24
    s_sub_u32 s3, s58, 1024
    v_lshl_add_u32 v22, v22, 4, s3
    v_mad_u32_u24 v9, v24, s62, v22
    v_mul_u32_u24 v21, s41, v20
    v_lshrrev_b32 v21, 16, v21
    v_mul_u32_u24 v22, 12, v21
    v_sub_u32 v22, v20, v22
    v_lshrrev_b32 v23, 1, v21
    v_and_b32 v23, 2, v23
    v_xor_b32 v22, v22, v23
    v_lshrrev_b32 v25, 2, v22
    v_and_b32 v22, 3, v22
    s_sub_u32 s3, s59, 1024
    v_lshl_add_u32 v22, v22, 4, s3
    v_lshl_add_u32 v22, v25, 11, v22
    v_and_b32 v24, 35, v21
    v_bfe_u32 v23, v21, 2, 2
    v_lshl_or_b32 v24, v23, 3, v24
    v_bfe_u32 v23, v21, 4, 1
    v_lshl_or_b32 v24, v23, 2, v24
    v_mad_u32_u24 v12, v24, s63, v22
    s_add_u32 s3, s56, 128
    v_add_u32 v20, s3, v17
    v_mul_u32_u24 v21, s40, v20
    v_lshrrev_b32 v21, 16, v21
    v_mul_u32_u24 v22, 14, v21
    v_sub_u32 v22, v20, v22
    v_add_u32 v22, s48, v22
    v_lshrrev_b32 v23, 1, v22
    v_xor_b32 v23, v23, v22
    v_and_b32 v23, 1, v23
    v_mul_u32_u24 v23, 3, v23
    v_xor_b32 v22, v22, v23
    v_and_b32 v24, 35, v21
    v_bfe_u32 v23, v21, 2, 2
    v_lshl_or_b32 v24, v23, 3, v24
    v_bfe_u32 v23, v21, 4, 1
    v_lshl_or_b32 v24, v23, 2, v24
    s_sub_u32 s3, s58, 2048
    v_lshl_add_u32 v22, v22, 4, s3
    v_mad_u32_u24 v10, v24, s62, v22
    v_mul_u32_u24 v21, s41, v20
    v_lshrrev_b32 v21, 16, v21
    v_mul_u32_u24 v22, 12, v21
    v_sub_u32 v22, v20, v22
    v_lshrrev_b32 v23, 1, v21
    v_and_b32 v23, 2, v23
    v_xor_b32 v22, v22, v23
    v_lshrrev_b32 v25, 2, v22
    v_and_b32 v22, 3, v22
    s_sub_u32 s3, s59, 2048
    v_lshl_add_u32 v22, v22, 4, s3
    v_lshl_add_u32 v22, v25, 11, v22
    v_and_b32 v24, 35, v21
    v_bfe_u32 v23, v21, 2, 2
    v_lshl_or_b32 v24, v23, 3, v24
    v_bfe_u32 v23, v21, 4, 1
    v_lshl_or_b32 v24, v23, 2, v24
    v_mad_u32_u24 v13, v24, s63, v22
    s_and_b32 s35, s32, 1
    s_lshl_b32 s3, s35, 6
    s_add_u32 s3, s3, 768
    v_add_u32 v20, s3, v17
    v_mul_u32_u24 v21, s40, v20
    v_lshrrev_b32 v21, 16, v21
    v_mul_u32_u24 v22, 14, v21
    v_sub_u32 v22, v20, v22
    v_add_u32 v22, s48, v22
    v_lshrrev_b32 v23, 1, v22
    v_xor_b32 v23, v23, v22
    v_and_b32 v23, 1, v23
    v_mul_u32_u24 v23, 3, v23
    v_xor_b32 v22, v22, v23
    v_and_b32 v24, 35, v21
    v_bfe_u32 v23, v21, 2, 2
    v_lshl_or_b32 v24, v23, 3, v24
    v_bfe_u32 v23, v21, 4, 1
    v_lshl_or_b32 v24, v23, 2, v24
    s_sub_u32 s3, s58, 0
    v_lshl_add_u32 v22, v22, 4, s3
    v_mad_u32_u24 v14, v24, s62, v22
    s_mul_i32 s43, s32, 3072
    s_add_u32 s44, s43, 14336
    s_add_u32 s45, s43, 28672
    s_lshr_b32 s46, s32, 1
    s_mul_i32 s46, s46, 14336
    s_lshl_b32 s3, s35, 10
    s_add_u32 s46, s46, s3
    s_add_u32 s46, s46, 12288
    s_mov_b32 s8, s72
    s_mov_b32 s9, s73
    s_mov_b32 s10, 0x700000
    s_mov_b32 s11, 0x20000
    s_mov_b32 s12, s74
    s_mov_b32 s13, s75
    s_mov_b32 s14, 0x700000
    s_mov_b32 s15, 0x20000
    s_mov_b32 s16, s66
    s_mov_b32 s17, s67
    s_mov_b32 s18, 0x600000
    s_mov_b32 s19, 0x20000
    s_cmp_lt_u32 s32, 2
    s_cselect_b64 s[20:21], s[72:73], s[74:75]
    s_mov_b32 s22, 7340032
    s_mov_b32 s23, 0x20000
    s_mov_b32 s36, 0
    s_mov_b32 s37, 0
    s_waitcnt vmcnt(2)
    v_dot2_f32_bf16 v112, v32, v116, 0
    v_dot2_f32_bf16 v113, v32, v32, 0
    v_dot2_f32_bf16 v114, v33, v116, 0
    v_dot2_f32_bf16 v115, v33, v33, 0
    v_dot2_f32_bf16 v112, v34, v116, v112
    v_dot2_f32_bf16 v113, v34, v34, v113
    v_dot2_f32_bf16 v114, v35, v116, v114
    v_dot2_f32_bf16 v115, v35, v35, v115
    v_dot2_f32_bf16 v112, v36, v116, v112
    v_dot2_f32_bf16 v113, v36, v36, v113
    v_dot2_f32_bf16 v114, v37, v116, v114
    v_dot2_f32_bf16 v115, v37, v37, v115
    v_dot2_f32_bf16 v112, v38, v116, v112
    v_dot2_f32_bf16 v113, v38, v38, v113
    v_dot2_f32_bf16 v114, v39, v116, v114
    v_dot2_f32_bf16 v115, v39, v39, v115
    v_dot2_f32_bf16 v112, v40, v116, v112
    v_dot2_f32_bf16 v113, v40, v40, v113
    v_dot2_f32_bf16 v114, v41, v116, v114
    v_dot2_f32_bf16 v115, v41, v41, v115
    v_dot2_f32_bf16 v112, v42, v116, v112
    v_dot2_f32_bf16 v113, v42, v42, v113
    v_dot2_f32_bf16 v114, v43, v116, v114
    v_dot2_f32_bf16 v115, v43, v43, v115
    v_dot2_f32_bf16 v112, v44, v116, v112
    v_dot2_f32_bf16 v113, v44, v44, v113
    v_dot2_f32_bf16 v114, v45, v116, v114
    v_dot2_f32_bf16 v115, v45, v45, v115
    v_dot2_f32_bf16 v112, v46, v116, v112
    v_dot2_f32_bf16 v113, v46, v46, v113
    v_dot2_f32_bf16 v114, v47, v116, v114
    v_dot2_f32_bf16 v115, v47, v47, v115
    s_nop 2
    v_pk_add_f32 v[112:113], v[112:113], v[114:115]
    s_nop 1
    v_add_f32_dpp v112, v112, v112 quad_perm:[1,0,3,2] row_mask:0xf bank_mask:0xf
    v_add_f32_dpp v113, v113, v113 quad_perm:[1,0,3,2] row_mask:0xf bank_mask:0xf
    s_nop 0
    v_add_f32_dpp v112, v112, v112 quad_perm:[2,3,0,1] row_mask:0xf bank_mask:0xf
    v_add_f32_dpp v113, v113, v113 quad_perm:[2,3,0,1] row_mask:0xf bank_mask:0xf
    s_nop 0
    v_add_f32_dpp v112, v112, v112 row_half_mirror row_mask:0xf bank_mask:0xf
    v_add_f32_dpp v113, v113, v113 row_half_mirror row_mask:0xf bank_mask:0xf
    ds_write_b64 v27, v[112:113]
    v_lshlrev_b32 v48, 16, v32
    v_and_b32 v49, s54, v32
    v_lshlrev_b32 v50, 16, v33
    v_and_b32 v51, s54, v33
    v_lshlrev_b32 v52, 16, v34
    v_and_b32 v53, s54, v34
    v_lshlrev_b32 v54, 16, v35
    v_and_b32 v55, s54, v35
    v_lshlrev_b32 v56, 16, v36
    v_and_b32 v57, s54, v36
    v_lshlrev_b32 v58, 16, v37
    v_and_b32 v59, s54, v37
    v_lshlrev_b32 v60, 16, v38
    v_and_b32 v61, s54, v38
    v_lshlrev_b32 v62, 16, v39
    v_and_b32 v63, s54, v39
    s_waitcnt lgkmcnt(0)
    s_barrier
    ds_read_b128 v[80:83], v26
    ds_read_b128 v[84:87], v26 offset:16
    v_lshlrev_b32 v64, 16, v40
    v_and_b32 v65, s54, v40
    v_lshlrev_b32 v66, 16, v41
    v_and_b32 v67, s54, v41
    v_lshlrev_b32 v68, 16, v42
    v_and_b32 v69, s54, v42
    v_lshlrev_b32 v70, 16, v43
    v_and_b32 v71, s54, v43
    v_lshlrev_b32 v72, 16, v44
    v_and_b32 v73, s54, v44
    v_lshlrev_b32 v74, 16, v45
    v_and_b32 v75, s54, v45
    v_lshlrev_b32 v76, 16, v46
    v_and_b32 v77, s54, v46
    v_lshlrev_b32 v78, 16, v47
    v_and_b32 v79, s54, v47
    s_waitcnt lgkmcnt(0)
    v_pk_add_f32 v[80:81], v[80:81], v[82:83]
    v_pk_add_f32 v[84:85], v[84:85], v[86:87]
    v_pk_add_f32 v[80:81], v[80:81], v[84:85]
    v_mul_f32 v88, 0x3a800000, v80
    v_mul_f32 v81, 0x3a800000, v81
    v_fma_f32 v81, -v88, v88, v81
    v_max_f32 v81, 0, v81
    v_cvt_pk_bf16_f32 v88, v88, v81
    v_and_b32 v81, s54, v88
    v_lshlrev_b32 v88, 16, v88
    v_add_f32 v81, 0x3727c5ac, v81
    v_cvt_pk_bf16_f32 v81, v81, v81
    v_and_b32 v81, s54, v81
    v_sqrt_f32 v81, v81
    v_sub_f32 v88, 0, v88
    v_cvt_pk_bf16_f32 v81, v81, v81
    v_and_b32 v81, s54, v81
    v_rcp_f32 v90, v81
    v_mov_b32 v89, v88
    v_mov_b32 v91, v90
    v_pk_add_f32 v[48:49], v[48:49], v[88:89]
    v_pk_add_f32 v[50:51], v[50:51], v[88:89]
    v_pk_add_f32 v[52:53], v[52:53], v[88:89]
    v_pk_add_f32 v[54:55], v[54:55], v[88:89]
    v_cvt_pk_bf16_f32 v32, v48, v49
    v_cvt_pk_bf16_f32 v33, v50, v51
    v_cvt_pk_bf16_f32 v34, v52, v53
    v_cvt_pk_bf16_f32 v35, v54, v55
    v_lshlrev_b32 v48, 16, v32
    v_and_b32 v49, s54, v32
    v_lshlrev_b32 v50, 16, v33
    v_and_b32 v51, s54, v33
    v_lshlrev_b32 v52, 16, v34
    v_and_b32 v53, s54, v34
    v_lshlrev_b32 v54, 16, v35
    v_and_b32 v55, s54, v35
    v_pk_mul_f32 v[48:49], v[48:49], v[90:91]
    v_pk_mul_f32 v[50:51], v[50:51], v[90:91]
    v_pk_mul_f32 v[52:53], v[52:53], v[90:91]
    v_pk_mul_f32 v[54:55], v[54:55], v[90:91]
    v_cvt_pk_bf16_f32 v32, v48, v49
    v_cvt_pk_bf16_f32 v33, v50, v51
    v_cvt_pk_bf16_f32 v34, v52, v53
    v_cvt_pk_bf16_f32 v35, v54, v55
    buffer_store_dwordx4 v[32:35], v28, s[24:27], s50 offen sc1
    v_pk_add_f32 v[56:57], v[56:57], v[88:89]
    v_pk_add_f32 v[58:59], v[58:59], v[88:89]
    v_pk_add_f32 v[60:61], v[60:61], v[88:89]
    v_pk_add_f32 v[62:63], v[62:63], v[88:89]
    v_cvt_pk_bf16_f32 v36, v56, v57
    v_cvt_pk_bf16_f32 v37, v58, v59
    v_cvt_pk_bf16_f32 v38, v60, v61
    v_cvt_pk_bf16_f32 v39, v62, v63
    v_lshlrev_b32 v56, 16, v36
    v_and_b32 v57, s54, v36
    v_lshlrev_b32 v58, 16, v37
    v_and_b32 v59, s54, v37
    v_lshlrev_b32 v60, 16, v38
    v_and_b32 v61, s54, v38
    v_lshlrev_b32 v62, 16, v39
    v_and_b32 v63, s54, v39
    v_pk_mul_f32 v[56:57], v[56:57], v[90:91]
    v_pk_mul_f32 v[58:59], v[58:59], v[90:91]
    v_pk_mul_f32 v[60:61], v[60:61], v[90:91]
    v_pk_mul_f32 v[62:63], v[62:63], v[90:91]
    v_cvt_pk_bf16_f32 v36, v56, v57
    v_cvt_pk_bf16_f32 v37, v58, v59
    v_cvt_pk_bf16_f32 v38, v60, v61
    v_cvt_pk_bf16_f32 v39, v62, v63
    buffer_store_dwordx4 v[36:39], v28, s[24:27], s51 offen sc1
    v_pk_add_f32 v[64:65], v[64:65], v[88:89]
    v_pk_add_f32 v[66:67], v[66:67], v[88:89]
    v_pk_add_f32 v[68:69], v[68:69], v[88:89]
    v_pk_add_f32 v[70:71], v[70:71], v[88:89]
    v_cvt_pk_bf16_f32 v40, v64, v65
    v_cvt_pk_bf16_f32 v41, v66, v67
    v_cvt_pk_bf16_f32 v42, v68, v69
    v_cvt_pk_bf16_f32 v43, v70, v71
    v_lshlrev_b32 v64, 16, v40
    v_and_b32 v65, s54, v40
    v_lshlrev_b32 v66, 16, v41
    v_and_b32 v67, s54, v41
    v_lshlrev_b32 v68, 16, v42
    v_and_b32 v69, s54, v42
    v_lshlrev_b32 v70, 16, v43
    v_and_b32 v71, s54, v43
    v_pk_mul_f32 v[64:65], v[64:65], v[90:91]
    v_pk_mul_f32 v[66:67], v[66:67], v[90:91]
    v_pk_mul_f32 v[68:69], v[68:69], v[90:91]
    v_pk_mul_f32 v[70:71], v[70:71], v[90:91]
    v_cvt_pk_bf16_f32 v40, v64, v65
    v_cvt_pk_bf16_f32 v41, v66, v67
    v_cvt_pk_bf16_f32 v42, v68, v69
    v_cvt_pk_bf16_f32 v43, v70, v71
    buffer_store_dwordx4 v[40:43], v28, s[24:27], s52 offen sc1
    v_pk_add_f32 v[72:73], v[72:73], v[88:89]
    v_pk_add_f32 v[74:75], v[74:75], v[88:89]
    v_pk_add_f32 v[76:77], v[76:77], v[88:89]
    v_pk_add_f32 v[78:79], v[78:79], v[88:89]
    v_cvt_pk_bf16_f32 v44, v72, v73
    v_cvt_pk_bf16_f32 v45, v74, v75
    v_cvt_pk_bf16_f32 v46, v76, v77
    v_cvt_pk_bf16_f32 v47, v78, v79
    v_lshlrev_b32 v72, 16, v44
    v_and_b32 v73, s54, v44
    v_lshlrev_b32 v74, 16, v45
    v_and_b32 v75, s54, v45
    v_lshlrev_b32 v76, 16, v46
    v_and_b32 v77, s54, v46
    v_lshlrev_b32 v78, 16, v47
    v_and_b32 v79, s54, v47
    v_pk_mul_f32 v[72:73], v[72:73], v[90:91]
    v_pk_mul_f32 v[74:75], v[74:75], v[90:91]
    v_pk_mul_f32 v[76:77], v[76:77], v[90:91]
    v_pk_mul_f32 v[78:79], v[78:79], v[90:91]
    v_cvt_pk_bf16_f32 v44, v72, v73
    v_cvt_pk_bf16_f32 v45, v74, v75
    v_cvt_pk_bf16_f32 v46, v76, v77
    v_cvt_pk_bf16_f32 v47, v78, v79
    buffer_store_dwordx4 v[44:47], v28, s[24:27], s53 offen sc1
    s_lshl_b32 s3, s32, 13
    s_add_u32 s60, s60, s3
    s_lshl_b32 s61, s61, 19
    s_add_u32 s61, s61, 30720
    s_lshl_b32 s40, s81, 15
    s_add_u32 s42, s40, s61
    s_add_u32 s40, s40, s60
    s_add_u32 s41, s40, 4096
    v_mov_b32 v27, v121
    v_mov_b32 v28, v122
    v_lshrrev_b32 v18, 2, v17
    v_and_b32 v19, 3, v17
    v_lshlrev_b32 v19, 3, v19
    s_movk_i32 s3, 224
    v_and_b32 v20, 16, v15
    v_and_b32 v21, 2, v17
    v_lshl_add_u32 v20, v21, 2, v20
    v_mad_u32_u24 v1, v18, s3, v20
    s_movk_i32 s3, 192
    v_mad_u32_u24 v2, v18, s3, v19
    v_add_u32 v2, 28672, v2
    v_and_b32 v19, 16, v17
    v_lshlrev_b32 v19, 1, v19
    v_xor_b32 v20, 32, v19
    v_add_u32 v3, v2, v20
    v_add_u32 v2, v2, v19
    s_cmp_eq_u32 s35, 1
    s_cselect_b64 vcc, -1, 0
    v_cndmask_b32 v4, v2, v3, vcc
    s_lshr_b32 s3, s32, 1
    s_lshl_b32 s3, s3, 6
    s_add_u32 s3, s3, 64
    v_add_u32 v4, s3, v4
    s_mov_b32 s62, 40960
    s_mov_b32 s63, 4294885376
    s_add_u32 s28, s82, 0x400000
    s_addc_u32 s29, s83, 0
    s_mov_b32 s30, 0x1200000
    s_mov_b32 s31, 0x20000
    s_bfe_u32 s66, s2, 0x10001
    s_and_b32 s67, s2, 1
    s_bfe_u32 s3, s2, 0x20003
    s_lshl2_add_u32 s67, s67, s3
    s_lshr_b32 s70, s2, 5
    s_lshl_b32 s48, s66, 2
    s_xor_b32 s48, s48, 4
    s_lshl_b32 s49, s70, 8
    s_lshl_b32 s50, s32, 15
    s_add_u32 s50, s50, s49
    v_lshrrev_b32 v20, 4, v17
    v_bfe_u32 v21, v17, 1, 3
    v_xor_b32 v21, s48, v21
    v_xor_b32 v21, v21, v20
    v_and_b32 v22, 16, v15
    v_lshl_add_u32 v23, v20, 11, v22
    v_lshl_add_u32 v16, v21, 5, v23
    v_add_u32 v16, s50, v16
    s_lshl_b32 s51, s32, 16
    s_add_u32 s51, s51, s49
    s_lshl_b32 s3, s66, 7
    s_add_u32 s51, s51, s3
    v_bfe_u32 v21, v17, 1, 2
    v_xor_b32 v21, v21, v20
    v_lshrrev_b32 v23, 3, v17
    v_lshl_add_u32 v22, v23, 11, v22
    v_lshl_add_u32 v22, v21, 5, v22
    v_add_u32 v22, s51, v22
    v_mov_b32 v30, v22
    v_lshrrev_b32 v20, 2, v17
    v_and_b32 v21, 3, v17
    v_lshlrev_b32 v21, 3, v21
    v_add_u32 v21, 40960, v21
    v_lshl_add_u32 v22, v20, 8, v21
    v_and_b32 v23, 7, v20
    v_lshl_add_u32 v22, v23, 5, v22
    v_accvgpr_write_b32 a220, v22
    v_lshl_add_u32 v22, v20, 7, v21
    v_bfe_u32 v23, v17, 3, 2
    v_lshl_add_u32 v22, v23, 5, v22
    v_accvgpr_write_b32 a221, v22
    v_and_b32 v20, 15, v17
    v_lshlrev_b32 v22, 11, v20
    v_bfe_u32 v23, v17, 4, 1
    v_lshl_add_u32 v22, v23, 5, v22
    v_lshrrev_b32 v21, 5, v17
    v_lshl_add_u32 v22, v21, 4, v22
    v_accvgpr_write_b32 a222, v22
    v_lshlrev_b32 v22, 10, v23
    v_lshl_add_u32 v22, v21, 8, v22
    v_lshl_add_u32 v26, v20, 4, v22
    v_bfe_u32 v22, v17, 2, 2
    v_lshlrev_b32 v22, 8, v22
    v_lshrrev_b32 v23, 4, v17
    v_lshl_add_u32 v22, v23, 6, v22
    v_and_b32 v23, 3, v17
    v_lshl_add_u32 v22, v23, 1, v22
    v_add_u32 v22, 1024, v22
    s_cmp_ge_u32 s32, 2
    s_cselect_b64 vcc, -1, 0
    s_cselect_b32 s71, 16, 2
    v_cndmask_b32 v22, v15, v22, vcc
    s_lshl_b32 s3, s35, 3
    s_add_u32 s3, s3, 155648
    v_add_u32 v22, s3, v22
    v_accvgpr_write_b32 a223, v22
    v_lshlrev_b32 v22, 7, v17
    v_cmp_gt_u32 vcc, 32, v17
    v_mov_b32 v21, 1073741824
    s_lshl_b32 s7, s2, 13
    v_cndmask_b32 v24, v21, v22, vcc
    v_cndmask_b32 v25, v22, v21, vcc
    s_mov_b64 s[4:5], s[68:69]
    s_mov_b32 s6, 2097152
    s_cmp_eq_u32 s32, 0
    s_cbranch_scc1 L_alt
    s_lshl1_add_u32 s7, s2, s35
    s_lshl_b32 s7, s7, 13
    s_mov_b64 s[4:5], s[64:65]
    s_mov_b32 s6, 0
L_alt:
    s_cmp_eq_u32 s32, 3
    s_cselect_b32 s47, 99, 13
    v_xor_b32 v17, 0x80, v16
    v_add_u32 v17, 7168, v17
    v_add_u32 v18, 14336, v16
    v_add_u32 v19, 14336, v17
    v_bfe_u32 v20, v15, 2, 7
    s_waitcnt vmcnt(0)
    s_barrier
    v_add_u32 v7, 0x6a09e667, v7
    buffer_store_dword v7, v20, s[84:87], s92 offen sc1
    v_readfirstlane_b32 s96, v7
    v_mov_b64 v[32:33], 0
    v_mov_b64 v[34:35], 0
    v_mov_b64 v[36:37], 0
    v_mov_b64 v[38:39], 0
    v_mov_b64 v[40:41], 0
    s_add_u32 s81, s36, s80
    s_and_b32 s81, s81, 15
    s_mul_i32 s38, s81, 458752
    s_mul_i32 s39, s81, 393216
    s_add_u32 m0, s37, s43
    s_nop 0
    buffer_load_dwordx4 v8, s[8:11], s38 offen offset:0 lds
    v_mov_b64 v[42:43], 0
    v_mov_b64 v[44:45], 0
    v_mov_b64 v[46:47], 0
    v_mov_b64 v[48:49], 0
    v_mov_b64 v[50:51], 0
    buffer_load_dwordx4 v9, s[8:11], s38 offen offset:1024 lds
    v_mov_b64 v[52:53], 0
    v_mov_b64 v[54:55], 0
    v_mov_b64 v[56:57], 0
    v_mov_b64 v[58:59], 0
    v_mov_b64 v[60:61], 0
    buffer_load_dwordx4 v10, s[8:11], s38 offen offset:2048 lds
    v_mov_b64 v[62:63], 0
    v_mov_b64 v[64:65], 0
    v_mov_b64 v[66:67], 0
    v_mov_b64 v[68:69], 0
    v_mov_b64 v[70:71], 0
    s_add_u32 m0, s37, s44
    s_nop 0
    buffer_load_dwordx4 v8, s[12:15], s38 offen offset:0 lds
    v_mov_b64 v[72:73], 0
    v_mov_b64 v[74:75], 0
    v_mov_b64 v[76:77], 0
    v_mov_b64 v[78:79], 0
    v_mov_b64 v[80:81], 0
    buffer_load_dwordx4 v9, s[12:15], s38 offen offset:1024 lds
    v_mov_b64 v[82:83], 0
    v_mov_b64 v[84:85], 0
    v_mov_b64 v[86:87], 0
    v_mov_b64 v[88:89], 0
    v_mov_b64 v[90:91], 0
    buffer_load_dwordx4 v10, s[12:15], s38 offen offset:2048 lds
    v_mov_b64 v[92:93], 0
    v_mov_b64 v[94:95], 0
    v_mov_b64 v[96:97], 0
    v_mov_b64 v[98:99], 0
    v_mov_b64 v[100:101], 0
    s_add_u32 m0, s37, s45
    s_nop 0
    buffer_load_dwordx4 v11, s[16:19], s39 offen offset:0 lds
    v_mov_b64 v[102:103], 0
    v_mov_b64 v[104:105], 0
    v_mov_b64 v[106:107], 0
    v_mov_b64 v[108:109], 0
    v_mov_b64 v[110:111], 0
    buffer_load_dwordx4 v12, s[16:19], s39 offen offset:1024 lds
    v_mov_b64 v[112:113], 0
    v_mov_b64 v[114:115], 0
    v_mov_b64 v[116:117], 0
    v_mov_b64 v[118:119], 0
    v_mov_b64 v[120:121], 0
    buffer_load_dwordx4 v13, s[16:19], s39 offen offset:2048 lds
    v_mov_b64 v[122:123], 0
    v_mov_b64 v[124:125], 0
    v_mov_b64 v[126:127], 0
    v_mov_b64 v[128:129], 0
    v_mov_b64 v[130:131], 0
    s_add_u32 m0, s37, s46
    s_nop 0
    buffer_load_dwordx4 v14, s[20:23], s38 offen lds
    v_mov_b64 v[132:133], 0
    v_mov_b64 v[134:135], 0
    v_mov_b64 v[136:137], 0
    v_mov_b64 v[138:139], 0
    v_mov_b64 v[140:141], 0
    s_mov_b32 s36, 1
    s_mov_b32 s37, 40960
    s_add_u32 s81, s36, s80
    s_and_b32 s81, s81, 15
    s_mul_i32 s38, s81, 458752
    s_mul_i32 s39, s81, 393216
    s_add_u32 m0, s37, s43
    s_nop 0
    buffer_load_dwordx4 v8, s[8:11], s38 offen offset:0 lds
    v_mov_b64 v[142:143], 0
    v_mov_b64 v[144:145], 0
    v_mov_b64 v[146:147], 0
    v_mov_b64 v[148:149], 0
    v_mov_b64 v[150:151], 0
    buffer_load_dwordx4 v9, s[8:11], s38 offen offset:1024 lds
    v_mov_b64 v[152:153], 0
    v_mov_b64 v[154:155], 0
    v_mov_b64 v[156:157], 0
    v_mov_b64 v[158:159], 0
    v_mov_b64 v[160:161], 0
    buffer_load_dwordx4 v10, s[8:11], s38 offen offset:2048 lds
    v_mov_b64 v[162:163], 0
    v_mov_b64 v[164:165], 0
    v_mov_b64 v[166:167], 0
    v_mov_b64 v[168:169], 0
    v_mov_b64 v[170:171], 0
    s_add_u32 m0, s37, s44
    s_nop 0
    buffer_load_dwordx4 v8, s[12:15], s38 offen offset:0 lds
    v_mov_b64 v[172:173], 0
    v_mov_b64 v[174:175], 0
    v_mov_b64 v[176:177], 0
    v_mov_b64 v[178:179], 0
    v_mov_b64 v[180:181], 0
    buffer_load_dwordx4 v9, s[12:15], s38 offen offset:1024 lds
    v_mov_b64 v[182:183], 0
    v_mov_b64 v[184:185], 0
    v_mov_b64 v[186:187], 0
    v_mov_b64 v[188:189], 0
    v_mov_b64 v[190:191], 0
    buffer_load_dwordx4 v10, s[12:15], s38 offen offset:2048 lds
    v_mov_b64 v[192:193], 0
    v_mov_b64 v[194:195], 0
    v_mov_b64 v[196:197], 0
    v_mov_b64 v[198:199], 0
    v_mov_b64 v[200:201], 0
    s_add_u32 m0, s37, s45
    s_nop 0
    buffer_load_dwordx4 v11, s[16:19], s39 offen offset:0 lds
    v_mov_b64 v[202:203], 0
    v_mov_b64 v[204:205], 0
    v_mov_b64 v[206:207], 0
    v_mov_b64 v[208:209], 0
    v_mov_b64 v[210:211], 0
    buffer_load_dword v255, v254, s[84:87], 0 offen sc1
    v_mov_b64 v[212:213], 0
    v_mov_b64 v[214:215], 0
    v_mov_b64 v[216:217], 0
    v_mov_b64 v[218:219], 0
    v_mov_b64 v[220:221], 0
    buffer_load_dwordx4 v12, s[16:19], s39 offen offset:1024 lds
    v_mov_b64 v[222:223], 0
    v_mov_b64 v[224:225], 0
    v_mov_b64 v[226:227], 0
    v_mov_b64 v[228:229], 0
    v_mov_b64 v[230:231], 0
    buffer_load_dwordx4 v13, s[16:19], s39 offen offset:2048 lds
    v_mov_b64 v[232:233], 0
    v_mov_b64 v[234:235], 0
    v_mov_b64 v[236:237], 0
    v_mov_b64 v[238:239], 0
    v_mov_b64 v[240:241], 0
    s_add_u32 m0, s37, s46
    s_nop 0
    buffer_load_dwordx4 v14, s[20:23], s38 offen lds
    v_mov_b64 v[242:243], 0
    v_mov_b64 v[244:245], 0
    v_mov_b64 v[246:247], 0
    v_mov_b64 v[248:249], 0
    v_mov_b64 v[250:251], 0
    v_mov_b64 v[252:253], 0
    s_lshl_b32 s72, s67, 19
    s_add_u32 s72, s72, s51
    s_bfe_u32 s3, s2, 0x10002
    s_add_u32 s3, s3, s32
    s_lshl_b32 s3, s3, 16
    s_add_u32 s72, s72, s3
    s_lshl_b32 s56, s32, 12
    s_add_u32 s56, s56, 40960
    s_lshl_b32 s48, s33, 1
    s_lshr_b32 s3, s32, 1
    s_add_u32 s48, s48, s3
    s_mul_i32 s48, s48, 1179648
    s_lshl_b32 s3, s35, 12
    s_add_u32 s48, s48, s3
    s_mul_i32 s73, s34, 7
    s_lshr_b32 s73, s73, 1
    s_lshl_b32 s73, s73, 13
    s_add_u32 s73, s73, s48
    s_lshl_b32 s3, s57, 9
    s_add_u32 s73, s73, s3
    s_mul_i32 s74, s57, 7168
    s_add_u32 s74, s74, 512
    s_add_u32 s74, s74, s73
    s_add_u32 s75, s34, 112
    s_lshl_b32 s75, s75, 13
    s_add_u32 s75, s75, s48
    s_lshl2_add_u32 s92, s33, s32
    s_lshl_b32 s92, s92, 7
    s_lshl2_add_u32 s92, s34, s92
    s_add_u32 s35, s92, 40960
    s_lshl_b32 s92, s92, 5
    s_add_u32 s92, s92, 131072
    s_lshl2_add_u32 s58, s67, s32
    s_lshl_b32 s58, s58, 7
    s_add_u32 s59, s58, 40960
    s_lshl_b32 s58, s58, 5
    s_add_u32 s58, s58, 131072
    s_or_b32 s33, s33, s32
    s_lshr_b32 s3, s32, 1
    s_lshl1_add_u32 s57, s67, s3
    s_mul_i32 s57, s57, 1179648
    s_and_b32 s3, s32, 1
    s_lshl_b32 s3, s3, 12
    s_add_u32 s57, s57, s3
    s_mov_b32 s50, 0xbfb8aa3b
    s_mov_b32 s51, 0xbfb8aa3b
    s_mov_b32 s52, 1.0
    s_mov_b32 s53, 1.0
    s_waitcnt vmcnt(3)
    v_cmp_ne_u32 vcc, s96, v255
    s_cbranch_vccz L_f0_ok
    s_mov_b32 s97, 0
L_f0_spin:
    s_sleep 1
    buffer_load_dword v255, v254, s[84:87], 0 offen sc1
    s_add_u32 s97, s97, 1
    s_waitcnt vmcnt(0)
    s_cmp_gt_u32 s97, 0x80000
    s_cbranch_scc1 L_f0_ok
    v_cmp_ne_u32 vcc, s96, v255
    s_cbranch_vccnz L_f0_spin
L_f0_ok:
    buffer_load_dwordx4 a[100:103], v15, s[24:27], s40 offen offset:0 sc1
    buffer_load_dwordx4 a[104:107], v15, s[24:27], s40 offen offset:1024 sc1
    buffer_load_dwordx4 a[108:111], v15, s[24:27], s40 offen offset:2048 sc1
    buffer_load_dwordx4 a[112:115], v15, s[24:27], s40 offen offset:3072 sc1
    buffer_load_dwordx4 a[116:119], v15, s[24:27], s41 offen offset:0 sc1
    buffer_load_dwordx4 a[120:123], v15, s[24:27], s41 offen offset:1024 sc1
    buffer_load_dwordx4 a[124:127], v15, s[24:27], s41 offen offset:2048 sc1
    buffer_load_dwordx4 a[128:131], v15, s[24:27], s41 offen offset:3072 sc1
    buffer_load_dwordx4 a[132:135], v15, s[24:27], s42 offen offset:0 sc1
    buffer_load_dwordx4 a[136:139], v15, s[24:27], s42 offen offset:1024 sc1
    s_add_u32 s40, s80, 15
    s_and_b32 s40, s40, 15
    s_lshl_b32 s40, s40, 15
    s_add_u32 s40, s40, s60
    s_add_u32 s41, s40, 4096
    buffer_load_dwordx4 a[224:227], v15, s[24:27], s40 offen offset:0 sc1
    buffer_load_dwordx4 a[228:231], v15, s[24:27], s40 offen offset:1024 sc1
    buffer_load_dwordx4 a[232:235], v15, s[24:27], s40 offen offset:2048 sc1
    buffer_load_dwordx4 a[236:239], v15, s[24:27], s40 offen offset:3072 sc1
    buffer_load_dwordx4 a[240:243], v15, s[24:27], s41 offen offset:0 sc1
    buffer_load_dwordx4 a[244:247], v15, s[24:27], s41 offen offset:1024 sc1
    buffer_load_dwordx4 a[248:251], v15, s[24:27], s41 offen offset:2048 sc1
    buffer_load_dwordx4 a[252:255], v15, s[24:27], s41 offen offset:3072 sc1
    v_mov_b64 v[254:255], 0
    v_mfma_f32_16x16x32_bf16 a[0:3], v[48:51], v[48:51], 0
    v_mfma_f32_16x16x32_bf16 a[4:7], v[48:51], v[48:51], 0
    v_mfma_f32_16x16x32_bf16 a[8:11], v[48:51], v[48:51], 0
    v_mfma_f32_16x16x32_bf16 a[12:15], v[48:51], v[48:51], 0
    v_mfma_f32_16x16x32_bf16 a[16:19], v[48:51], v[48:51], 0
    v_mfma_f32_16x16x32_bf16 a[20:23], v[48:51], v[48:51], 0
    v_mfma_f32_16x16x32_bf16 a[24:27], v[48:51], v[48:51], 0
    v_mfma_f32_16x16x32_bf16 a[28:31], v[48:51], v[48:51], 0
    v_mfma_f32_16x16x32_bf16 a[32:35], v[48:51], v[48:51], 0
    v_mfma_f32_16x16x32_bf16 a[36:39], v[48:51], v[48:51], 0
    v_mfma_f32_16x16x32_bf16 a[40:43], v[48:51], v[48:51], 0
    v_mfma_f32_16x16x32_bf16 a[44:47], v[48:51], v[48:51], 0
    v_mfma_f32_16x16x32_bf16 a[48:51], v[48:51], v[48:51], 0
    v_mfma_f32_16x16x32_bf16 a[52:55], v[48:51], v[48:51], 0
    v_mfma_f32_16x16x32_bf16 a[56:59], v[48:51], v[48:51], 0
    v_mfma_f32_16x16x32_bf16 a[60:63], v[48:51], v[48:51], 0
    v_mfma_f32_16x16x32_bf16 a[64:67], v[48:51], v[48:51], 0
    v_mfma_f32_16x16x32_bf16 a[68:71], v[48:51], v[48:51], 0
    v_mfma_f32_16x16x32_bf16 a[72:75], v[48:51], v[48:51], 0
    v_mfma_f32_16x16x32_bf16 a[76:79], v[48:51], v[48:51], 0
    v_mfma_f32_16x16x32_bf16 a[80:83], v[48:51], v[48:51], 0
    v_mfma_f32_16x16x32_bf16 a[84:87], v[48:51], v[48:51], 0
    v_mfma_f32_16x16x32_bf16 a[88:91], v[48:51], v[48:51], 0
    v_mfma_f32_16x16x32_bf16 a[92:95], v[48:51], v[48:51], 0
    v_mfma_f32_16x16x32_bf16 a[96:99], v[48:51], v[48:51], 0
    s_waitcnt vmcnt(8)
    s_barrier
    ds_read_b64_tr_b16 a[180:181], v1 offset:0
    ds_read_b64_tr_b16 a[182:183], v1 offset:3584
    ds_read_b64_tr_b16 a[184:185], v1 offset:7168
    ds_read_b64_tr_b16 a[186:187], v1 offset:10752
    ds_read_b64_tr_b16 a[188:189], v1 offset:14336
    ds_read_b64_tr_b16 a[190:191], v1 offset:17920
    ds_read_b64_tr_b16 a[192:193], v1 offset:21504
    ds_read_b64_tr_b16 a[194:195], v1 offset:25088
    ds_read_b64_tr_b16 a[196:197], v1 offset:32
    ds_read_b64_tr_b16 a[198:199], v1 offset:3616
    ds_read_b64_tr_b16 a[200:201], v1 offset:7200
    ds_read_b64_tr_b16 a[202:203], v1 offset:10784
    s_add_u32 s94, s94, s95
    s_cmp_ge_u32 s94, s90
    s_cselect_b32 s3, s90, 0
    s_sub_u32 s94, s94, s3
    s_cmp_eq_u32 s32, 3
    s_cselect_b32 s95, 4294705152, s95
    s_cselect_b32 s49, -1, s90
    .p2align 6
L_g1:
    s_waitcnt lgkmcnt(8)
    v_mfma_f32_16x16x32_bf16 v[32:35], a[180:183], a[100:103], v[32:35]
    ds_read_b64_tr_b16 a[204:205], v1 offset:14368
    v_mfma_f32_16x16x32_bf16 v[32:35], a[184:187], a[104:107], v[32:35]
    s_lshl_b32 s40, s81, 15
    v_mfma_f32_16x16x32_bf16 v[36:39], a[180:183], a[108:111], v[36:39]
    ds_read_b64_tr_b16 a[206:207], v1 offset:17952
    s_add_u32 s42, s40, s61
    v_mfma_f32_16x16x32_bf16 v[36:39], a[184:187], a[112:115], v[36:39]
    s_add_u32 s40, s40, s60
    v_mfma_f32_16x16x32_bf16 v[40:43], a[180:183], a[116:119], v[40:43]
    ds_read_b64_tr_b16 a[208:209], v1 offset:21536
    s_add_u32 s41, s40, 4096
    v_mfma_f32_16x16x32_bf16 v[40:43], a[184:187], a[120:123], v[40:43]
    buffer_load_dwordx4 a[140:143], v15, s[24:27], s40 offen offset:0 sc1
    v_mfma_f32_16x16x32_bf16 v[44:47], a[180:183], a[124:127], v[44:47]
    ds_read_b64_tr_b16 a[210:211], v1 offset:25120
    v_mfma_f32_16x16x32_bf16 v[44:47], a[184:187], a[128:131], v[44:47]
    s_waitcnt lgkmcnt(8)
    v_mfma_f32_16x16x32_bf16 v[48:51], a[188:191], a[100:103], v[48:51]
    ds_read_b64_tr_b16 a[180:181], v1 offset:64
    v_mfma_f32_16x16x32_bf16 v[48:51], a[192:195], a[104:107], v[48:51]
    v_mfma_f32_16x16x32_bf16 v[52:55], a[188:191], a[108:111], v[52:55]
    ds_read_b64_tr_b16 a[182:183], v1 offset:3648
    v_mfma_f32_16x16x32_bf16 v[52:55], a[192:195], a[112:115], v[52:55]
    buffer_load_dwordx4 a[144:147], v15, s[24:27], s40 offen offset:1024 sc1
    s_add_u32 s36, s36, 1
    s_add_u32 s81, s36, s80
    v_mfma_f32_16x16x32_bf16 v[56:59], a[188:191], a[116:119], v[56:59]
    ds_read_b64_tr_b16 a[184:185], v1 offset:7232
    s_and_b32 s81, s81, 15
    v_mfma_f32_16x16x32_bf16 v[56:59], a[192:195], a[120:123], v[56:59]
    s_mul_i32 s38, s81, 458752
    v_mfma_f32_16x16x32_bf16 v[60:63], a[188:191], a[124:127], v[60:63]
    ds_read_b64_tr_b16 a[186:187], v1 offset:10816
    s_mul_i32 s39, s81, 393216
    v_mfma_f32_16x16x32_bf16 v[60:63], a[192:195], a[128:131], v[60:63]
    buffer_load_dwordx4 a[148:151], v15, s[24:27], s40 offen offset:2048 sc1
    s_waitcnt lgkmcnt(8)
    v_mfma_f32_16x16x32_bf16 v[64:67], a[196:199], a[100:103], v[64:67]
    ds_read_b64_tr_b16 a[188:189], v1 offset:14400
    v_mfma_f32_16x16x32_bf16 v[64:67], a[200:203], a[104:107], v[64:67]
    v_mfma_f32_16x16x32_bf16 v[68:71], a[196:199], a[108:111], v[68:71]
    ds_read_b64_tr_b16 a[190:191], v1 offset:17984
    v_mfma_f32_16x16x32_bf16 v[68:71], a[200:203], a[112:115], v[68:71]
    v_mfma_f32_16x16x32_bf16 v[72:75], a[196:199], a[116:119], v[72:75]
    ds_read_b64_tr_b16 a[192:193], v1 offset:21568
    v_mfma_f32_16x16x32_bf16 v[72:75], a[200:203], a[120:123], v[72:75]
    buffer_load_dwordx4 a[152:155], v15, s[24:27], s40 offen offset:3072 sc1
    v_mfma_f32_16x16x32_bf16 v[76:79], a[196:199], a[124:127], v[76:79]
    ds_read_b64_tr_b16 a[194:195], v1 offset:25152
    v_mfma_f32_16x16x32_bf16 v[76:79], a[200:203], a[128:131], v[76:79]
    s_waitcnt lgkmcnt(8)
    v_mfma_f32_16x16x32_bf16 v[80:83], a[204:207], a[100:103], v[80:83]
    ds_read_b64_tr_b16 a[196:197], v1 offset:96
    s_add_u32 s37, s37, s62
    v_mfma_f32_16x16x32_bf16 v[80:83], a[208:211], a[104:107], v[80:83]
    s_cmp_eq_u32 s37, 122880
    v_mfma_f32_16x16x32_bf16 v[84:87], a[204:207], a[108:111], v[84:87]
    ds_read_b64_tr_b16 a[198:199], v1 offset:3680
    s_cselect_b32 s37, 0, s37
    v_mfma_f32_16x16x32_bf16 v[84:87], a[208:211], a[112:115], v[84:87]
    buffer_load_dwordx4 a[156:159], v15, s[24:27], s41 offen offset:0 sc1
    v_mfma_f32_16x16x32_bf16 v[88:91], a[204:207], a[116:119], v[88:91]
    ds_read_b64_tr_b16 a[200:201], v1 offset:7264
    v_mfma_f32_16x16x32_bf16 v[88:91], a[208:211], a[120:123], v[88:91]
    v_mfma_f32_16x16x32_bf16 v[92:95], a[204:207], a[124:127], v[92:95]
    ds_read_b64_tr_b16 a[202:203], v1 offset:10848
    v_mfma_f32_16x16x32_bf16 v[92:95], a[208:211], a[128:131], v[92:95]
    s_waitcnt lgkmcnt(8)
    v_mfma_f32_16x16x32_bf16 v[96:99], a[180:183], a[100:103], v[96:99]
    ds_read_b64_tr_b16 a[204:205], v1 offset:14432
    v_mfma_f32_16x16x32_bf16 v[96:99], a[184:187], a[104:107], v[96:99]
    buffer_load_dwordx4 a[160:163], v15, s[24:27], s41 offen offset:1024 sc1
    v_mfma_f32_16x16x32_bf16 v[100:103], a[180:183], a[108:111], v[100:103]
    ds_read_b64_tr_b16 a[206:207], v1 offset:18016
    v_mfma_f32_16x16x32_bf16 v[100:103], a[184:187], a[112:115], v[100:103]
    s_cmp_eq_u32 s37, s62
    v_mfma_f32_16x16x32_bf16 v[104:107], a[180:183], a[116:119], v[104:107]
    ds_read_b64_tr_b16 a[208:209], v1 offset:21600
    s_cselect_b32 s93, s63, s62
    v_mfma_f32_16x16x32_bf16 v[104:107], a[184:187], a[120:123], v[104:107]
    buffer_load_dwordx4 a[164:167], v15, s[24:27], s41 offen offset:2048 sc1
    v_mfma_f32_16x16x32_bf16 v[108:111], a[180:183], a[124:127], v[108:111]
    ds_read_b64_tr_b16 a[210:211], v1 offset:25184
    v_mfma_f32_16x16x32_bf16 v[108:111], a[184:187], a[128:131], v[108:111]
    s_waitcnt lgkmcnt(8)
    v_mfma_f32_16x16x32_bf16 v[112:115], a[188:191], a[100:103], v[112:115]
    ds_read_b64_tr_b16 a[180:181], v1 offset:128
    v_mfma_f32_16x16x32_bf16 v[112:115], a[192:195], a[104:107], v[112:115]
    v_mfma_f32_16x16x32_bf16 v[116:119], a[188:191], a[108:111], v[116:119]
    ds_read_b64_tr_b16 a[182:183], v1 offset:3712
    v_mfma_f32_16x16x32_bf16 v[116:119], a[192:195], a[112:115], v[116:119]
    buffer_load_dwordx4 a[168:171], v15, s[24:27], s41 offen offset:3072 sc1
    v_mfma_f32_16x16x32_bf16 v[120:123], a[188:191], a[116:119], v[120:123]
    ds_read_b64_tr_b16 a[184:185], v1 offset:7296
    v_mfma_f32_16x16x32_bf16 v[120:123], a[192:195], a[120:123], v[120:123]
    v_mfma_f32_16x16x32_bf16 v[124:127], a[188:191], a[124:127], v[124:127]
    ds_read_b64_tr_b16 a[186:187], v1 offset:10880
    v_mfma_f32_16x16x32_bf16 v[124:127], a[192:195], a[128:131], v[124:127]
    s_waitcnt lgkmcnt(8)
    v_mfma_f32_16x16x32_bf16 v[128:131], a[196:199], a[100:103], v[128:131]
    ds_read_b64_tr_b16 a[188:189], v1 offset:14464
    v_mfma_f32_16x16x32_bf16 v[128:131], a[200:203], a[104:107], v[128:131]
    buffer_load_dwordx4 a[172:175], v15, s[24:27], s42 offen offset:0 sc1
    v_mfma_f32_16x16x32_bf16 v[132:135], a[196:199], a[108:111], v[132:135]
    ds_read_b64_tr_b16 a[190:191], v1 offset:18048
    v_mfma_f32_16x16x32_bf16 v[132:135], a[200:203], a[112:115], v[132:135]
    v_mfma_f32_16x16x32_bf16 v[136:139], a[196:199], a[116:119], v[136:139]
    ds_read_b64_tr_b16 a[192:193], v1 offset:21632
    v_mfma_f32_16x16x32_bf16 v[136:139], a[200:203], a[120:123], v[136:139]
    buffer_load_dwordx4 a[176:179], v15, s[24:27], s42 offen offset:1024 sc1
    v_mfma_f32_16x16x32_bf16 v[140:143], a[196:199], a[124:127], v[140:143]
    ds_read_b64_tr_b16 a[194:195], v1 offset:25216
    v_mfma_f32_16x16x32_bf16 v[140:143], a[200:203], a[128:131], v[140:143]
    s_waitcnt lgkmcnt(8)
    v_mfma_f32_16x16x32_bf16 v[144:147], a[204:207], a[100:103], v[144:147]
    ds_read_b64_tr_b16 a[196:197], v1 offset:160
    v_mfma_f32_16x16x32_bf16 v[144:147], a[208:211], a[104:107], v[144:147]
    v_mfma_f32_16x16x32_bf16 v[148:151], a[204:207], a[108:111], v[148:151]
    ds_read_b64_tr_b16 a[198:199], v1 offset:3744
    s_add_u32 m0, s37, s43
    v_mfma_f32_16x16x32_bf16 v[148:151], a[208:211], a[112:115], v[148:151]
    buffer_load_dwordx4 v8, s[8:11], s38 offen offset:0 lds
    v_mfma_f32_16x16x32_bf16 v[152:155], a[204:207], a[116:119], v[152:155]
    ds_read_b64_tr_b16 a[200:201], v1 offset:7328
    v_mfma_f32_16x16x32_bf16 v[152:155], a[208:211], a[120:123], v[152:155]
    v_mfma_f32_16x16x32_bf16 v[156:159], a[204:207], a[124:127], v[156:159]
    ds_read_b64_tr_b16 a[202:203], v1 offset:10912
    v_mfma_f32_16x16x32_bf16 v[156:159], a[208:211], a[128:131], v[156:159]
    s_waitcnt lgkmcnt(8)
    v_mfma_f32_16x16x32_bf16 v[160:163], a[180:183], a[100:103], v[160:163]
    ds_read_b64_tr_b16 a[204:205], v1 offset:14496
    v_mfma_f32_16x16x32_bf16 v[160:163], a[184:187], a[104:107], v[160:163]
    buffer_load_dwordx4 v9, s[8:11], s38 offen offset:1024 lds
    v_mfma_f32_16x16x32_bf16 v[164:167], a[180:183], a[108:111], v[164:167]
    ds_read_b64_tr_b16 a[206:207], v1 offset:18080
    v_mfma_f32_16x16x32_bf16 v[164:167], a[184:187], a[112:115], v[164:167]
    v_mfma_f32_16x16x32_bf16 v[168:171], a[180:183], a[116:119], v[168:171]
    ds_read_b64_tr_b16 a[208:209], v1 offset:21664
    v_mfma_f32_16x16x32_bf16 v[168:171], a[184:187], a[120:123], v[168:171]
    buffer_load_dwordx4 v10, s[8:11], s38 offen offset:2048 lds
    v_mfma_f32_16x16x32_bf16 v[172:175], a[180:183], a[124:127], v[172:175]
    ds_read_b64_tr_b16 a[210:211], v1 offset:25248
    v_mfma_f32_16x16x32_bf16 v[172:175], a[184:187], a[128:131], v[172:175]
    s_waitcnt lgkmcnt(8)
    v_mfma_f32_16x16x32_bf16 v[176:179], a[188:191], a[100:103], v[176:179]
    ds_read_b64_tr_b16 a[180:181], v1 offset:192
    v_mfma_f32_16x16x32_bf16 v[176:179], a[192:195], a[104:107], v[176:179]
    ds_read_b64_tr_b16 a[212:213], v4 offset:0
    v_mfma_f32_16x16x32_bf16 v[180:183], a[188:191], a[108:111], v[180:183]
    ds_read_b64_tr_b16 a[182:183], v1 offset:3776
    v_mfma_f32_16x16x32_bf16 v[180:183], a[192:195], a[112:115], v[180:183]
    ds_read_b64_tr_b16 a[214:215], v4 offset:3072
    v_mfma_f32_16x16x32_bf16 v[184:187], a[188:191], a[116:119], v[184:187]
    ds_read_b64_tr_b16 a[184:185], v1 offset:7360
    v_mfma_f32_16x16x32_bf16 v[184:187], a[192:195], a[120:123], v[184:187]
    ds_read_b64_tr_b16 a[216:217], v4 offset:6144
    v_mfma_f32_16x16x32_bf16 v[188:191], a[188:191], a[124:127], v[188:191]
    ds_read_b64_tr_b16 a[186:187], v1 offset:10944
    v_mfma_f32_16x16x32_bf16 v[188:191], a[192:195], a[128:131], v[188:191]
    ds_read_b64_tr_b16 a[218:219], v4 offset:9216
    s_waitcnt lgkmcnt(12)
    v_mfma_f32_16x16x32_bf16 v[192:195], a[196:199], a[100:103], v[192:195]
    ds_read_b64_tr_b16 a[188:189], v1 offset:14528
    v_mfma_f32_16x16x32_bf16 v[192:195], a[200:203], a[104:107], v[192:195]
    v_mfma_f32_16x16x32_bf16 v[196:199], a[196:199], a[108:111], v[196:199]
    ds_read_b64_tr_b16 a[190:191], v1 offset:18112
    s_add_u32 m0, s37, s44
    v_mfma_f32_16x16x32_bf16 v[196:199], a[200:203], a[112:115], v[196:199]
    buffer_load_dwordx4 v8, s[12:15], s38 offen offset:0 lds
    v_mfma_f32_16x16x32_bf16 v[200:203], a[196:199], a[116:119], v[200:203]
    ds_read_b64_tr_b16 a[192:193], v1 offset:21696
    v_mfma_f32_16x16x32_bf16 v[200:203], a[200:203], a[120:123], v[200:203]
    v_mfma_f32_16x16x32_bf16 v[204:207], a[196:199], a[124:127], v[204:207]
    ds_read_b64_tr_b16 a[194:195], v1 offset:25280
    v_mfma_f32_16x16x32_bf16 v[204:207], a[200:203], a[128:131], v[204:207]
    s_waitcnt lgkmcnt(12)
    v_mfma_f32_16x16x32_bf16 v[208:211], a[204:207], a[100:103], v[208:211]
    ds_read_b64_tr_b16 a[196:197], v2 offset:0
    v_mfma_f32_16x16x32_bf16 v[208:211], a[208:211], a[104:107], v[208:211]
    buffer_load_dwordx4 v9, s[12:15], s38 offen offset:1024 lds
    v_mfma_f32_16x16x32_bf16 v[212:215], a[204:207], a[108:111], v[212:215]
    ds_read_b64_tr_b16 a[198:199], v2 offset:3072
    v_mfma_f32_16x16x32_bf16 v[212:215], a[208:211], a[112:115], v[212:215]
    v_mfma_f32_16x16x32_bf16 v[216:219], a[204:207], a[116:119], v[216:219]
    ds_read_b64_tr_b16 a[200:201], v2 offset:6144
    v_mfma_f32_16x16x32_bf16 v[216:219], a[208:211], a[120:123], v[216:219]
    v_mfma_f32_16x16x32_bf16 v[220:223], a[204:207], a[124:127], v[220:223]
    ds_read_b64_tr_b16 a[202:203], v2 offset:9216
    v_mfma_f32_16x16x32_bf16 v[220:223], a[208:211], a[128:131], v[220:223]
    buffer_load_dwordx4 v10, s[12:15], s38 offen offset:2048 lds
    s_waitcnt lgkmcnt(9)
    v_mfma_f32_16x16x32_bf16 v[224:227], a[180:183], a[100:103], v[224:227]
    ds_read_b64_tr_b16 a[204:205], v3 offset:0
    v_mfma_f32_16x16x32_bf16 v[224:227], a[184:187], a[104:107], v[224:227]
    v_mfma_f32_16x16x32_bf16 v[228:231], a[180:183], a[108:111], v[228:231]
    ds_read_b64_tr_b16 a[206:207], v3 offset:3072
    s_add_u32 m0, s37, s45
    v_mfma_f32_16x16x32_bf16 v[228:231], a[184:187], a[112:115], v[228:231]
    buffer_load_dwordx4 v11, s[16:19], s39 offen offset:0 lds
    v_mfma_f32_16x16x32_bf16 v[232:235], a[180:183], a[116:119], v[232:235]
    ds_read_b64_tr_b16 a[208:209], v3 offset:6144
    v_mfma_f32_16x16x32_bf16 v[232:235], a[184:187], a[120:123], v[232:235]
    v_mfma_f32_16x16x32_bf16 v[236:239], a[180:183], a[124:127], v[236:239]
    ds_read_b64_tr_b16 a[210:211], v3 offset:9216
    v_mfma_f32_16x16x32_bf16 v[236:239], a[184:187], a[128:131], v[236:239]
    s_waitcnt lgkmcnt(8)
    v_mfma_f32_16x16x32_bf16 v[240:243], a[188:191], a[100:103], v[240:243]
    ds_read_b64_tr_b16 a[180:181], v2 offset:64
    v_mfma_f32_16x16x32_bf16 v[240:243], a[192:195], a[104:107], v[240:243]
    buffer_load_dwordx4 v12, s[16:19], s39 offen offset:1024 lds
    v_mfma_f32_16x16x32_bf16 v[244:247], a[188:191], a[108:111], v[244:247]
    ds_read_b64_tr_b16 a[182:183], v2 offset:3136
    v_mfma_f32_16x16x32_bf16 v[244:247], a[192:195], a[112:115], v[244:247]
    v_mfma_f32_16x16x32_bf16 v[248:251], a[188:191], a[116:119], v[248:251]
    ds_read_b64_tr_b16 a[184:185], v2 offset:6208
    v_mfma_f32_16x16x32_bf16 v[248:251], a[192:195], a[120:123], v[248:251]
    v_mfma_f32_16x16x32_bf16 v[252:255], a[188:191], a[124:127], v[252:255]
    ds_read_b64_tr_b16 a[186:187], v2 offset:9280
    v_mfma_f32_16x16x32_bf16 v[252:255], a[192:195], a[128:131], v[252:255]
    buffer_load_dwordx4 v13, s[16:19], s39 offen offset:2048 lds
    v_mfma_f32_16x16x32_bf16 a[96:99], a[212:215], a[132:135], a[96:99]
    v_mfma_f32_16x16x32_bf16 a[96:99], a[216:219], a[136:139], a[96:99]
    s_waitcnt lgkmcnt(8)
    v_mfma_f32_16x16x32_bf16 a[0:3], a[196:199], a[100:103], a[0:3]
    ds_read_b64_tr_b16 a[188:189], v3 offset:64
    v_mfma_f32_16x16x32_bf16 a[0:3], a[200:203], a[104:107], a[0:3]
    v_mfma_f32_16x16x32_bf16 a[4:7], a[196:199], a[108:111], a[4:7]
    ds_read_b64_tr_b16 a[190:191], v3 offset:3136
    s_add_u32 m0, s37, s46
    v_mfma_f32_16x16x32_bf16 a[4:7], a[200:203], a[112:115], a[4:7]
    buffer_load_dwordx4 v14, s[20:23], s38 offen lds
    v_mfma_f32_16x16x32_bf16 a[8:11], a[196:199], a[116:119], a[8:11]
    ds_read_b64_tr_b16 a[192:193], v3 offset:6208
    v_mfma_f32_16x16x32_bf16 a[8:11], a[200:203], a[120:123], a[8:11]
    v_mfma_f32_16x16x32_bf16 a[12:15], a[196:199], a[124:127], a[12:15]
    ds_read_b64_tr_b16 a[194:195], v3 offset:9280
    v_mfma_f32_16x16x32_bf16 a[12:15], a[200:203], a[128:131], a[12:15]
    s_waitcnt lgkmcnt(8)
    v_mfma_f32_16x16x32_bf16 a[16:19], a[204:207], a[100:103], a[16:19]
    ds_read_b64_tr_b16 a[196:197], v2 offset:128
    v_mfma_f32_16x16x32_bf16 a[16:19], a[208:211], a[104:107], a[16:19]
    buffer_load_dword v29, v27, s[88:91], s94 offen
    v_mfma_f32_16x16x32_bf16 a[20:23], a[204:207], a[108:111], a[20:23]
    ds_read_b64_tr_b16 a[198:199], v2 offset:3200
    v_mfma_f32_16x16x32_bf16 a[20:23], a[208:211], a[112:115], a[20:23]
    v_mfma_f32_16x16x32_bf16 a[24:27], a[204:207], a[116:119], a[24:27]
    ds_read_b64_tr_b16 a[200:201], v2 offset:6272
    v_mfma_f32_16x16x32_bf16 a[24:27], a[208:211], a[120:123], a[24:27]
    v_mfma_f32_16x16x32_bf16 a[28:31], a[204:207], a[124:127], a[28:31]
    ds_read_b64_tr_b16 a[202:203], v2 offset:9344
    v_mfma_f32_16x16x32_bf16 a[28:31], a[208:211], a[128:131], a[28:31]
    s_waitcnt lgkmcnt(8)
    v_mfma_f32_16x16x32_bf16 a[32:35], a[180:183], a[100:103], a[32:35]
    ds_read_b64_tr_b16 a[204:205], v3 offset:128
    v_mfma_f32_16x16x32_bf16 a[32:35], a[184:187], a[104:107], a[32:35]
    v_mfma_f32_16x16x32_bf16 a[36:39], a[180:183], a[108:111], a[36:39]
    ds_read_b64_tr_b16 a[206:207], v3 offset:3200
    v_mfma_f32_16x16x32_bf16 a[36:39], a[184:187], a[112:115], a[36:39]
    v_mfma_f32_16x16x32_bf16 a[40:43], a[180:183], a[116:119], a[40:43]
    ds_read_b64_tr_b16 a[208:209], v3 offset:6272
    v_mfma_f32_16x16x32_bf16 a[40:43], a[184:187], a[120:123], a[40:43]
    v_mfma_f32_16x16x32_bf16 a[44:47], a[180:183], a[124:127], a[44:47]
    ds_read_b64_tr_b16 a[210:211], v3 offset:9344
    v_mfma_f32_16x16x32_bf16 a[44:47], a[184:187], a[128:131], a[44:47]
    s_waitcnt lgkmcnt(8)
    v_mfma_f32_16x16x32_bf16 a[48:51], a[188:191], a[100:103], a[48:51]
    v_mfma_f32_16x16x32_bf16 a[48:51], a[192:195], a[104:107], a[48:51]
    v_add_u32 v1, s93, v1
    v_mfma_f32_16x16x32_bf16 a[52:55], a[188:191], a[108:111], a[52:55]
    v_add_u32 v2, s93, v2
    v_mfma_f32_16x16x32_bf16 a[52:55], a[192:195], a[112:115], a[52:55]
    v_add_u32 v3, s93, v3
    v_mfma_f32_16x16x32_bf16 a[56:59], a[188:191], a[116:119], a[56:59]
    v_add_u32 v4, s93, v4
    v_mfma_f32_16x16x32_bf16 a[56:59], a[192:195], a[120:123], a[56:59]
    v_mfma_f32_16x16x32_bf16 a[60:63], a[188:191], a[124:127], a[60:63]
    v_mfma_f32_16x16x32_bf16 a[60:63], a[192:195], a[128:131], a[60:63]
    s_waitcnt vmcnt(11) lgkmcnt(0)
    s_barrier
    v_mfma_f32_16x16x32_bf16 a[64:67], a[100:103], a[196:199], a[64:67]
    ds_read_b64_tr_b16 a[180:181], v1 offset:0
    v_mfma_f32_16x16x32_bf16 a[64:67], a[104:107], a[200:203], a[64:67]
    ds_read_b64_tr_b16 a[182:183], v1 offset:3584
    v_mfma_f32_16x16x32_bf16 a[68:71], a[108:111], a[196:199], a[68:71]
    ds_read_b64_tr_b16 a[184:185], v1 offset:7168
    v_mfma_f32_16x16x32_bf16 a[68:71], a[112:115], a[200:203], a[68:71]
    ds_read_b64_tr_b16 a[186:187], v1 offset:10752
    v_mfma_f32_16x16x32_bf16 a[72:75], a[116:119], a[196:199], a[72:75]
    ds_read_b64_tr_b16 a[188:189], v1 offset:14336
    v_mfma_f32_16x16x32_bf16 a[72:75], a[120:123], a[200:203], a[72:75]
    ds_read_b64_tr_b16 a[190:191], v1 offset:17920
    v_mfma_f32_16x16x32_bf16 a[76:79], a[124:127], a[196:199], a[76:79]
    ds_read_b64_tr_b16 a[192:193], v1 offset:21504
    v_mfma_f32_16x16x32_bf16 a[76:79], a[128:131], a[200:203], a[76:79]
    ds_read_b64_tr_b16 a[194:195], v1 offset:25088
    v_mfma_f32_16x16x32_bf16 a[80:83], a[100:103], a[204:207], a[80:83]
    ds_read_b64_tr_b16 a[196:197], v1 offset:32
    v_mfma_f32_16x16x32_bf16 a[80:83], a[104:107], a[208:211], a[80:83]
    v_mfma_f32_16x16x32_bf16 a[84:87], a[108:111], a[204:207], a[84:87]
    ds_read_b64_tr_b16 a[198:199], v1 offset:3616
    v_mfma_f32_16x16x32_bf16 a[84:87], a[112:115], a[208:211], a[84:87]
    v_mfma_f32_16x16x32_bf16 a[88:91], a[116:119], a[204:207], a[88:91]
    ds_read_b64_tr_b16 a[200:201], v1 offset:7200
    v_mfma_f32_16x16x32_bf16 a[88:91], a[120:123], a[208:211], a[88:91]
    v_mfma_f32_16x16x32_bf16 a[92:95], a[124:127], a[204:207], a[92:95]
    ds_read_b64_tr_b16 a[202:203], v1 offset:10784
    v_mfma_f32_16x16x32_bf16 a[92:95], a[128:131], a[208:211], a[92:95]
    s_waitcnt lgkmcnt(8)
    v_mfma_f32_16x16x32_bf16 v[32:35], a[180:183], a[140:143], v[32:35]
    ds_read_b64_tr_b16 a[204:205], v1 offset:14368
    v_mfma_f32_16x16x32_bf16 v[32:35], a[184:187], a[144:147], v[32:35]
    s_lshl_b32 s40, s81, 15
    v_mfma_f32_16x16x32_bf16 v[36:39], a[180:183], a[148:151], v[36:39]
    ds_read_b64_tr_b16 a[206:207], v1 offset:17952
    s_add_u32 s42, s40, s61
    v_mfma_f32_16x16x32_bf16 v[36:39], a[184:187], a[152:155], v[36:39]
    s_add_u32 s40, s40, s60
    v_mfma_f32_16x16x32_bf16 v[40:43], a[180:183], a[156:159], v[40:43]
    ds_read_b64_tr_b16 a[208:209], v1 offset:21536
    s_add_u32 s41, s40, 4096
    v_mfma_f32_16x16x32_bf16 v[40:43], a[184:187], a[160:163], v[40:43]
    buffer_load_dwordx4 a[100:103], v15, s[24:27], s40 offen offset:0 sc1
    v_mfma_f32_16x16x32_bf16 v[44:47], a[180:183], a[164:167], v[44:47]
    ds_read_b64_tr_b16 a[210:211], v1 offset:25120
    v_mfma_f32_16x16x32_bf16 v[44:47], a[184:187], a[168:171], v[44:47]
    s_waitcnt lgkmcnt(8)
    v_mfma_f32_16x16x32_bf16 v[48:51], a[188:191], a[140:143], v[48:51]
    ds_read_b64_tr_b16 a[180:181], v1 offset:64
    v_mfma_f32_16x16x32_bf16 v[48:51], a[192:195], a[144:147], v[48:51]
    v_mfma_f32_16x16x32_bf16 v[52:55], a[188:191], a[148:151], v[52:55]
    ds_read_b64_tr_b16 a[182:183], v1 offset:3648
    v_mfma_f32_16x16x32_bf16 v[52:55], a[192:195], a[152:155], v[52:55]
    buffer_load_dwordx4 a[104:107], v15, s[24:27], s40 offen offset:1024 sc1
    s_add_u32 s36, s36, 1
    s_add_u32 s81, s36, s80
    v_mfma_f32_16x16x32_bf16 v[56:59], a[188:191], a[156:159], v[56:59]
    ds_read_b64_tr_b16 a[184:185], v1 offset:7232
    s_and_b32 s81, s81, 15
    v_mfma_f32_16x16x32_bf16 v[56:59], a[192:195], a[160:163], v[56:59]
    s_mul_i32 s38, s81, 458752
    v_mfma_f32_16x16x32_bf16 v[60:63], a[188:191], a[164:167], v[60:63]
    ds_read_b64_tr_b16 a[186:187], v1 offset:10816
    s_mul_i32 s39, s81, 393216
    v_mfma_f32_16x16x32_bf16 v[60:63], a[192:195], a[168:171], v[60:63]
    buffer_load_dwordx4 a[108:111], v15, s[24:27], s40 offen offset:2048 sc1
    s_waitcnt lgkmcnt(8)
    v_mfma_f32_16x16x32_bf16 v[64:67], a[196:199], a[140:143], v[64:67]
    ds_read_b64_tr_b16 a[188:189], v1 offset:14400
    v_mfma_f32_16x16x32_bf16 v[64:67], a[200:203], a[144:147], v[64:67]
    v_mfma_f32_16x16x32_bf16 v[68:71], a[196:199], a[148:151], v[68:71]
    ds_read_b64_tr_b16 a[190:191], v1 offset:17984
    v_mfma_f32_16x16x32_bf16 v[68:71], a[200:203], a[152:155], v[68:71]
    v_mfma_f32_16x16x32_bf16 v[72:75], a[196:199], a[156:159], v[72:75]
    ds_read_b64_tr_b16 a[192:193], v1 offset:21568
    v_mfma_f32_16x16x32_bf16 v[72:75], a[200:203], a[160:163], v[72:75]
    buffer_load_dwordx4 a[112:115], v15, s[24:27], s40 offen offset:3072 sc1
    v_mfma_f32_16x16x32_bf16 v[76:79], a[196:199], a[164:167], v[76:79]
    ds_read_b64_tr_b16 a[194:195], v1 offset:25152
    v_mfma_f32_16x16x32_bf16 v[76:79], a[200:203], a[168:171], v[76:79]
    s_waitcnt lgkmcnt(8)
    v_mfma_f32_16x16x32_bf16 v[80:83], a[204:207], a[140:143], v[80:83]
    ds_read_b64_tr_b16 a[196:197], v1 offset:96
    s_add_u32 s37, s37, s62
    v_mfma_f32_16x16x32_bf16 v[80:83], a[208:211], a[144:147], v[80:83]
    s_cmp_eq_u32 s37, 122880
    v_mfma_f32_16x16x32_bf16 v[84:87], a[204:207], a[148:151], v[84:87]
    ds_read_b64_tr_b16 a[198:199], v1 offset:3680
    s_cselect_b32 s37, 0, s37
    v_mfma_f32_16x16x32_bf16 v[84:87], a[208:211], a[152:155], v[84:87]
    buffer_load_dwordx4 a[116:119], v15, s[24:27], s41 offen offset:0 sc1
    v_mfma_f32_16x16x32_bf16 v[88:91], a[204:207], a[156:159], v[88:91]
    ds_read_b64_tr_b16 a[200:201], v1 offset:7264
    v_mfma_f32_16x16x32_bf16 v[88:91], a[208:211], a[160:163], v[88:91]
    v_mfma_f32_16x16x32_bf16 v[92:95], a[204:207], a[164:167], v[92:95]
    ds_read_b64_tr_b16 a[202:203], v1 offset:10848
    v_mfma_f32_16x16x32_bf16 v[92:95], a[208:211], a[168:171], v[92:95]
    s_waitcnt lgkmcnt(8)
    v_mfma_f32_16x16x32_bf16 v[96:99], a[180:183], a[140:143], v[96:99]
    ds_read_b64_tr_b16 a[204:205], v1 offset:14432
    v_mfma_f32_16x16x32_bf16 v[96:99], a[184:187], a[144:147], v[96:99]
    buffer_load_dwordx4 a[120:123], v15, s[24:27], s41 offen offset:1024 sc1
    v_mfma_f32_16x16x32_bf16 v[100:103], a[180:183], a[148:151], v[100:103]
    ds_read_b64_tr_b16 a[206:207], v1 offset:18016
    v_mfma_f32_16x16x32_bf16 v[100:103], a[184:187], a[152:155], v[100:103]
    s_cmp_eq_u32 s37, s62
    v_mfma_f32_16x16x32_bf16 v[104:107], a[180:183], a[156:159], v[104:107]
    ds_read_b64_tr_b16 a[208:209], v1 offset:21600
    s_cselect_b32 s93, s63, s62
    v_mfma_f32_16x16x32_bf16 v[104:107], a[184:187], a[160:163], v[104:107]
    buffer_load_dwordx4 a[124:127], v15, s[24:27], s41 offen offset:2048 sc1
    v_mfma_f32_16x16x32_bf16 v[108:111], a[180:183], a[164:167], v[108:111]
    ds_read_b64_tr_b16 a[210:211], v1 offset:25184
    v_mfma_f32_16x16x32_bf16 v[108:111], a[184:187], a[168:171], v[108:111]
    s_waitcnt lgkmcnt(8)
    v_mfma_f32_16x16x32_bf16 v[112:115], a[188:191], a[140:143], v[112:115]
    ds_read_b64_tr_b16 a[180:181], v1 offset:128
    v_mfma_f32_16x16x32_bf16 v[112:115], a[192:195], a[144:147], v[112:115]
    v_mfma_f32_16x16x32_bf16 v[116:119], a[188:191], a[148:151], v[116:119]
    ds_read_b64_tr_b16 a[182:183], v1 offset:3712
    v_mfma_f32_16x16x32_bf16 v[116:119], a[192:195], a[152:155], v[116:119]
    buffer_load_dwordx4 a[128:131], v15, s[24:27], s41 offen offset:3072 sc1
    v_mfma_f32_16x16x32_bf16 v[120:123], a[188:191], a[156:159], v[120:123]
    ds_read_b64_tr_b16 a[184:185], v1 offset:7296
    v_mfma_f32_16x16x32_bf16 v[120:123], a[192:195], a[160:163], v[120:123]
    v_mfma_f32_16x16x32_bf16 v[124:127], a[188:191], a[164:167], v[124:127]
    ds_read_b64_tr_b16 a[186:187], v1 offset:10880
    v_mfma_f32_16x16x32_bf16 v[124:127], a[192:195], a[168:171], v[124:127]
    s_waitcnt lgkmcnt(8)
    v_mfma_f32_16x16x32_bf16 v[128:131], a[196:199], a[140:143], v[128:131]
    ds_read_b64_tr_b16 a[188:189], v1 offset:14464
    v_mfma_f32_16x16x32_bf16 v[128:131], a[200:203], a[144:147], v[128:131]
    buffer_load_dwordx4 a[132:135], v15, s[24:27], s42 offen offset:0 sc1
    v_mfma_f32_16x16x32_bf16 v[132:135], a[196:199], a[148:151], v[132:135]
    ds_read_b64_tr_b16 a[190:191], v1 offset:18048
    v_mfma_f32_16x16x32_bf16 v[132:135], a[200:203], a[152:155], v[132:135]
    v_mfma_f32_16x16x32_bf16 v[136:139], a[196:199], a[156:159], v[136:139]
    ds_read_b64_tr_b16 a[192:193], v1 offset:21632
    v_mfma_f32_16x16x32_bf16 v[136:139], a[200:203], a[160:163], v[136:139]
    buffer_load_dwordx4 a[136:139], v15, s[24:27], s42 offen offset:1024 sc1
    v_mfma_f32_16x16x32_bf16 v[140:143], a[196:199], a[164:167], v[140:143]
    ds_read_b64_tr_b16 a[194:195], v1 offset:25216
    v_mfma_f32_16x16x32_bf16 v[140:143], a[200:203], a[168:171], v[140:143]
    s_waitcnt lgkmcnt(8)
    v_mfma_f32_16x16x32_bf16 v[144:147], a[204:207], a[140:143], v[144:147]
    ds_read_b64_tr_b16 a[196:197], v1 offset:160
    v_mfma_f32_16x16x32_bf16 v[144:147], a[208:211], a[144:147], v[144:147]
    v_mfma_f32_16x16x32_bf16 v[148:151], a[204:207], a[148:151], v[148:151]
    ds_read_b64_tr_b16 a[198:199], v1 offset:3744
    s_add_u32 m0, s37, s43
    v_mfma_f32_16x16x32_bf16 v[148:151], a[208:211], a[152:155], v[148:151]
    buffer_load_dwordx4 v8, s[8:11], s38 offen offset:0 lds
    v_mfma_f32_16x16x32_bf16 v[152:155], a[204:207], a[156:159], v[152:155]
    ds_read_b64_tr_b16 a[200:201], v1 offset:7328
    v_mfma_f32_16x16x32_bf16 v[152:155], a[208:211], a[160:163], v[152:155]
    v_mfma_f32_16x16x32_bf16 v[156:159], a[204:207], a[164:167], v[156:159]
    ds_read_b64_tr_b16 a[202:203], v1 offset:10912
    v_mfma_f32_16x16x32_bf16 v[156:159], a[208:211], a[168:171], v[156:159]
    s_waitcnt lgkmcnt(8)
    v_mfma_f32_16x16x32_bf16 v[160:163], a[180:183], a[140:143], v[160:163]
    ds_read_b64_tr_b16 a[204:205], v1 offset:14496
    v_mfma_f32_16x16x32_bf16 v[160:163], a[184:187], a[144:147], v[160:163]
    buffer_load_dwordx4 v9, s[8:11], s38 offen offset:1024 lds
    v_mfma_f32_16x16x32_bf16 v[164:167], a[180:183], a[148:151], v[164:167]
    ds_read_b64_tr_b16 a[206:207], v1 offset:18080
    v_mfma_f32_16x16x32_bf16 v[164:167], a[184:187], a[152:155], v[164:167]
    v_mfma_f32_16x16x32_bf16 v[168:171], a[180:183], a[156:159], v[168:171]
    ds_read_b64_tr_b16 a[208:209], v1 offset:21664
    v_mfma_f32_16x16x32_bf16 v[168:171], a[184:187], a[160:163], v[168:171]
    buffer_load_dwordx4 v10, s[8:11], s38 offen offset:2048 lds
    v_mfma_f32_16x16x32_bf16 v[172:175], a[180:183], a[164:167], v[172:175]
    ds_read_b64_tr_b16 a[210:211], v1 offset:25248
    v_mfma_f32_16x16x32_bf16 v[172:175], a[184:187], a[168:171], v[172:175]
    s_waitcnt lgkmcnt(8)
    v_mfma_f32_16x16x32_bf16 v[176:179], a[188:191], a[140:143], v[176:179]
    ds_read_b64_tr_b16 a[180:181], v1 offset:192
    v_mfma_f32_16x16x32_bf16 v[176:179], a[192:195], a[144:147], v[176:179]
    ds_read_b64_tr_b16 a[212:213], v4 offset:0
    v_mfma_f32_16x16x32_bf16 v[180:183], a[188:191], a[148:151], v[180:183]
    ds_read_b64_tr_b16 a[182:183], v1 offset:3776
    v_mfma_f32_16x16x32_bf16 v[180:183], a[192:195], a[152:155], v[180:183]
    ds_read_b64_tr_b16 a[214:215], v4 offset:3072
    v_mfma_f32_16x16x32_bf16 v[184:187], a[188:191], a[156:159], v[184:187]
    ds_read_b64_tr_b16 a[184:185], v1 offset:7360
    v_mfma_f32_16x16x32_bf16 v[184:187], a[192:195], a[160:163], v[184:187]
    ds_read_b64_tr_b16 a[216:217], v4 offset:6144
    v_mfma_f32_16x16x32_bf16 v[188:191], a[188:191], a[164:167], v[188:191]
    ds_read_b64_tr_b16 a[186:187], v1 offset:10944
    v_mfma_f32_16x16x32_bf16 v[188:191], a[192:195], a[168:171], v[188:191]
    ds_read_b64_tr_b16 a[218:219], v4 offset:9216
    s_waitcnt lgkmcnt(12)
    v_mfma_f32_16x16x32_bf16 v[192:195], a[196:199], a[140:143], v[192:195]
    ds_read_b64_tr_b16 a[188:189], v1 offset:14528
    v_mfma_f32_16x16x32_bf16 v[192:195], a[200:203], a[144:147], v[192:195]
    v_mfma_f32_16x16x32_bf16 v[196:199], a[196:199], a[148:151], v[196:199]
    ds_read_b64_tr_b16 a[190:191], v1 offset:18112
    s_add_u32 m0, s37, s44
    v_mfma_f32_16x16x32_bf16 v[196:199], a[200:203], a[152:155], v[196:199]
    buffer_load_dwordx4 v8, s[12:15], s38 offen offset:0 lds
    v_mfma_f32_16x16x32_bf16 v[200:203], a[196:199], a[156:159], v[200:203]
    ds_read_b64_tr_b16 a[192:193], v1 offset:21696
    v_mfma_f32_16x16x32_bf16 v[200:203], a[200:203], a[160:163], v[200:203]
    v_mfma_f32_16x16x32_bf16 v[204:207], a[196:199], a[164:167], v[204:207]
    ds_read_b64_tr_b16 a[194:195], v1 offset:25280
    v_mfma_f32_16x16x32_bf16 v[204:207], a[200:203], a[168:171], v[204:207]
    s_waitcnt lgkmcnt(12)
    v_mfma_f32_16x16x32_bf16 v[208:211], a[204:207], a[140:143], v[208:211]
    ds_read_b64_tr_b16 a[196:197], v2 offset:0
    v_mfma_f32_16x16x32_bf16 v[208:211], a[208:211], a[144:147], v[208:211]
    buffer_load_dwordx4 v9, s[12:15], s38 offen offset:1024 lds
    v_mfma_f32_16x16x32_bf16 v[212:215], a[204:207], a[148:151], v[212:215]
    ds_read_b64_tr_b16 a[198:199], v2 offset:3072
    v_mfma_f32_16x16x32_bf16 v[212:215], a[208:211], a[152:155], v[212:215]
    v_mfma_f32_16x16x32_bf16 v[216:219], a[204:207], a[156:159], v[216:219]
    ds_read_b64_tr_b16 a[200:201], v2 offset:6144
    v_mfma_f32_16x16x32_bf16 v[216:219], a[208:211], a[160:163], v[216:219]
    v_mfma_f32_16x16x32_bf16 v[220:223], a[204:207], a[164:167], v[220:223]
    ds_read_b64_tr_b16 a[202:203], v2 offset:9216
    v_mfma_f32_16x16x32_bf16 v[220:223], a[208:211], a[168:171], v[220:223]
    buffer_load_dwordx4 v10, s[12:15], s38 offen offset:2048 lds
    s_waitcnt lgkmcnt(9)
    v_mfma_f32_16x16x32_bf16 v[224:227], a[180:183], a[140:143], v[224:227]
    ds_read_b64_tr_b16 a[204:205], v3 offset:0
    v_mfma_f32_16x16x32_bf16 v[224:227], a[184:187], a[144:147], v[224:227]
    v_mfma_f32_16x16x32_bf16 v[228:231], a[180:183], a[148:151], v[228:231]
    ds_read_b64_tr_b16 a[206:207], v3 offset:3072
    s_add_u32 m0, s37, s45
    v_mfma_f32_16x16x32_bf16 v[228:231], a[184:187], a[152:155], v[228:231]
    buffer_load_dwordx4 v11, s[16:19], s39 offen offset:0 lds
    v_mfma_f32_16x16x32_bf16 v[232:235], a[180:183], a[156:159], v[232:235]
    ds_read_b64_tr_b16 a[208:209], v3 offset:6144
    v_mfma_f32_16x16x32_bf16 v[232:235], a[184:187], a[160:163], v[232:235]
    v_mfma_f32_16x16x32_bf16 v[236:239], a[180:183], a[164:167], v[236:239]
    ds_read_b64_tr_b16 a[210:211], v3 offset:9216
    v_mfma_f32_16x16x32_bf16 v[236:239], a[184:187], a[168:171], v[236:239]
    s_waitcnt lgkmcnt(8)
    v_mfma_f32_16x16x32_bf16 v[240:243], a[188:191], a[140:143], v[240:243]
    ds_read_b64_tr_b16 a[180:181], v2 offset:64
    v_mfma_f32_16x16x32_bf16 v[240:243], a[192:195], a[144:147], v[240:243]
    buffer_load_dwordx4 v12, s[16:19], s39 offen offset:1024 lds
    v_mfma_f32_16x16x32_bf16 v[244:247], a[188:191], a[148:151], v[244:247]
    ds_read_b64_tr_b16 a[182:183], v2 offset:3136
    v_mfma_f32_16x16x32_bf16 v[244:247], a[192:195], a[152:155], v[244:247]
    v_mfma_f32_16x16x32_bf16 v[248:251], a[188:191], a[156:159], v[248:251]
    ds_read_b64_tr_b16 a[184:185], v2 offset:6208
    v_mfma_f32_16x16x32_bf16 v[248:251], a[192:195], a[160:163], v[248:251]
    v_mfma_f32_16x16x32_bf16 v[252:255], a[188:191], a[164:167], v[252:255]
    ds_read_b64_tr_b16 a[186:187], v2 offset:9280
    v_mfma_f32_16x16x32_bf16 v[252:255], a[192:195], a[168:171], v[252:255]
    buffer_load_dwordx4 v13, s[16:19], s39 offen offset:2048 lds
    v_mfma_f32_16x16x32_bf16 a[96:99], a[212:215], a[172:175], a[96:99]
    v_mfma_f32_16x16x32_bf16 a[96:99], a[216:219], a[176:179], a[96:99]
    s_waitcnt lgkmcnt(8)
    v_mfma_f32_16x16x32_bf16 a[0:3], a[196:199], a[140:143], a[0:3]
    ds_read_b64_tr_b16 a[188:189], v3 offset:64
    v_mfma_f32_16x16x32_bf16 a[0:3], a[200:203], a[144:147], a[0:3]
    v_mfma_f32_16x16x32_bf16 a[4:7], a[196:199], a[148:151], a[4:7]
    ds_read_b64_tr_b16 a[190:191], v3 offset:3136
    s_add_u32 m0, s37, s46
    v_mfma_f32_16x16x32_bf16 a[4:7], a[200:203], a[152:155], a[4:7]
    buffer_load_dwordx4 v14, s[20:23], s38 offen lds
    v_mfma_f32_16x16x32_bf16 a[8:11], a[196:199], a[156:159], a[8:11]
    ds_read_b64_tr_b16 a[192:193], v3 offset:6208
    v_mfma_f32_16x16x32_bf16 a[8:11], a[200:203], a[160:163], a[8:11]
    v_mfma_f32_16x16x32_bf16 a[12:15], a[196:199], a[164:167], a[12:15]
    ds_read_b64_tr_b16 a[194:195], v3 offset:9280
    v_mfma_f32_16x16x32_bf16 a[12:15], a[200:203], a[168:171], a[12:15]
    s_waitcnt lgkmcnt(8)
    v_mfma_f32_16x16x32_bf16 a[16:19], a[204:207], a[140:143], a[16:19]
    ds_read_b64_tr_b16 a[196:197], v2 offset:128
    v_mfma_f32_16x16x32_bf16 a[16:19], a[208:211], a[144:147], a[16:19]
    buffer_load_dword v29, v28, s[88:91], s94 offen
    v_mfma_f32_16x16x32_bf16 a[20:23], a[204:207], a[148:151], a[20:23]
    ds_read_b64_tr_b16 a[198:199], v2 offset:3200
    s_add_u32 s94, s94, s95
    v_mfma_f32_16x16x32_bf16 a[20:23], a[208:211], a[152:155], a[20:23]
    s_cmp_ge_u32 s94, s49
    v_mfma_f32_16x16x32_bf16 a[24:27], a[204:207], a[156:159], a[24:27]
    ds_read_b64_tr_b16 a[200:201], v2 offset:6272
    s_cselect_b32 s3, s90, 0
    v_mfma_f32_16x16x32_bf16 a[24:27], a[208:211], a[160:163], a[24:27]
    s_sub_u32 s94, s94, s3
    v_mfma_f32_16x16x32_bf16 a[28:31], a[204:207], a[164:167], a[28:31]
    ds_read_b64_tr_b16 a[202:203], v2 offset:9344
    s_cmp_eq_u32 s36, s47
    v_mfma_f32_16x16x32_bf16 a[28:31], a[208:211], a[168:171], a[28:31]
    s_cselect_b64 s[88:89], s[4:5], s[88:89]
    s_waitcnt lgkmcnt(8)
    v_mfma_f32_16x16x32_bf16 a[32:35], a[180:183], a[140:143], a[32:35]
    ds_read_b64_tr_b16 a[204:205], v3 offset:128
    s_cselect_b32 s90, s6, s90
    v_mfma_f32_16x16x32_bf16 a[32:35], a[184:187], a[144:147], a[32:35]
    s_cselect_b32 s94, s7, s94
    v_mfma_f32_16x16x32_bf16 a[36:39], a[180:183], a[148:151], a[36:39]
    ds_read_b64_tr_b16 a[206:207], v3 offset:3200
    s_cselect_b64 vcc, -1, 0
    v_mfma_f32_16x16x32_bf16 a[36:39], a[184:187], a[152:155], a[36:39]
    v_cndmask_b32 v27, v27, v24, vcc
    v_mfma_f32_16x16x32_bf16 a[40:43], a[180:183], a[156:159], a[40:43]
    ds_read_b64_tr_b16 a[208:209], v3 offset:6272
    v_cndmask_b32 v28, v28, v25, vcc
    v_mfma_f32_16x16x32_bf16 a[40:43], a[184:187], a[160:163], a[40:43]
    v_mfma_f32_16x16x32_bf16 a[44:47], a[180:183], a[164:167], a[44:47]
    ds_read_b64_tr_b16 a[210:211], v3 offset:9344
    v_mfma_f32_16x16x32_bf16 a[44:47], a[184:187], a[168:171], a[44:47]
    s_waitcnt lgkmcnt(8)
    v_mfma_f32_16x16x32_bf16 a[48:51], a[188:191], a[140:143], a[48:51]
    v_mfma_f32_16x16x32_bf16 a[48:51], a[192:195], a[144:147], a[48:51]
    v_add_u32 v1, s93, v1
    v_mfma_f32_16x16x32_bf16 a[52:55], a[188:191], a[148:151], a[52:55]
    v_add_u32 v2, s93, v2
    v_mfma_f32_16x16x32_bf16 a[52:55], a[192:195], a[152:155], a[52:55]
    v_add_u32 v3, s93, v3
    v_mfma_f32_16x16x32_bf16 a[56:59], a[188:191], a[156:159], a[56:59]
    v_add_u32 v4, s93, v4
    v_mfma_f32_16x16x32_bf16 a[56:59], a[192:195], a[160:163], a[56:59]
    v_mfma_f32_16x16x32_bf16 a[60:63], a[188:191], a[164:167], a[60:63]
    v_mfma_f32_16x16x32_bf16 a[60:63], a[192:195], a[168:171], a[60:63]
    s_waitcnt vmcnt(11) lgkmcnt(0)
    s_barrier
    v_mfma_f32_16x16x32_bf16 a[64:67], a[140:143], a[196:199], a[64:67]
    ds_read_b64_tr_b16 a[180:181], v1 offset:0
    v_mfma_f32_16x16x32_bf16 a[64:67], a[144:147], a[200:203], a[64:67]
    ds_read_b64_tr_b16 a[182:183], v1 offset:3584
    v_mfma_f32_16x16x32_bf16 a[68:71], a[148:151], a[196:199], a[68:71]
    ds_read_b64_tr_b16 a[184:185], v1 offset:7168
    v_mfma_f32_16x16x32_bf16 a[68:71], a[152:155], a[200:203], a[68:71]
    ds_read_b64_tr_b16 a[186:187], v1 offset:10752
    v_mfma_f32_16x16x32_bf16 a[72:75], a[156:159], a[196:199], a[72:75]
    ds_read_b64_tr_b16 a[188:189], v1 offset:14336
    v_mfma_f32_16x16x32_bf16 a[72:75], a[160:163], a[200:203], a[72:75]
    ds_read_b64_tr_b16 a[190:191], v1 offset:17920
    v_mfma_f32_16x16x32_bf16 a[76:79], a[164:167], a[196:199], a[76:79]
    ds_read_b64_tr_b16 a[192:193], v1 offset:21504
    v_mfma_f32_16x16x32_bf16 a[76:79], a[168:171], a[200:203], a[76:79]
    ds_read_b64_tr_b16 a[194:195], v1 offset:25088
    v_mfma_f32_16x16x32_bf16 a[80:83], a[140:143], a[204:207], a[80:83]
    ds_read_b64_tr_b16 a[196:197], v1 offset:32
    v_mfma_f32_16x16x32_bf16 a[80:83], a[144:147], a[208:211], a[80:83]
    v_mfma_f32_16x16x32_bf16 a[84:87], a[148:151], a[204:207], a[84:87]
    ds_read_b64_tr_b16 a[198:199], v1 offset:3616
    v_mfma_f32_16x16x32_bf16 a[84:87], a[152:155], a[208:211], a[84:87]
    v_mfma_f32_16x16x32_bf16 a[88:91], a[156:159], a[204:207], a[88:91]
    ds_read_b64_tr_b16 a[200:201], v1 offset:7200
    v_mfma_f32_16x16x32_bf16 a[88:91], a[160:163], a[208:211], a[88:91]
    s_cmp_lt_u32 s36, 15
    v_mfma_f32_16x16x32_bf16 a[92:95], a[164:167], a[204:207], a[92:95]
    ds_read_b64_tr_b16 a[202:203], v1 offset:10784
    v_mfma_f32_16x16x32_bf16 a[92:95], a[168:171], a[208:211], a[92:95]
    s_cbranch_scc1 L_g1
    s_waitcnt lgkmcnt(8)
    v_mfma_f32_16x16x32_bf16 v[32:35], a[180:183], a[100:103], v[32:35]
    ds_read_b64_tr_b16 a[204:205], v1 offset:14368
    v_add_u32 v8, s63, v1
    v_mfma_f32_16x16x32_bf16 v[32:35], a[184:187], a[104:107], v[32:35]
    v_add_u32 v9, s63, v2
    v_add_u32 v10, s63, v3
    v_mfma_f32_16x16x32_bf16 v[36:39], a[180:183], a[108:111], v[36:39]
    ds_read_b64_tr_b16 a[206:207], v1 offset:17952
    v_add_u32 v11, s63, v4
    v_mfma_f32_16x16x32_bf16 v[36:39], a[184:187], a[112:115], v[36:39]
    s_getpc_b64 s[16:17]
L_pc2:
    s_mov_b32 s18, L_end-L_pc2
    s_bfe_u32 s3, s2, 0x30003
    v_mfma_f32_16x16x32_bf16 v[40:43], a[180:183], a[116:119], v[40:43]
    ds_read_b64_tr_b16 a[208:209], v1 offset:21536
    s_lshl2_add_u32 s3, s3, s32
    v_mfma_f32_16x16x32_bf16 v[40:43], a[184:187], a[120:123], v[40:43]
    s_lshl_b32 s3, s3, 11
    v_and_b32 v20, 0xf0, v15
    v_lshl_add_u32 v20, v20, 3, s3
    v_mfma_f32_16x16x32_bf16 v[44:47], a[180:183], a[124:127], v[44:47]
    ds_read_b64_tr_b16 a[210:211], v1 offset:25120
    buffer_load_dword v29, v20, s[16:19], 0 offen
    v_mfma_f32_16x16x32_bf16 v[44:47], a[184:187], a[128:131], v[44:47]
    s_waitcnt vmcnt(2)
    s_barrier
    s_waitcnt lgkmcnt(8)
    s_lshl_b32 s40, s81, 15
    s_add_u32 s42, s40, s61
    v_mfma_f32_16x16x32_bf16 v[48:51], a[188:191], a[100:103], v[48:51]
    ds_read_b64_tr_b16 a[180:181], v8 offset:0
    buffer_load_dwordx4 a[172:175], v15, s[24:27], s42 offen offset:0 sc1
    v_mfma_f32_16x16x32_bf16 v[48:51], a[192:195], a[104:107], v[48:51]
    buffer_load_dwordx4 a[176:179], v15, s[24:27], s42 offen offset:1024 sc1
    v_lshrrev_b32 v13, 4, v15
    v_mfma_f32_16x16x32_bf16 v[52:55], a[188:191], a[108:111], v[52:55]
    ds_read_b64_tr_b16 a[182:183], v8 offset:3584
    v_and_b32 v14, 15, v13
    v_mfma_f32_16x16x32_bf16 v[52:55], a[192:195], a[112:115], v[52:55]
    v_and_b32 v27, 1, v13
    v_lshrrev_b32 v20, 4, v13
    v_mfma_f32_16x16x32_bf16 v[56:59], a[188:191], a[116:119], v[56:59]
    ds_read_b64_tr_b16 a[184:185], v8 offset:7168
    v_lshl_add_u32 v20, v20, 2, v27
    v_mfma_f32_16x16x32_bf16 v[56:59], a[192:195], a[120:123], v[56:59]
    v_cmp_le_u32 s[40:41], v20, v14
    v_add_u32 v20, 2, v20
    v_mfma_f32_16x16x32_bf16 v[60:63], a[188:191], a[124:127], v[60:63]
    ds_read_b64_tr_b16 a[186:187], v8 offset:10752
    v_cmp_le_u32 s[42:43], v20, v14
    v_mfma_f32_16x16x32_bf16 v[60:63], a[192:195], a[128:131], v[60:63]
    s_waitcnt lgkmcnt(8)
    v_cmp_ne_u32 s[62:63], 0, v27
    v_lshlrev_b32 v27, 4, v27
    v_mfma_f32_16x16x32_bf16 v[64:67], a[196:199], a[100:103], v[64:67]
    ds_read_b64_tr_b16 a[188:189], v8 offset:14336
    s_cmp_eq_u32 s33, 0
    v_mfma_f32_16x16x32_bf16 v[64:67], a[200:203], a[104:107], v[64:67]
    s_cselect_b64 s[88:89], -1, 0
    s_andn2_b64 s[90:91], s[88:89], s[42:43]
    s_andn2_b64 s[88:89], s[88:89], s[40:41]
    v_mfma_f32_16x16x32_bf16 v[68:71], a[196:199], a[108:111], v[68:71]
    ds_read_b64_tr_b16 a[190:191], v8 offset:17920
    s_mov_b32 s48, 0x3e3504f3
    v_mfma_f32_16x16x32_bf16 v[68:71], a[200:203], a[112:115], v[68:71]
    s_mov_b32 s49, 0x3fb8aa3b
    s_lshl_b32 s3, s32, 11
    s_add_u32 s3, s3, 155648
    v_mfma_f32_16x16x32_bf16 v[72:75], a[196:199], a[116:119], v[72:75]
    ds_read_b64_tr_b16 a[192:193], v8 offset:21504
    v_add_u32 v25, s3, v15
    v_mfma_f32_16x16x32_bf16 v[72:75], a[200:203], a[120:123], v[72:75]
    v_accvgpr_read_b32 v24, a223
    v_lshlrev_b32 v14, 7, v14
    v_mfma_f32_16x16x32_bf16 v[76:79], a[196:199], a[124:127], v[76:79]
    ds_read_b64_tr_b16 a[194:195], v8 offset:25088
    v_and_b32 v13, 31, v13
    v_mfma_f32_16x16x32_bf16 v[76:79], a[200:203], a[128:131], v[76:79]
    s_waitcnt lgkmcnt(8)
    v_lshlrev_b32 v13, 2, v13
    s_and_b32 s3, s2, 7
    v_mfma_f32_16x16x32_bf16 v[80:83], a[204:207], a[100:103], v[80:83]
    ds_read_b64_tr_b16 a[196:197], v8 offset:32
    s_xor_b32 s61, s3, 1
    v_mfma_f32_16x16x32_bf16 v[80:83], a[208:211], a[104:107], v[80:83]
    ds_read_b64_tr_b16 a[212:213], v4 offset:0
    s_xor_b32 s3, s61, 1
    v_mfma_f32_16x16x32_bf16 v[84:87], a[204:207], a[108:111], v[84:87]
    ds_read_b64_tr_b16 a[198:199], v8 offset:3616
    s_mul_i32 s44, s61, 917504
    v_mfma_f32_16x16x32_bf16 v[84:87], a[208:211], a[112:115], v[84:87]
    ds_read_b64_tr_b16 a[214:215], v4 offset:3072
    s_mul_i32 s45, s3, 917504
    v_mfma_f32_16x16x32_bf16 v[88:91], a[204:207], a[116:119], v[88:91]
    ds_read_b64_tr_b16 a[200:201], v8 offset:7200
    s_mul_i32 s46, s61, 114688
    v_mfma_f32_16x16x32_bf16 v[88:91], a[208:211], a[120:123], v[88:91]
    ds_read_b64_tr_b16 a[216:217], v4 offset:6144
    s_add_u32 s46, s46, s57
    v_mfma_f32_16x16x32_bf16 v[92:95], a[204:207], a[124:127], v[92:95]
    ds_read_b64_tr_b16 a[202:203], v8 offset:10784
    s_mul_i32 s47, s3, 114688
    v_mfma_f32_16x16x32_bf16 v[92:95], a[208:211], a[128:131], v[92:95]
    ds_read_b64_tr_b16 a[218:219], v4 offset:9216
    s_waitcnt lgkmcnt(12)
    v_mfma_f32_16x16x32_bf16 v[32:35], a[180:183], a[224:227], v[32:35]
    ds_read_b64_tr_b16 a[204:205], v8 offset:14368
    s_add_u32 s47, s47, s57
    v_mfma_f32_16x16x32_bf16 v[32:35], a[184:187], a[228:231], v[32:35]
    s_mov_b32 s60, s46
    s_lshl_b32 s61, s61, 9
    s_add_u32 s34, s61, s58
    v_mfma_f32_16x16x32_bf16 v[36:39], a[180:183], a[232:235], v[36:39]
    ds_read_b64_tr_b16 a[206:207], v8 offset:17952
    s_lshl_b32 s3, s3, 9
    v_mfma_f32_16x16x32_bf16 v[36:39], a[184:187], a[236:239], v[36:39]
    s_add_u32 s58, s58, s3
    v_and_b32 v5, 384, v14
    s_and_b32 s95, s2, 4
    v_mfma_f32_16x16x32_bf16 v[40:43], a[180:183], a[240:243], v[40:43]
    ds_read_b64_tr_b16 a[208:209], v8 offset:21536
    s_lshl_b32 s95, s95, 9
    v_mfma_f32_16x16x32_bf16 v[40:43], a[184:187], a[244:247], v[40:43]
    s_add_u32 s3, s67, s70
    s_mov_b32 s4, 0x6453201
    s_mov_b32 s5, 0x6542310
    v_mfma_f32_16x16x32_bf16 v[44:47], a[180:183], a[248:251], v[44:47]
    ds_read_b64_tr_b16 a[210:211], v8 offset:25120
    s_bitcmp1_b32 s3, 0
    v_mfma_f32_16x16x32_bf16 v[44:47], a[184:187], a[252:255], v[44:47]
    s_waitcnt lgkmcnt(12)
    s_cselect_b32 s4, 0x5643120, s4
    s_cselect_b32 s5, 0x6534210, s5
    v_mfma_f32_16x16x32_bf16 v[48:51], a[188:191], a[224:227], v[48:51]
    ds_read_b64_tr_b16 a[180:181], v1 offset:64
    s_bitcmp1_b32 s3, 1
    v_mfma_f32_16x16x32_bf16 v[48:51], a[192:195], a[228:231], v[48:51]
    s_cselect_b32 s3, s5, s4
    s_bfe_u32 s4, s3, 0x40000
    s_lshl_b32 s4, s4, 14
    v_mfma_f32_16x16x32_bf16 v[52:55], a[188:191], a[232:235], v[52:55]
    ds_read_b64_tr_b16 a[182:183], v1 offset:3648
    s_bfe_u32 s5, s3, 0x40004
    v_mfma_f32_16x16x32_bf16 v[52:55], a[192:195], a[236:239], v[52:55]
    s_lshl_b32 s5, s5, 14
    s_bfe_u32 s6, s3, 0x40008
    s_lshl_b32 s6, s6, 14
    v_mfma_f32_16x16x32_bf16 v[56:59], a[188:191], a[240:243], v[56:59]
    ds_read_b64_tr_b16 a[184:185], v1 offset:7232
    s_bfe_u32 s7, s3, 0x4000c
    v_mfma_f32_16x16x32_bf16 v[56:59], a[192:195], a[244:247], v[56:59]
    s_lshl_b32 s7, s7, 14
    s_bfe_u32 s36, s3, 0x40010
    s_lshl_b32 s36, s36, 14
    v_mfma_f32_16x16x32_bf16 v[60:63], a[188:191], a[248:251], v[60:63]
    ds_read_b64_tr_b16 a[186:187], v1 offset:10816
    s_bfe_u32 s37, s3, 0x40014
    v_mfma_f32_16x16x32_bf16 v[60:63], a[192:195], a[252:255], v[60:63]
    s_waitcnt lgkmcnt(9)
    s_lshl_b32 s37, s37, 14
    s_bfe_u32 s55, s3, 0x40018
    v_mfma_f32_16x16x32_bf16 v[64:67], a[196:199], a[224:227], v[64:67]
    ds_read_b64_tr_b16 a[188:189], v8 offset:64
    s_lshl_b32 s55, s55, 14
    v_mfma_f32_16x16x32_bf16 v[64:67], a[200:203], a[228:231], v[64:67]
    s_add_u32 s3, s67, s70
    s_mov_b32 s80, 0x76453201
    s_mov_b32 s81, 0x67542310
    v_mfma_f32_16x16x32_bf16 v[68:71], a[196:199], a[232:235], v[68:71]
    ds_read_b64_tr_b16 a[190:191], v8 offset:3648
    s_bitcmp1_b32 s3, 0
    v_mfma_f32_16x16x32_bf16 v[68:71], a[200:203], a[236:239], v[68:71]
    s_cselect_b32 s80, 0x75643120, s80
    s_cselect_b32 s81, 0x76534210, s81
    s_bitcmp1_b32 s3, 1
    v_mfma_f32_16x16x32_bf16 v[72:75], a[196:199], a[240:243], v[72:75]
    ds_read_b64_tr_b16 a[192:193], v8 offset:7232
    s_cselect_b32 s80, s81, s80
    v_mfma_f32_16x16x32_bf16 v[72:75], a[200:203], a[244:247], v[72:75]
    s_add_u32 s81, s57, 917504
    v_mfma_f32_16x16x32_bf16 v[76:79], a[196:199], a[248:251], v[76:79]
    ds_read_b64_tr_b16 a[194:195], v8 offset:10816
    v_pk_mul_f32 v[48:49], v[32:33], v[48:49]
    v_pk_mul_f32 v[50:51], v[34:35], v[50:51]
    v_pk_mul_f32 v[52:53], v[36:37], v[52:53]
    v_pk_mul_f32 v[54:55], v[38:39], v[54:55]
    v_pk_mul_f32 v[56:57], v[40:41], v[56:57]
    v_pk_mul_f32 v[58:59], v[42:43], v[58:59]
    v_pk_mul_f32 v[60:61], v[44:45], v[60:61]
    v_pk_mul_f32 v[62:63], v[46:47], v[62:63]
    v_pk_mul_f32 v[32:33], v[32:33], s[50:51]
    v_pk_mul_f32 v[34:35], v[34:35], s[50:51]
    v_pk_mul_f32 v[36:37], v[36:37], s[50:51]
    v_pk_mul_f32 v[38:39], v[38:39], s[50:51]
    v_pk_mul_f32 v[40:41], v[40:41], s[50:51]
    v_pk_mul_f32 v[42:43], v[42:43], s[50:51]
    v_pk_mul_f32 v[44:45], v[44:45], s[50:51]
    v_pk_mul_f32 v[46:47], v[46:47], s[50:51]
    v_mfma_f32_16x16x32_bf16 v[76:79], a[200:203], a[252:255], v[76:79]
    s_waitcnt lgkmcnt(8)
    s_mov_b64 s[8:9], s[76:77]
    v_exp_f32 v32, v32
    v_mfma_f32_16x16x32_bf16 v[80:83], a[204:207], a[224:227], v[80:83]
    ds_read_b64_tr_b16 a[196:197], v1 offset:14400
    v_exp_f32 v33, v33
    v_mfma_f32_16x16x32_bf16 v[80:83], a[208:211], a[228:231], v[80:83]
    s_mov_b32 s10, 7340032
    v_exp_f32 v34, v34
    v_exp_f32 v35, v35
    v_mfma_f32_16x16x32_bf16 v[84:87], a[204:207], a[232:235], v[84:87]
    ds_read_b64_tr_b16 a[198:199], v1 offset:17984
    v_exp_f32 v36, v36
    v_mfma_f32_16x16x32_bf16 v[84:87], a[208:211], a[236:239], v[84:87]
    s_lshl3_add_u32 s38, s4, s44
    v_exp_f32 v37, v37
    v_exp_f32 v38, v38
    v_mfma_f32_16x16x32_bf16 v[88:91], a[204:207], a[240:243], v[88:91]
    ds_read_b64_tr_b16 a[200:201], v1 offset:21568
    v_exp_f32 v39, v39
    v_mfma_f32_16x16x32_bf16 v[88:91], a[208:211], a[244:247], v[88:91]
    s_add_u32 m0, s56, 0
    v_exp_f32 v40, v40
    v_exp_f32 v41, v41
    v_mfma_f32_16x16x32_bf16 v[92:95], a[204:207], a[248:251], v[92:95]
    ds_read_b64_tr_b16 a[202:203], v1 offset:25152
    v_exp_f32 v42, v42
    v_mfma_f32_16x16x32_bf16 v[92:95], a[208:211], a[252:255], v[92:95]
    buffer_load_dwordx4 v16, s[8:11], s38 offen offset:0 lds
    v_exp_f32 v43, v43
    v_mfma_f32_16x16x32_bf16 a[96:99], a[212:215], a[132:135], a[96:99]
    v_exp_f32 v44, v44
    v_exp_f32 v45, v45
    v_mfma_f32_16x16x32_bf16 a[96:99], a[216:219], a[136:139], a[96:99]
    s_waitcnt lgkmcnt(8)
    v_exp_f32 v46, v46
    v_exp_f32 v47, v47
    v_pk_add_f32 v[32:33], v[32:33], s[52:53]
    v_pk_add_f32 v[34:35], v[34:35], s[52:53]
    v_pk_add_f32 v[36:37], v[36:37], s[52:53]
    v_pk_add_f32 v[38:39], v[38:39], s[52:53]
    v_pk_add_f32 v[40:41], v[40:41], s[52:53]
    v_pk_add_f32 v[42:43], v[42:43], s[52:53]
    v_pk_add_f32 v[44:45], v[44:45], s[52:53]
    v_pk_add_f32 v[46:47], v[46:47], s[52:53]
    v_mfma_f32_16x16x32_bf16 v[96:99], a[180:183], a[100:103], v[96:99]
    ds_read_b64_tr_b16 a[204:205], v8 offset:14400
    v_rcp_f32 v32, v32
    v_mfma_f32_16x16x32_bf16 v[96:99], a[184:187], a[104:107], v[96:99]
    v_rcp_f32 v33, v33
    v_rcp_f32 v34, v34
    v_mfma_f32_16x16x32_bf16 v[100:103], a[180:183], a[108:111], v[100:103]
    ds_read_b64_tr_b16 a[206:207], v8 offset:17984
    v_rcp_f32 v35, v35
    v_mfma_f32_16x16x32_bf16 v[100:103], a[184:187], a[112:115], v[100:103]
    v_rcp_f32 v36, v36
    v_rcp_f32 v37, v37
    v_mfma_f32_16x16x32_bf16 v[104:107], a[180:183], a[116:119], v[104:107]
    ds_read_b64_tr_b16 a[208:209], v8 offset:21568
    v_rcp_f32 v38, v38
    v_mfma_f32_16x16x32_bf16 v[104:107], a[184:187], a[120:123], v[104:107]
    buffer_load_dwordx4 v17, s[8:11], s38 offen offset:1024 lds
    v_rcp_f32 v39, v39
    v_mfma_f32_16x16x32_bf16 v[108:111], a[180:183], a[124:127], v[108:111]
    ds_read_b64_tr_b16 a[210:211], v8 offset:25152
    v_rcp_f32 v40, v40
    v_mfma_f32_16x16x32_bf16 v[108:111], a[184:187], a[128:131], v[108:111]
    s_waitcnt lgkmcnt(8)
    v_rcp_f32 v41, v41
    v_rcp_f32 v42, v42
    v_mfma_f32_16x16x32_bf16 v[96:99], a[188:191], a[224:227], v[96:99]
    ds_read_b64_tr_b16 a[180:181], v1 offset:96
    v_rcp_f32 v43, v43
    v_mfma_f32_16x16x32_bf16 v[96:99], a[192:195], a[228:231], v[96:99]
    v_rcp_f32 v44, v44
    v_rcp_f32 v45, v45
    v_mfma_f32_16x16x32_bf16 v[100:103], a[188:191], a[232:235], v[100:103]
    ds_read_b64_tr_b16 a[182:183], v1 offset:3680
    v_rcp_f32 v46, v46
    v_rcp_f32 v47, v47
    v_pk_mul_f32 v[48:49], v[48:49], v[32:33]
    v_pk_mul_f32 v[50:51], v[50:51], v[34:35]
    v_pk_mul_f32 v[52:53], v[52:53], v[36:37]
    v_pk_mul_f32 v[54:55], v[54:55], v[38:39]
    v_pk_mul_f32 v[56:57], v[56:57], v[40:41]
    v_pk_mul_f32 v[58:59], v[58:59], v[42:43]
    v_pk_mul_f32 v[60:61], v[60:61], v[44:45]
    v_pk_mul_f32 v[62:63], v[62:63], v[46:47]
    v_pk_mul_f32 v[80:81], v[64:65], v[80:81]
    v_pk_mul_f32 v[82:83], v[66:67], v[82:83]
    v_pk_mul_f32 v[84:85], v[68:69], v[84:85]
    v_pk_mul_f32 v[86:87], v[70:71], v[86:87]
    v_pk_mul_f32 v[88:89], v[72:73], v[88:89]
    v_pk_mul_f32 v[90:91], v[74:75], v[90:91]
    v_pk_mul_f32 v[92:93], v[76:77], v[92:93]
    v_pk_mul_f32 v[94:95], v[78:79], v[94:95]
    v_pk_mul_f32 v[64:65], v[64:65], s[50:51]
    v_pk_mul_f32 v[66:67], v[66:67], s[50:51]
    v_pk_mul_f32 v[68:69], v[68:69], s[50:51]
    v_pk_mul_f32 v[70:71], v[70:71], s[50:51]
    v_pk_mul_f32 v[72:73], v[72:73], s[50:51]
    v_pk_mul_f32 v[74:75], v[74:75], s[50:51]
    v_pk_mul_f32 v[76:77], v[76:77], s[50:51]
    v_pk_mul_f32 v[78:79], v[78:79], s[50:51]
    v_mfma_f32_16x16x32_bf16 v[100:103], a[192:195], a[236:239], v[100:103]
    buffer_load_dwordx4 v18, s[8:11], s38 offen offset:2048 lds
    v_cvt_pk_bf16_f32 v32, v48, v49
    v_exp_f32 v64, v64
    v_mfma_f32_16x16x32_bf16 v[104:107], a[188:191], a[240:243], v[104:107]
    ds_read_b64_tr_b16 a[184:185], v1 offset:7264
    v_cvt_pk_bf16_f32 v33, v50, v51
    v_exp_f32 v65, v65
    v_mfma_f32_16x16x32_bf16 v[104:107], a[192:195], a[244:247], v[104:107]
    v_cvt_pk_bf16_f32 v34, v52, v53
    v_exp_f32 v66, v66
    v_mfma_f32_16x16x32_bf16 v[108:111], a[188:191], a[248:251], v[108:111]
    ds_read_b64_tr_b16 a[186:187], v1 offset:10848
    v_cvt_pk_bf16_f32 v35, v54, v55
    v_exp_f32 v67, v67
    v_mfma_f32_16x16x32_bf16 v[108:111], a[192:195], a[252:255], v[108:111]
    s_waitcnt lgkmcnt(8)
    v_cvt_pk_bf16_f32 v40, v56, v57
    v_exp_f32 v68, v68
    v_mfma_f32_16x16x32_bf16 v[112:115], a[196:199], a[100:103], v[112:115]
    ds_read_b64_tr_b16 a[188:189], v8 offset:96
    v_cvt_pk_bf16_f32 v41, v58, v59
    v_exp_f32 v69, v69
    v_mfma_f32_16x16x32_bf16 v[112:115], a[200:203], a[104:107], v[112:115]
    buffer_load_dwordx4 v19, s[8:11], s38 offen offset:3072 lds
    v_cvt_pk_bf16_f32 v42, v60, v61
    v_exp_f32 v70, v70
    v_mfma_f32_16x16x32_bf16 v[116:119], a[196:199], a[108:111], v[116:119]
    ds_read_b64_tr_b16 a[190:191], v8 offset:3680
    v_cvt_pk_bf16_f32 v43, v62, v63
    v_exp_f32 v71, v71
    v_mfma_f32_16x16x32_bf16 v[116:119], a[200:203], a[112:115], v[116:119]
    s_lshl3_add_u32 s38, s5, s44
    v_permlane16_swap_b32 v32, v34
    v_exp_f32 v72, v72
    v_mfma_f32_16x16x32_bf16 v[120:123], a[196:199], a[116:119], v[120:123]
    ds_read_b64_tr_b16 a[192:193], v8 offset:7264
    v_permlane16_swap_b32 v33, v35
    v_mfma_f32_16x16x32_bf16 v[120:123], a[200:203], a[120:123], v[120:123]
    s_add_u32 m0, s56, 16384
    v_exp_f32 v73, v73
    v_exp_f32 v74, v74
    v_mfma_f32_16x16x32_bf16 v[124:127], a[196:199], a[124:127], v[124:127]
    ds_read_b64_tr_b16 a[194:195], v8 offset:10848
    v_permlane16_swap_b32 v40, v42
    v_mfma_f32_16x16x32_bf16 v[124:127], a[200:203], a[128:131], v[124:127]
    s_waitcnt lgkmcnt(8)
    v_exp_f32 v75, v75
    v_permlane16_swap_b32 v41, v43
    v_mfma_f32_16x16x32_bf16 v[112:115], a[204:207], a[224:227], v[112:115]
    ds_read_b64_tr_b16 a[196:197], v1 offset:14432
    v_exp_f32 v76, v76
    v_mfma_f32_16x16x32_bf16 v[112:115], a[208:211], a[228:231], v[112:115]
    buffer_store_dwordx4 v[32:35], v26, s[28:31], s73 offen offset:0 sc1
    v_exp_f32 v77, v77
    v_mfma_f32_16x16x32_bf16 v[116:119], a[204:207], a[232:235], v[116:119]
    ds_read_b64_tr_b16 a[198:199], v1 offset:18016
    v_exp_f32 v78, v78
    v_exp_f32 v79, v79
    v_pk_add_f32 v[64:65], v[64:65], s[52:53]
    v_pk_add_f32 v[66:67], v[66:67], s[52:53]
    v_pk_add_f32 v[68:69], v[68:69], s[52:53]
    v_pk_add_f32 v[70:71], v[70:71], s[52:53]
    v_pk_add_f32 v[72:73], v[72:73], s[52:53]
    v_pk_add_f32 v[74:75], v[74:75], s[52:53]
    v_pk_add_f32 v[76:77], v[76:77], s[52:53]
    v_pk_add_f32 v[78:79], v[78:79], s[52:53]
    v_mfma_f32_16x16x32_bf16 v[116:119], a[208:211], a[236:239], v[116:119]
    v_rcp_f32 v64, v64
    v_rcp_f32 v65, v65
    v_mfma_f32_16x16x32_bf16 v[120:123], a[204:207], a[240:243], v[120:123]
    ds_read_b64_tr_b16 a[200:201], v1 offset:21600
    v_rcp_f32 v66, v66
    v_mfma_f32_16x16x32_bf16 v[120:123], a[208:211], a[244:247], v[120:123]
    buffer_store_dwordx4 v[40:43], v26, s[28:31], s73 offen offset:2048 sc1
    v_rcp_f32 v67, v67
    v_mfma_f32_16x16x32_bf16 v[124:127], a[204:207], a[248:251], v[124:127]
    ds_read_b64_tr_b16 a[202:203], v1 offset:25184
    v_rcp_f32 v68, v68
    v_mfma_f32_16x16x32_bf16 v[124:127], a[208:211], a[252:255], v[124:127]
    s_waitcnt lgkmcnt(8)
    s_add_u32 s73, s73, 8192
    v_rcp_f32 v69, v69
    v_mfma_f32_16x16x32_bf16 v[128:131], a[180:183], a[100:103], v[128:131]
    ds_read_b64_tr_b16 a[204:205], v8 offset:14432
    v_rcp_f32 v70, v70
    v_mfma_f32_16x16x32_bf16 v[128:131], a[184:187], a[104:107], v[128:131]
    v_rcp_f32 v71, v71
    v_rcp_f32 v72, v72
    v_mfma_f32_16x16x32_bf16 v[132:135], a[180:183], a[108:111], v[132:135]
    ds_read_b64_tr_b16 a[206:207], v8 offset:18016
    v_rcp_f32 v73, v73
    v_mfma_f32_16x16x32_bf16 v[132:135], a[184:187], a[112:115], v[132:135]
    buffer_load_dwordx4 v16, s[8:11], s38 offen offset:0 lds
    v_rcp_f32 v74, v74
    v_mfma_f32_16x16x32_bf16 v[136:139], a[180:183], a[116:119], v[136:139]
    ds_read_b64_tr_b16 a[208:209], v8 offset:21600
    v_rcp_f32 v75, v75
    v_mfma_f32_16x16x32_bf16 v[136:139], a[184:187], a[120:123], v[136:139]
    v_rcp_f32 v76, v76
    v_rcp_f32 v77, v77
    v_mfma_f32_16x16x32_bf16 v[140:143], a[180:183], a[124:127], v[140:143]
    ds_read_b64_tr_b16 a[210:211], v8 offset:25184
    v_rcp_f32 v78, v78
    v_rcp_f32 v79, v79
    v_pk_mul_f32 v[80:81], v[80:81], v[64:65]
    v_pk_mul_f32 v[82:83], v[82:83], v[66:67]
    v_pk_mul_f32 v[84:85], v[84:85], v[68:69]
    v_pk_mul_f32 v[86:87], v[86:87], v[70:71]
    v_pk_mul_f32 v[88:89], v[88:89], v[72:73]
    v_pk_mul_f32 v[90:91], v[90:91], v[74:75]
    v_pk_mul_f32 v[92:93], v[92:93], v[76:77]
    v_pk_mul_f32 v[94:95], v[94:95], v[78:79]
    v_pk_mul_f32 v[112:113], v[96:97], v[112:113]
    v_pk_mul_f32 v[114:115], v[98:99], v[114:115]
    v_pk_mul_f32 v[116:117], v[100:101], v[116:117]
    v_pk_mul_f32 v[118:119], v[102:103], v[118:119]
    v_pk_mul_f32 v[120:121], v[104:105], v[120:121]
    v_pk_mul_f32 v[122:123], v[106:107], v[122:123]
    v_pk_mul_f32 v[124:125], v[108:109], v[124:125]
    v_pk_mul_f32 v[126:127], v[110:111], v[126:127]
    v_pk_mul_f32 v[96:97], v[96:97], s[50:51]
    v_pk_mul_f32 v[98:99], v[98:99], s[50:51]
    v_pk_mul_f32 v[100:101], v[100:101], s[50:51]
    v_pk_mul_f32 v[102:103], v[102:103], s[50:51]
    v_pk_mul_f32 v[104:105], v[104:105], s[50:51]
    v_pk_mul_f32 v[106:107], v[106:107], s[50:51]
    v_pk_mul_f32 v[108:109], v[108:109], s[50:51]
    v_pk_mul_f32 v[110:111], v[110:111], s[50:51]
    v_mfma_f32_16x16x32_bf16 v[140:143], a[184:187], a[128:131], v[140:143]
    s_waitcnt lgkmcnt(8)
    v_cvt_pk_bf16_f32 v64, v80, v81
    v_exp_f32 v96, v96
    v_mfma_f32_16x16x32_bf16 v[128:131], a[188:191], a[224:227], v[128:131]
    ds_read_b64_tr_b16 a[180:181], v1 offset:128
    v_cvt_pk_bf16_f32 v65, v82, v83
    v_exp_f32 v97, v97
    v_mfma_f32_16x16x32_bf16 v[128:131], a[192:195], a[228:231], v[128:131]
    buffer_load_dwordx4 v17, s[8:11], s38 offen offset:1024 lds
    v_cvt_pk_bf16_f32 v66, v84, v85
    v_exp_f32 v98, v98
    v_mfma_f32_16x16x32_bf16 v[132:135], a[188:191], a[232:235], v[132:135]
    ds_read_b64_tr_b16 a[182:183], v1 offset:3712
    v_cvt_pk_bf16_f32 v67, v86, v87
    v_exp_f32 v99, v99
    v_mfma_f32_16x16x32_bf16 v[132:135], a[192:195], a[236:239], v[132:135]
    v_cvt_pk_bf16_f32 v72, v88, v89
    v_exp_f32 v100, v100
    v_mfma_f32_16x16x32_bf16 v[136:139], a[188:191], a[240:243], v[136:139]
    ds_read_b64_tr_b16 a[184:185], v1 offset:7296
    v_cvt_pk_bf16_f32 v73, v90, v91
    v_exp_f32 v101, v101
    v_mfma_f32_16x16x32_bf16 v[136:139], a[192:195], a[244:247], v[136:139]
    v_cvt_pk_bf16_f32 v74, v92, v93
    v_exp_f32 v102, v102
    v_mfma_f32_16x16x32_bf16 v[140:143], a[188:191], a[248:251], v[140:143]
    ds_read_b64_tr_b16 a[186:187], v1 offset:10880
    v_cvt_pk_bf16_f32 v75, v94, v95
    v_exp_f32 v103, v103
    v_mfma_f32_16x16x32_bf16 v[140:143], a[192:195], a[252:255], v[140:143]
    s_waitcnt lgkmcnt(8)
    v_permlane16_swap_b32 v64, v66
    v_exp_f32 v104, v104
    v_mfma_f32_16x16x32_bf16 v[144:147], a[196:199], a[100:103], v[144:147]
    ds_read_b64_tr_b16 a[188:189], v8 offset:128
    v_permlane16_swap_b32 v65, v67
    v_mfma_f32_16x16x32_bf16 v[144:147], a[200:203], a[104:107], v[144:147]
    buffer_load_dwordx4 v18, s[8:11], s38 offen offset:2048 lds
    v_exp_f32 v105, v105
    v_mfma_f32_16x16x32_bf16 v[148:151], a[196:199], a[108:111], v[148:151]
    ds_read_b64_tr_b16 a[190:191], v8 offset:3712
    v_exp_f32 v106, v106
    v_mfma_f32_16x16x32_bf16 v[148:151], a[200:203], a[112:115], v[148:151]
    v_permlane16_swap_b32 v72, v74
    v_exp_f32 v107, v107
    v_mfma_f32_16x16x32_bf16 v[152:155], a[196:199], a[116:119], v[152:155]
    ds_read_b64_tr_b16 a[192:193], v8 offset:7296
    v_permlane16_swap_b32 v73, v75
    v_mfma_f32_16x16x32_bf16 v[152:155], a[200:203], a[120:123], v[152:155]
    buffer_store_dwordx4 v[64:67], v26, s[28:31], s74 offen offset:0 sc1
    v_exp_f32 v108, v108
    v_mfma_f32_16x16x32_bf16 v[156:159], a[196:199], a[124:127], v[156:159]
    ds_read_b64_tr_b16 a[194:195], v8 offset:10880
    v_exp_f32 v109, v109
    v_mfma_f32_16x16x32_bf16 v[156:159], a[200:203], a[128:131], v[156:159]
    s_waitcnt lgkmcnt(8)
    v_exp_f32 v110, v110
    v_exp_f32 v111, v111
    v_pk_add_f32 v[96:97], v[96:97], s[52:53]
    v_pk_add_f32 v[98:99], v[98:99], s[52:53]
    v_pk_add_f32 v[100:101], v[100:101], s[52:53]
    v_pk_add_f32 v[102:103], v[102:103], s[52:53]
    v_pk_add_f32 v[104:105], v[104:105], s[52:53]
    v_pk_add_f32 v[106:107], v[106:107], s[52:53]
    v_pk_add_f32 v[108:109], v[108:109], s[52:53]
    v_pk_add_f32 v[110:111], v[110:111], s[52:53]
    v_mfma_f32_16x16x32_bf16 v[144:147], a[204:207], a[224:227], v[144:147]
    ds_read_b64_tr_b16 a[196:197], v1 offset:14464
    v_rcp_f32 v96, v96
    v_mfma_f32_16x16x32_bf16 v[144:147], a[208:211], a[228:231], v[144:147]
    ds_read_b64_tr_b16 a[212:213], v11 offset:0
    v_rcp_f32 v97, v97
    v_mfma_f32_16x16x32_bf16 v[148:151], a[204:207], a[232:235], v[148:151]
    ds_read_b64_tr_b16 a[198:199], v1 offset:18048
    v_rcp_f32 v98, v98
    v_mfma_f32_16x16x32_bf16 v[148:151], a[208:211], a[236:239], v[148:151]
    ds_read_b64_tr_b16 a[214:215], v11 offset:3072
    v_rcp_f32 v99, v99
    v_mfma_f32_16x16x32_bf16 v[152:155], a[204:207], a[240:243], v[152:155]
    ds_read_b64_tr_b16 a[200:201], v1 offset:21632
    v_rcp_f32 v100, v100
    v_mfma_f32_16x16x32_bf16 v[152:155], a[208:211], a[244:247], v[152:155]
    ds_read_b64_tr_b16 a[216:217], v11 offset:6144
    v_rcp_f32 v101, v101
    v_mfma_f32_16x16x32_bf16 v[156:159], a[204:207], a[248:251], v[156:159]
    ds_read_b64_tr_b16 a[202:203], v1 offset:25216
    v_rcp_f32 v102, v102
    v_mfma_f32_16x16x32_bf16 v[156:159], a[208:211], a[252:255], v[156:159]
    ds_read_b64_tr_b16 a[218:219], v11 offset:9216
    s_waitcnt lgkmcnt(12)
    v_rcp_f32 v103, v103
    v_mfma_f32_16x16x32_bf16 v[160:163], a[180:183], a[100:103], v[160:163]
    ds_read_b64_tr_b16 a[204:205], v8 offset:14464
    v_rcp_f32 v104, v104
    v_mfma_f32_16x16x32_bf16 v[160:163], a[184:187], a[104:107], v[160:163]
    buffer_store_dwordx4 v[72:75], v26, s[28:31], s74 offen offset:2048 sc1
    v_rcp_f32 v105, v105
    v_mfma_f32_16x16x32_bf16 v[164:167], a[180:183], a[108:111], v[164:167]
    ds_read_b64_tr_b16 a[206:207], v8 offset:18048
    v_rcp_f32 v106, v106
    v_mfma_f32_16x16x32_bf16 v[164:167], a[184:187], a[112:115], v[164:167]
    s_add_u32 s74, s74, 8192
    v_rcp_f32 v107, v107
    v_rcp_f32 v108, v108
    v_mfma_f32_16x16x32_bf16 v[168:171], a[180:183], a[116:119], v[168:171]
    ds_read_b64_tr_b16 a[208:209], v8 offset:21632
    v_rcp_f32 v109, v109
    v_mfma_f32_16x16x32_bf16 v[168:171], a[184:187], a[120:123], v[168:171]
    v_rcp_f32 v110, v110
    v_rcp_f32 v111, v111
    v_pk_mul_f32 v[112:113], v[112:113], v[96:97]
    v_pk_mul_f32 v[114:115], v[114:115], v[98:99]
    v_pk_mul_f32 v[116:117], v[116:117], v[100:101]
    v_pk_mul_f32 v[118:119], v[118:119], v[102:103]
    v_pk_mul_f32 v[120:121], v[120:121], v[104:105]
    v_pk_mul_f32 v[122:123], v[122:123], v[106:107]
    v_pk_mul_f32 v[124:125], v[124:125], v[108:109]
    v_pk_mul_f32 v[126:127], v[126:127], v[110:111]
    v_pk_mul_f32 v[144:145], v[128:129], v[144:145]
    v_pk_mul_f32 v[146:147], v[130:131], v[146:147]
    v_pk_mul_f32 v[148:149], v[132:133], v[148:149]
    v_pk_mul_f32 v[150:151], v[134:135], v[150:151]
    v_pk_mul_f32 v[152:153], v[136:137], v[152:153]
    v_pk_mul_f32 v[154:155], v[138:139], v[154:155]
    v_pk_mul_f32 v[156:157], v[140:141], v[156:157]
    v_pk_mul_f32 v[158:159], v[142:143], v[158:159]
    v_pk_mul_f32 v[128:129], v[128:129], s[50:51]
    v_pk_mul_f32 v[130:131], v[130:131], s[50:51]
    v_pk_mul_f32 v[132:133], v[132:133], s[50:51]
    v_pk_mul_f32 v[134:135], v[134:135], s[50:51]
    v_pk_mul_f32 v[136:137], v[136:137], s[50:51]
    v_pk_mul_f32 v[138:139], v[138:139], s[50:51]
    v_pk_mul_f32 v[140:141], v[140:141], s[50:51]
    v_pk_mul_f32 v[142:143], v[142:143], s[50:51]
    v_mfma_f32_16x16x32_bf16 v[172:175], a[180:183], a[124:127], v[172:175]
    ds_read_b64_tr_b16 a[210:211], v8 offset:25216
    v_cvt_pk_bf16_f32 v96, v112, v113
    v_exp_f32 v128, v128
    v_mfma_f32_16x16x32_bf16 v[172:175], a[184:187], a[128:131], v[172:175]
    s_waitcnt lgkmcnt(12)
    v_cvt_pk_bf16_f32 v97, v114, v115
    v_exp_f32 v129, v129
    v_mfma_f32_16x16x32_bf16 v[160:163], a[188:191], a[224:227], v[160:163]
    ds_read_b64_tr_b16 a[180:181], v1 offset:160
    v_cvt_pk_bf16_f32 v98, v116, v117
    v_exp_f32 v130, v130
    v_mfma_f32_16x16x32_bf16 v[160:163], a[192:195], a[228:231], v[160:163]
    buffer_load_dwordx4 v19, s[8:11], s38 offen offset:3072 lds
    v_cvt_pk_bf16_f32 v99, v118, v119
    v_exp_f32 v131, v131
    v_mfma_f32_16x16x32_bf16 v[164:167], a[188:191], a[232:235], v[164:167]
    ds_read_b64_tr_b16 a[182:183], v1 offset:3744
    v_cvt_pk_bf16_f32 v104, v120, v121
    v_exp_f32 v132, v132
    v_mfma_f32_16x16x32_bf16 v[164:167], a[192:195], a[236:239], v[164:167]
    s_mov_b64 s[12:13], s[68:69]
    v_cvt_pk_bf16_f32 v105, v122, v123
    v_exp_f32 v133, v133
    v_mfma_f32_16x16x32_bf16 v[168:171], a[188:191], a[240:243], v[168:171]
    ds_read_b64_tr_b16 a[184:185], v1 offset:7328
    v_cvt_pk_bf16_f32 v106, v124, v125
    v_exp_f32 v134, v134
    v_mfma_f32_16x16x32_bf16 v[168:171], a[192:195], a[244:247], v[168:171]
    s_mov_b32 s14, 2097152
    v_cvt_pk_bf16_f32 v107, v126, v127
    v_exp_f32 v135, v135
    v_mfma_f32_16x16x32_bf16 v[172:175], a[188:191], a[248:251], v[172:175]
    ds_read_b64_tr_b16 a[186:187], v1 offset:10912
    v_permlane16_swap_b32 v96, v98
    v_mfma_f32_16x16x32_bf16 v[172:175], a[192:195], a[252:255], v[172:175]
    s_waitcnt lgkmcnt(9)
    s_add_u32 m0, s56, 81920
    v_exp_f32 v136, v136
    v_mfma_f32_16x16x32_bf16 v[176:179], a[196:199], a[100:103], v[176:179]
    ds_read_b64_tr_b16 a[188:189], v8 offset:160
    v_permlane16_swap_b32 v97, v99
    v_mfma_f32_16x16x32_bf16 v[176:179], a[200:203], a[104:107], v[176:179]
    s_bfe_u32 s38, s80, 0x40014
    s_lshl_b32 s38, s38, 18
    s_add_u32 s38, s38, 0
    v_exp_f32 v137, v137
    v_exp_f32 v138, v138
    v_mfma_f32_16x16x32_bf16 v[180:183], a[196:199], a[108:111], v[180:183]
    ds_read_b64_tr_b16 a[190:191], v8 offset:3744
    v_permlane16_swap_b32 v104, v106
    v_mfma_f32_16x16x32_bf16 v[180:183], a[200:203], a[112:115], v[180:183]
    buffer_store_dwordx4 v[96:99], v26, s[28:31], s73 offen offset:0 sc1
    v_exp_f32 v139, v139
    v_mfma_f32_16x16x32_bf16 v[184:187], a[196:199], a[116:119], v[184:187]
    ds_read_b64_tr_b16 a[192:193], v8 offset:7328
    v_permlane16_swap_b32 v105, v107
    v_mfma_f32_16x16x32_bf16 v[184:187], a[200:203], a[120:123], v[184:187]
    v_exp_f32 v140, v140
    v_exp_f32 v141, v141
    v_mfma_f32_16x16x32_bf16 v[188:191], a[196:199], a[124:127], v[188:191]
    ds_read_b64_tr_b16 a[194:195], v8 offset:10912
    v_exp_f32 v142, v142
    v_exp_f32 v143, v143
    v_pk_add_f32 v[128:129], v[128:129], s[52:53]
    v_pk_add_f32 v[130:131], v[130:131], s[52:53]
    v_pk_add_f32 v[132:133], v[132:133], s[52:53]
    v_pk_add_f32 v[134:135], v[134:135], s[52:53]
    v_pk_add_f32 v[136:137], v[136:137], s[52:53]
    v_pk_add_f32 v[138:139], v[138:139], s[52:53]
    v_pk_add_f32 v[140:141], v[140:141], s[52:53]
    v_pk_add_f32 v[142:143], v[142:143], s[52:53]
    v_mfma_f32_16x16x32_bf16 v[188:191], a[200:203], a[128:131], v[188:191]
    s_waitcnt lgkmcnt(8)
    v_rcp_f32 v128, v128
    v_rcp_f32 v129, v129
    s_waitcnt vmcnt(13)
    v_mfma_f32_16x16x32_bf16 v[176:179], a[204:207], a[224:227], v[176:179]
    ds_read_b64_tr_b16 a[196:197], v1 offset:14496
    v_rcp_f32 v130, v130
    v_mfma_f32_16x16x32_bf16 v[176:179], a[208:211], a[228:231], v[176:179]
    buffer_store_dwordx4 v[104:107], v26, s[28:31], s73 offen offset:2048 sc1
    v_rcp_f32 v131, v131
    v_mfma_f32_16x16x32_bf16 v[180:183], a[204:207], a[232:235], v[180:183]
    ds_read_b64_tr_b16 a[198:199], v1 offset:18080
    v_rcp_f32 v132, v132
    v_mfma_f32_16x16x32_bf16 v[180:183], a[208:211], a[236:239], v[180:183]
    s_add_u32 s73, s73, 8192
    v_rcp_f32 v133, v133
    v_rcp_f32 v134, v134
    v_mfma_f32_16x16x32_bf16 v[184:187], a[204:207], a[240:243], v[184:187]
    ds_read_b64_tr_b16 a[200:201], v1 offset:21664
    v_rcp_f32 v135, v135
    v_mfma_f32_16x16x32_bf16 v[184:187], a[208:211], a[244:247], v[184:187]
    v_rcp_f32 v136, v136
    v_rcp_f32 v137, v137
    v_mfma_f32_16x16x32_bf16 v[188:191], a[204:207], a[248:251], v[188:191]
    ds_read_b64_tr_b16 a[202:203], v1 offset:25248
    v_rcp_f32 v138, v138
    v_mfma_f32_16x16x32_bf16 v[188:191], a[208:211], a[252:255], v[188:191]
    buffer_load_dwordx4 v30, s[12:15], s38 offen offset:0 lds
    v_rcp_f32 v139, v139
    v_mfma_f32_16x16x32_bf16 a[96:99], a[212:215], a[172:175], a[96:99]
    s_bfe_u32 s38, s80, 0x40014
    s_lshl_b32 s38, s38, 18
    s_add_u32 s38, s38, 15360
    v_rcp_f32 v140, v140
    v_rcp_f32 v141, v141
    v_mfma_f32_16x16x32_bf16 a[96:99], a[216:219], a[176:179], a[96:99]
    s_waitcnt lgkmcnt(8)
    v_rcp_f32 v142, v142
    v_rcp_f32 v143, v143
    v_pk_mul_f32 v[144:145], v[144:145], v[128:129]
    v_pk_mul_f32 v[146:147], v[146:147], v[130:131]
    v_pk_mul_f32 v[148:149], v[148:149], v[132:133]
    v_pk_mul_f32 v[150:151], v[150:151], v[134:135]
    v_pk_mul_f32 v[152:153], v[152:153], v[136:137]
    v_pk_mul_f32 v[154:155], v[154:155], v[138:139]
    v_pk_mul_f32 v[156:157], v[156:157], v[140:141]
    v_pk_mul_f32 v[158:159], v[158:159], v[142:143]
    v_pk_mul_f32 v[176:177], v[160:161], v[176:177]
    v_pk_mul_f32 v[178:179], v[162:163], v[178:179]
    v_pk_mul_f32 v[180:181], v[164:165], v[180:181]
    v_pk_mul_f32 v[182:183], v[166:167], v[182:183]
    v_pk_mul_f32 v[184:185], v[168:169], v[184:185]
    v_pk_mul_f32 v[186:187], v[170:171], v[186:187]
    v_pk_mul_f32 v[188:189], v[172:173], v[188:189]
    v_pk_mul_f32 v[190:191], v[174:175], v[190:191]
    v_pk_mul_f32 v[160:161], v[160:161], s[50:51]
    v_pk_mul_f32 v[162:163], v[162:163], s[50:51]
    v_pk_mul_f32 v[164:165], v[164:165], s[50:51]
    v_pk_mul_f32 v[166:167], v[166:167], s[50:51]
    v_pk_mul_f32 v[168:169], v[168:169], s[50:51]
    v_pk_mul_f32 v[170:171], v[170:171], s[50:51]
    v_pk_mul_f32 v[172:173], v[172:173], s[50:51]
    v_pk_mul_f32 v[174:175], v[174:175], s[50:51]
    v_mfma_f32_16x16x32_bf16 v[192:195], a[180:183], a[100:103], v[192:195]
    ds_read_b64_tr_b16 a[204:205], v8 offset:14496
    v_cvt_pk_bf16_f32 v128, v144, v145
    v_exp_f32 v160, v160
    v_mfma_f32_16x16x32_bf16 v[192:195], a[184:187], a[104:107], v[192:195]
    v_cvt_pk_bf16_f32 v129, v146, v147
    v_exp_f32 v161, v161
    v_mfma_f32_16x16x32_bf16 v[196:199], a[180:183], a[108:111], v[196:199]
    ds_read_b64_tr_b16 a[206:207], v8 offset:18080
    v_cvt_pk_bf16_f32 v130, v148, v149
    v_exp_f32 v162, v162
    v_mfma_f32_16x16x32_bf16 v[196:199], a[184:187], a[112:115], v[196:199]
    v_cvt_pk_bf16_f32 v131, v150, v151
    v_exp_f32 v163, v163
    v_mfma_f32_16x16x32_bf16 v[200:203], a[180:183], a[116:119], v[200:203]
    ds_read_b64_tr_b16 a[208:209], v8 offset:21664
    v_cvt_pk_bf16_f32 v136, v152, v153
    v_exp_f32 v164, v164
    v_mfma_f32_16x16x32_bf16 v[200:203], a[184:187], a[120:123], v[200:203]
    buffer_load_dwordx4 v30, s[12:15], s38 offen offset:1024 lds
    v_cvt_pk_bf16_f32 v137, v154, v155
    v_exp_f32 v165, v165
    v_mfma_f32_16x16x32_bf16 v[204:207], a[180:183], a[124:127], v[204:207]
    ds_read_b64_tr_b16 a[210:211], v8 offset:25248
    v_cvt_pk_bf16_f32 v138, v156, v157
    v_exp_f32 v166, v166
    v_mfma_f32_16x16x32_bf16 v[204:207], a[184:187], a[128:131], v[204:207]
    s_waitcnt lgkmcnt(8)
    s_bfe_u32 s38, s80, 0x40014
    s_lshl_b32 s38, s38, 18
    s_add_u32 s38, s38, 30720
    v_cvt_pk_bf16_f32 v139, v158, v159
    v_exp_f32 v167, v167
    v_mfma_f32_16x16x32_bf16 v[192:195], a[188:191], a[224:227], v[192:195]
    ds_read_b64_tr_b16 a[180:181], v1 offset:192
    v_permlane16_swap_b32 v128, v130
    v_mfma_f32_16x16x32_bf16 v[192:195], a[192:195], a[228:231], v[192:195]
    v_exp_f32 v168, v168
    v_permlane16_swap_b32 v129, v131
    v_mfma_f32_16x16x32_bf16 v[196:199], a[188:191], a[232:235], v[196:199]
    ds_read_b64_tr_b16 a[182:183], v1 offset:3776
    v_exp_f32 v169, v169
    v_mfma_f32_16x16x32_bf16 v[196:199], a[192:195], a[236:239], v[196:199]
    buffer_load_dwordx4 v30, s[12:15], s38 offen offset:2048 lds
    v_exp_f32 v170, v170
    v_mfma_f32_16x16x32_bf16 v[200:203], a[188:191], a[240:243], v[200:203]
    ds_read_b64_tr_b16 a[184:185], v1 offset:7360
    v_permlane16_swap_b32 v136, v138
    v_mfma_f32_16x16x32_bf16 v[200:203], a[192:195], a[244:247], v[200:203]
    v_exp_f32 v171, v171
    v_permlane16_swap_b32 v137, v139
    v_mfma_f32_16x16x32_bf16 v[204:207], a[188:191], a[248:251], v[204:207]
    ds_read_b64_tr_b16 a[186:187], v1 offset:10944
    v_exp_f32 v172, v172
    v_mfma_f32_16x16x32_bf16 v[204:207], a[192:195], a[252:255], v[204:207]
    s_waitcnt lgkmcnt(8)
    v_exp_f32 v173, v173
    v_mfma_f32_16x16x32_bf16 v[208:211], a[196:199], a[100:103], v[208:211]
    ds_read_b64_tr_b16 a[188:189], v8 offset:192
    v_exp_f32 v174, v174
    v_exp_f32 v175, v175
    v_pk_add_f32 v[160:161], v[160:161], s[52:53]
    v_pk_add_f32 v[162:163], v[162:163], s[52:53]
    v_pk_add_f32 v[164:165], v[164:165], s[52:53]
    v_pk_add_f32 v[166:167], v[166:167], s[52:53]
    v_pk_add_f32 v[168:169], v[168:169], s[52:53]
    v_pk_add_f32 v[170:171], v[170:171], s[52:53]
    v_pk_add_f32 v[172:173], v[172:173], s[52:53]
    v_pk_add_f32 v[174:175], v[174:175], s[52:53]
    v_mfma_f32_16x16x32_bf16 v[208:211], a[200:203], a[104:107], v[208:211]
    buffer_store_dwordx4 v[128:131], v26, s[28:31], s74 offen offset:0 sc1
    v_rcp_f32 v160, v160
    v_mfma_f32_16x16x32_bf16 v[212:215], a[196:199], a[108:111], v[212:215]
    ds_read_b64_tr_b16 a[190:191], v8 offset:3776
    v_rcp_f32 v161, v161
    v_mfma_f32_16x16x32_bf16 v[212:215], a[200:203], a[112:115], v[212:215]
    v_rcp_f32 v162, v162
    v_rcp_f32 v163, v163
    v_mfma_f32_16x16x32_bf16 v[216:219], a[196:199], a[116:119], v[216:219]
    ds_read_b64_tr_b16 a[192:193], v8 offset:7360
    v_rcp_f32 v164, v164
    v_mfma_f32_16x16x32_bf16 v[216:219], a[200:203], a[120:123], v[216:219]
    buffer_store_dwordx4 v[136:139], v26, s[28:31], s74 offen offset:2048 sc1
    v_rcp_f32 v165, v165
    v_mfma_f32_16x16x32_bf16 v[220:223], a[196:199], a[124:127], v[220:223]
    ds_read_b64_tr_b16 a[194:195], v8 offset:10944
    v_rcp_f32 v166, v166
    v_mfma_f32_16x16x32_bf16 v[220:223], a[200:203], a[128:131], v[220:223]
    s_waitcnt lgkmcnt(8)
    s_add_u32 s74, s74, 8192
    v_rcp_f32 v167, v167
    v_mfma_f32_16x16x32_bf16 v[208:211], a[204:207], a[224:227], v[208:211]
    ds_read_b64_tr_b16 a[196:197], v1 offset:14528
    v_rcp_f32 v168, v168
    v_mfma_f32_16x16x32_bf16 v[208:211], a[208:211], a[228:231], v[208:211]
    s_bfe_u32 s38, s80, 0x40014
    s_lshl_b32 s38, s38, 18
    s_add_u32 s38, s38, 46080
    v_rcp_f32 v169, v169
    v_rcp_f32 v170, v170
    v_mfma_f32_16x16x32_bf16 v[212:215], a[204:207], a[232:235], v[212:215]
    ds_read_b64_tr_b16 a[198:199], v1 offset:18112
    v_rcp_f32 v171, v171
    v_mfma_f32_16x16x32_bf16 v[212:215], a[208:211], a[236:239], v[212:215]
    buffer_load_dwordx4 v30, s[12:15], s38 offen offset:3072 lds
    v_rcp_f32 v172, v172
    v_mfma_f32_16x16x32_bf16 v[216:219], a[204:207], a[240:243], v[216:219]
    ds_read_b64_tr_b16 a[200:201], v1 offset:21696
    v_rcp_f32 v173, v173
    v_mfma_f32_16x16x32_bf16 v[216:219], a[208:211], a[244:247], v[216:219]
    s_add_u32 m0, s56, 98304
    v_rcp_f32 v174, v174
    v_rcp_f32 v175, v175
    v_mfma_f32_16x16x32_bf16 v[220:223], a[204:207], a[248:251], v[220:223]
    ds_read_b64_tr_b16 a[202:203], v1 offset:25280
    s_bfe_u32 s38, s80, 0x40018
    s_lshl_b32 s38, s38, 18
    s_add_u32 s38, s38, 0
    v_mfma_f32_16x16x32_bf16 v[220:223], a[208:211], a[252:255], v[220:223]
    s_waitcnt lgkmcnt(8)
    v_mfma_f32_16x16x32_bf16 v[224:227], a[180:183], a[100:103], v[224:227]
    ds_read_b64_tr_b16 a[204:205], v8 offset:14528
    v_mfma_f32_16x16x32_bf16 v[224:227], a[184:187], a[104:107], v[224:227]
    buffer_load_dwordx4 v30, s[12:15], s38 offen offset:0 lds
    v_pk_mul_f32 v[176:177], v[176:177], v[160:161]
    v_pk_mul_f32 v[178:179], v[178:179], v[162:163]
    v_pk_mul_f32 v[180:181], v[180:181], v[164:165]
    v_pk_mul_f32 v[182:183], v[182:183], v[166:167]
    v_pk_mul_f32 v[184:185], v[184:185], v[168:169]
    v_pk_mul_f32 v[186:187], v[186:187], v[170:171]
    v_pk_mul_f32 v[188:189], v[188:189], v[172:173]
    v_pk_mul_f32 v[190:191], v[190:191], v[174:175]
    v_pk_mul_f32 v[208:209], v[192:193], v[208:209]
    v_pk_mul_f32 v[210:211], v[194:195], v[210:211]
    v_pk_mul_f32 v[212:213], v[196:197], v[212:213]
    v_pk_mul_f32 v[214:215], v[198:199], v[214:215]
    v_pk_mul_f32 v[216:217], v[200:201], v[216:217]
    v_pk_mul_f32 v[218:219], v[202:203], v[218:219]
    v_pk_mul_f32 v[220:221], v[204:205], v[220:221]
    v_pk_mul_f32 v[222:223], v[206:207], v[222:223]
    v_pk_mul_f32 v[192:193], v[192:193], s[50:51]
    v_pk_mul_f32 v[194:195], v[194:195], s[50:51]
    v_pk_mul_f32 v[196:197], v[196:197], s[50:51]
    v_pk_mul_f32 v[198:199], v[198:199], s[50:51]
    v_pk_mul_f32 v[200:201], v[200:201], s[50:51]
    v_pk_mul_f32 v[202:203], v[202:203], s[50:51]
    v_pk_mul_f32 v[204:205], v[204:205], s[50:51]
    v_pk_mul_f32 v[206:207], v[206:207], s[50:51]
    v_mfma_f32_16x16x32_bf16 v[228:231], a[180:183], a[108:111], v[228:231]
    ds_read_b64_tr_b16 a[206:207], v8 offset:18112
    v_cvt_pk_bf16_f32 v160, v176, v177
    v_exp_f32 v192, v192
    v_mfma_f32_16x16x32_bf16 v[228:231], a[184:187], a[112:115], v[228:231]
    s_bfe_u32 s38, s80, 0x40018
    s_lshl_b32 s38, s38, 18
    s_add_u32 s38, s38, 15360
    v_cvt_pk_bf16_f32 v161, v178, v179
    v_exp_f32 v193, v193
    v_mfma_f32_16x16x32_bf16 v[232:235], a[180:183], a[116:119], v[232:235]
    ds_read_b64_tr_b16 a[208:209], v8 offset:21696
    v_cvt_pk_bf16_f32 v162, v180, v181
    v_exp_f32 v194, v194
    v_mfma_f32_16x16x32_bf16 v[232:235], a[184:187], a[120:123], v[232:235]
    v_cvt_pk_bf16_f32 v163, v182, v183
    v_exp_f32 v195, v195
    v_mfma_f32_16x16x32_bf16 v[236:239], a[180:183], a[124:127], v[236:239]
    ds_read_b64_tr_b16 a[210:211], v8 offset:25280
    v_cvt_pk_bf16_f32 v168, v184, v185
    v_exp_f32 v196, v196
    v_mfma_f32_16x16x32_bf16 v[236:239], a[184:187], a[128:131], v[236:239]
    s_waitcnt lgkmcnt(8)
    v_cvt_pk_bf16_f32 v169, v186, v187
    v_exp_f32 v197, v197
    v_mfma_f32_16x16x32_bf16 v[224:227], a[188:191], a[224:227], v[224:227]
    ds_read_b64_tr_b16 a[180:181], v2 offset:0
    v_cvt_pk_bf16_f32 v170, v188, v189
    v_exp_f32 v198, v198
    v_mfma_f32_16x16x32_bf16 v[224:227], a[192:195], a[228:231], v[224:227]
    buffer_load_dwordx4 v30, s[12:15], s38 offen offset:1024 lds
    v_cvt_pk_bf16_f32 v171, v190, v191
    v_exp_f32 v199, v199
    v_mfma_f32_16x16x32_bf16 v[228:231], a[188:191], a[232:235], v[228:231]
    ds_read_b64_tr_b16 a[182:183], v2 offset:3072
    v_permlane16_swap_b32 v160, v162
    v_mfma_f32_16x16x32_bf16 v[228:231], a[192:195], a[236:239], v[228:231]
    s_bfe_u32 s38, s80, 0x40018
    s_lshl_b32 s38, s38, 18
    s_add_u32 s38, s38, 30720
    v_exp_f32 v200, v200
    v_permlane16_swap_b32 v161, v163
    v_mfma_f32_16x16x32_bf16 v[232:235], a[188:191], a[240:243], v[232:235]
    ds_read_b64_tr_b16 a[184:185], v2 offset:6144
    v_exp_f32 v201, v201
    v_mfma_f32_16x16x32_bf16 v[232:235], a[192:195], a[244:247], v[232:235]
    v_exp_f32 v202, v202
    v_permlane16_swap_b32 v168, v170
    v_mfma_f32_16x16x32_bf16 v[236:239], a[188:191], a[248:251], v[236:239]
    ds_read_b64_tr_b16 a[186:187], v2 offset:9216
    v_exp_f32 v203, v203
    v_mfma_f32_16x16x32_bf16 v[236:239], a[192:195], a[252:255], v[236:239]
    s_waitcnt lgkmcnt(8)
    v_permlane16_swap_b32 v169, v171
    v_exp_f32 v204, v204
    v_mfma_f32_16x16x32_bf16 v[240:243], a[196:199], a[100:103], v[240:243]
    ds_read_b64_tr_b16 a[188:189], v9 offset:0
    v_exp_f32 v205, v205
    v_mfma_f32_16x16x32_bf16 v[240:243], a[200:203], a[104:107], v[240:243]
    buffer_store_dwordx4 v[160:163], v26, s[28:31], s73 offen offset:0 sc1
    v_exp_f32 v206, v206
    v_exp_f32 v207, v207
    v_pk_add_f32 v[192:193], v[192:193], s[52:53]
    v_pk_add_f32 v[194:195], v[194:195], s[52:53]
    v_pk_add_f32 v[196:197], v[196:197], s[52:53]
    v_pk_add_f32 v[198:199], v[198:199], s[52:53]
    v_pk_add_f32 v[200:201], v[200:201], s[52:53]
    v_pk_add_f32 v[202:203], v[202:203], s[52:53]
    v_pk_add_f32 v[204:205], v[204:205], s[52:53]
    v_pk_add_f32 v[206:207], v[206:207], s[52:53]
    v_mfma_f32_16x16x32_bf16 v[244:247], a[196:199], a[108:111], v[244:247]
    ds_read_b64_tr_b16 a[190:191], v9 offset:3072
    v_rcp_f32 v192, v192
    v_mfma_f32_16x16x32_bf16 v[244:247], a[200:203], a[112:115], v[244:247]
    v_rcp_f32 v193, v193
    v_rcp_f32 v194, v194
    v_mfma_f32_16x16x32_bf16 v[248:251], a[196:199], a[116:119], v[248:251]
    ds_read_b64_tr_b16 a[192:193], v9 offset:6144
    v_rcp_f32 v195, v195
    v_mfma_f32_16x16x32_bf16 v[248:251], a[200:203], a[120:123], v[248:251]
    buffer_store_dwordx4 v[168:171], v26, s[28:31], s73 offen offset:2048 sc1
    v_rcp_f32 v196, v196
    v_mfma_f32_16x16x32_bf16 v[252:255], a[196:199], a[124:127], v[252:255]
    ds_read_b64_tr_b16 a[194:195], v9 offset:9216
    v_rcp_f32 v197, v197
    v_mfma_f32_16x16x32_bf16 v[252:255], a[200:203], a[128:131], v[252:255]
    s_waitcnt lgkmcnt(8)
    s_add_u32 s73, s73, 8192
    v_rcp_f32 v198, v198
    v_mfma_f32_16x16x32_bf16 v[240:243], a[204:207], a[224:227], v[240:243]
    ds_read_b64_tr_b16 a[196:197], v3 offset:0
    v_rcp_f32 v199, v199
    v_mfma_f32_16x16x32_bf16 v[240:243], a[208:211], a[228:231], v[240:243]
    v_rcp_f32 v200, v200
    v_rcp_f32 v201, v201
    v_mfma_f32_16x16x32_bf16 v[244:247], a[204:207], a[232:235], v[244:247]
    ds_read_b64_tr_b16 a[198:199], v3 offset:3072
    v_rcp_f32 v202, v202
    v_mfma_f32_16x16x32_bf16 v[244:247], a[208:211], a[236:239], v[244:247]
    buffer_load_dwordx4 v30, s[12:15], s38 offen offset:2048 lds
    v_rcp_f32 v203, v203
    v_mfma_f32_16x16x32_bf16 v[248:251], a[204:207], a[240:243], v[248:251]
    ds_read_b64_tr_b16 a[200:201], v3 offset:6144
    v_rcp_f32 v204, v204
    v_mfma_f32_16x16x32_bf16 v[248:251], a[208:211], a[244:247], v[248:251]
    s_bfe_u32 s38, s80, 0x40018
    s_lshl_b32 s38, s38, 18
    s_add_u32 s38, s38, 46080
    v_rcp_f32 v205, v205
    v_rcp_f32 v206, v206
    v_mfma_f32_16x16x32_bf16 v[252:255], a[204:207], a[248:251], v[252:255]
    ds_read_b64_tr_b16 a[202:203], v3 offset:9216
    v_rcp_f32 v207, v207
    v_mfma_f32_16x16x32_bf16 v[252:255], a[208:211], a[252:255], v[252:255]
    s_waitcnt lgkmcnt(8)
    v_mfma_f32_16x16x32_bf16 a[0:3], a[180:183], a[100:103], a[0:3]
    ds_read_b64_tr_b16 a[204:205], v10 offset:0
    v_mfma_f32_16x16x32_bf16 a[0:3], a[184:187], a[104:107], a[0:3]
    buffer_load_dwordx4 v30, s[12:15], s38 offen offset:3072 lds
    v_pk_mul_f32 v[208:209], v[208:209], v[192:193]
    v_pk_mul_f32 v[210:211], v[210:211], v[194:195]
    v_pk_mul_f32 v[212:213], v[212:213], v[196:197]
    v_pk_mul_f32 v[214:215], v[214:215], v[198:199]
    v_pk_mul_f32 v[216:217], v[216:217], v[200:201]
    v_pk_mul_f32 v[218:219], v[218:219], v[202:203]
    v_pk_mul_f32 v[220:221], v[220:221], v[204:205]
    v_pk_mul_f32 v[222:223], v[222:223], v[206:207]
    v_pk_mul_f32 v[240:241], v[224:225], v[240:241]
    v_pk_mul_f32 v[242:243], v[226:227], v[242:243]
    v_pk_mul_f32 v[244:245], v[228:229], v[244:245]
    v_pk_mul_f32 v[246:247], v[230:231], v[246:247]
    v_pk_mul_f32 v[248:249], v[232:233], v[248:249]
    v_pk_mul_f32 v[250:251], v[234:235], v[250:251]
    v_pk_mul_f32 v[252:253], v[236:237], v[252:253]
    v_pk_mul_f32 v[254:255], v[238:239], v[254:255]
    v_pk_mul_f32 v[224:225], v[224:225], s[50:51]
    v_pk_mul_f32 v[226:227], v[226:227], s[50:51]
    v_pk_mul_f32 v[228:229], v[228:229], s[50:51]
    v_pk_mul_f32 v[230:231], v[230:231], s[50:51]
    v_pk_mul_f32 v[232:233], v[232:233], s[50:51]
    v_pk_mul_f32 v[234:235], v[234:235], s[50:51]
    v_pk_mul_f32 v[236:237], v[236:237], s[50:51]
    v_pk_mul_f32 v[238:239], v[238:239], s[50:51]
    v_mfma_f32_16x16x32_bf16 a[4:7], a[180:183], a[108:111], a[4:7]
    ds_read_b64_tr_b16 a[206:207], v10 offset:3072
    v_cvt_pk_bf16_f32 v192, v208, v209
    v_exp_f32 v224, v224
    v_mfma_f32_16x16x32_bf16 a[4:7], a[184:187], a[112:115], a[4:7]
    v_cvt_pk_bf16_f32 v193, v210, v211
    v_exp_f32 v225, v225
    v_mfma_f32_16x16x32_bf16 a[8:11], a[180:183], a[116:119], a[8:11]
    ds_read_b64_tr_b16 a[208:209], v10 offset:6144
    v_cvt_pk_bf16_f32 v194, v212, v213
    v_exp_f32 v226, v226
    v_mfma_f32_16x16x32_bf16 a[8:11], a[184:187], a[120:123], a[8:11]
    v_cvt_pk_bf16_f32 v195, v214, v215
    v_exp_f32 v227, v227
    v_mfma_f32_16x16x32_bf16 a[12:15], a[180:183], a[124:127], a[12:15]
    ds_read_b64_tr_b16 a[210:211], v10 offset:9216
    v_cvt_pk_bf16_f32 v200, v216, v217
    v_exp_f32 v228, v228
    v_mfma_f32_16x16x32_bf16 a[12:15], a[184:187], a[128:131], a[12:15]
    s_barrier
    s_waitcnt lgkmcnt(8)
    s_lshl3_add_u32 s38, s6, s44
    v_cvt_pk_bf16_f32 v201, v218, v219
    v_exp_f32 v229, v229
    v_mfma_f32_16x16x32_bf16 a[0:3], a[188:191], a[224:227], a[0:3]
    ds_read_b64_tr_b16 a[180:181], v2 offset:64
    v_cvt_pk_bf16_f32 v202, v220, v221
    v_exp_f32 v230, v230
    v_mfma_f32_16x16x32_bf16 a[0:3], a[192:195], a[228:231], a[0:3]
    s_add_u32 m0, s56, 32768
    v_cvt_pk_bf16_f32 v203, v222, v223
    v_exp_f32 v231, v231
    v_mfma_f32_16x16x32_bf16 a[4:7], a[188:191], a[232:235], a[4:7]
    ds_read_b64_tr_b16 a[182:183], v2 offset:3136
    v_permlane16_swap_b32 v192, v194
    v_mfma_f32_16x16x32_bf16 a[4:7], a[192:195], a[236:239], a[4:7]
    buffer_load_dwordx4 v16, s[8:11], s38 offen offset:0 lds
    v_exp_f32 v232, v232
    v_mfma_f32_16x16x32_bf16 a[8:11], a[188:191], a[240:243], a[8:11]
    ds_read_b64_tr_b16 a[184:185], v2 offset:6208
    v_permlane16_swap_b32 v193, v195
    v_mfma_f32_16x16x32_bf16 a[8:11], a[192:195], a[244:247], a[8:11]
    v_exp_f32 v233, v233
    v_exp_f32 v234, v234
    v_mfma_f32_16x16x32_bf16 a[12:15], a[188:191], a[248:251], a[12:15]
    ds_read_b64_tr_b16 a[186:187], v2 offset:9280
    v_permlane16_swap_b32 v200, v202
    v_mfma_f32_16x16x32_bf16 a[12:15], a[192:195], a[252:255], a[12:15]
    s_waitcnt lgkmcnt(8)
    v_exp_f32 v235, v235
    v_permlane16_swap_b32 v201, v203
    v_mfma_f32_16x16x32_bf16 a[16:19], a[196:199], a[100:103], a[16:19]
    ds_read_b64_tr_b16 a[188:189], v9 offset:64
    v_exp_f32 v236, v236
    v_mfma_f32_16x16x32_bf16 a[16:19], a[200:203], a[104:107], a[16:19]
    buffer_store_dwordx4 v[192:195], v26, s[28:31], s74 offen offset:0 sc1
    v_exp_f32 v237, v237
    v_mfma_f32_16x16x32_bf16 a[20:23], a[196:199], a[108:111], a[20:23]
    ds_read_b64_tr_b16 a[190:191], v9 offset:3136
    v_exp_f32 v238, v238
    v_exp_f32 v239, v239
    v_pk_add_f32 v[224:225], v[224:225], s[52:53]
    v_pk_add_f32 v[226:227], v[226:227], s[52:53]
    v_pk_add_f32 v[228:229], v[228:229], s[52:53]
    v_pk_add_f32 v[230:231], v[230:231], s[52:53]
    v_pk_add_f32 v[232:233], v[232:233], s[52:53]
    v_pk_add_f32 v[234:235], v[234:235], s[52:53]
    v_pk_add_f32 v[236:237], v[236:237], s[52:53]
    v_pk_add_f32 v[238:239], v[238:239], s[52:53]
    v_mfma_f32_16x16x32_bf16 a[20:23], a[200:203], a[112:115], a[20:23]
    v_rcp_f32 v224, v224
    v_rcp_f32 v225, v225
    v_mfma_f32_16x16x32_bf16 a[24:27], a[196:199], a[116:119], a[24:27]
    ds_read_b64_tr_b16 a[192:193], v9 offset:6208
    v_rcp_f32 v226, v226
    v_mfma_f32_16x16x32_bf16 a[24:27], a[200:203], a[120:123], a[24:27]
    buffer_store_dwordx4 v[200:203], v26, s[28:31], s74 offen offset:2048 sc1
    v_rcp_f32 v227, v227
    v_mfma_f32_16x16x32_bf16 a[28:31], a[196:199], a[124:127], a[28:31]
    ds_read_b64_tr_b16 a[194:195], v9 offset:9280
    v_rcp_f32 v228, v228
    v_mfma_f32_16x16x32_bf16 a[28:31], a[200:203], a[128:131], a[28:31]
    s_waitcnt lgkmcnt(8)
    s_add_u32 s74, s74, 8192
    v_rcp_f32 v229, v229
    v_mfma_f32_16x16x32_bf16 a[16:19], a[204:207], a[224:227], a[16:19]
    ds_read_b64_tr_b16 a[196:197], v3 offset:64
    v_rcp_f32 v230, v230
    v_mfma_f32_16x16x32_bf16 a[16:19], a[208:211], a[228:231], a[16:19]
    v_rcp_f32 v231, v231
    v_rcp_f32 v232, v232
    v_mfma_f32_16x16x32_bf16 a[20:23], a[204:207], a[232:235], a[20:23]
    ds_read_b64_tr_b16 a[198:199], v3 offset:3136
    v_rcp_f32 v233, v233
    v_mfma_f32_16x16x32_bf16 a[20:23], a[208:211], a[236:239], a[20:23]
    buffer_load_dwordx4 v17, s[8:11], s38 offen offset:1024 lds
    v_rcp_f32 v234, v234
    v_mfma_f32_16x16x32_bf16 a[24:27], a[204:207], a[240:243], a[24:27]
    ds_read_b64_tr_b16 a[200:201], v3 offset:6208
    v_rcp_f32 v235, v235
    v_mfma_f32_16x16x32_bf16 a[24:27], a[208:211], a[244:247], a[24:27]
    v_rcp_f32 v236, v236
    v_rcp_f32 v237, v237
    v_mfma_f32_16x16x32_bf16 a[28:31], a[204:207], a[248:251], a[28:31]
    ds_read_b64_tr_b16 a[202:203], v3 offset:9280
    v_rcp_f32 v238, v238
    v_rcp_f32 v239, v239
    v_pk_mul_f32 v[240:241], v[240:241], v[224:225]
    v_pk_mul_f32 v[242:243], v[242:243], v[226:227]
    v_pk_mul_f32 v[244:245], v[244:245], v[228:229]
    v_pk_mul_f32 v[246:247], v[246:247], v[230:231]
    v_pk_mul_f32 v[248:249], v[248:249], v[232:233]
    v_pk_mul_f32 v[250:251], v[250:251], v[234:235]
    v_pk_mul_f32 v[252:253], v[252:253], v[236:237]
    v_pk_mul_f32 v[254:255], v[254:255], v[238:239]
    v_mfma_f32_16x16x32_bf16 a[28:31], a[208:211], a[252:255], a[28:31]
    s_waitcnt lgkmcnt(8)
    v_cvt_pk_bf16_f32 v224, v240, v241
    v_cvt_pk_bf16_f32 v225, v242, v243
    v_cvt_pk_bf16_f32 v226, v244, v245
    v_mfma_f32_16x16x32_bf16 a[32:35], a[180:183], a[100:103], a[32:35]
    ds_read_b64_tr_b16 a[204:205], v10 offset:64
    v_cvt_pk_bf16_f32 v227, v246, v247
    v_cvt_pk_bf16_f32 v232, v248, v249
    v_mfma_f32_16x16x32_bf16 a[32:35], a[184:187], a[104:107], a[32:35]
    buffer_load_dwordx4 v18, s[8:11], s38 offen offset:2048 lds
    v_cvt_pk_bf16_f32 v233, v250, v251
    v_cvt_pk_bf16_f32 v234, v252, v253
    v_mfma_f32_16x16x32_bf16 a[36:39], a[180:183], a[108:111], a[36:39]
    ds_read_b64_tr_b16 a[206:207], v10 offset:3136
    v_cvt_pk_bf16_f32 v235, v254, v255
    v_permlane16_swap_b32 v224, v226
    v_mfma_f32_16x16x32_bf16 a[36:39], a[184:187], a[112:115], a[36:39]
    v_permlane16_swap_b32 v225, v227
    v_permlane16_swap_b32 v232, v234
    v_mfma_f32_16x16x32_bf16 a[40:43], a[180:183], a[116:119], a[40:43]
    ds_read_b64_tr_b16 a[208:209], v10 offset:6208
    v_permlane16_swap_b32 v233, v235
    v_mfma_f32_16x16x32_bf16 a[40:43], a[184:187], a[120:123], a[40:43]
    buffer_store_dwordx4 v[224:227], v26, s[28:31], s73 offen offset:0 sc1
    v_accvgpr_read_b32 v208, a0
    v_accvgpr_read_b32 v209, a1
    v_mfma_f32_16x16x32_bf16 a[44:47], a[180:183], a[124:127], a[44:47]
    ds_read_b64_tr_b16 a[210:211], v10 offset:9280
    v_accvgpr_read_b32 v210, a2
    v_accvgpr_read_b32 v211, a3
    v_mfma_f32_16x16x32_bf16 a[44:47], a[184:187], a[128:131], a[44:47]
    s_waitcnt lgkmcnt(8)
    v_cvt_pk_bf16_f32 v60, v208, v209
    v_cvt_pk_bf16_f32 v61, v210, v211
    v_accvgpr_read_b32 v212, a4
    v_mfma_f32_16x16x32_bf16 a[32:35], a[188:191], a[224:227], a[32:35]
    ds_read_b64_tr_b16 a[180:181], v2 offset:128
    v_accvgpr_read_b32 v213, a5
    v_accvgpr_read_b32 v214, a6
    v_mfma_f32_16x16x32_bf16 a[32:35], a[192:195], a[228:231], a[32:35]
    buffer_store_dwordx4 v[232:235], v26, s[28:31], s73 offen offset:2048 sc1
    v_accvgpr_read_b32 v215, a7
    v_cvt_pk_bf16_f32 v64, v212, v213
    v_mfma_f32_16x16x32_bf16 a[36:39], a[188:191], a[232:235], a[36:39]
    ds_read_b64_tr_b16 a[182:183], v2 offset:3200
    v_cvt_pk_bf16_f32 v65, v214, v215
    v_accvgpr_read_b32 v216, a8
    v_mfma_f32_16x16x32_bf16 a[36:39], a[192:195], a[236:239], a[36:39]
    s_add_u32 s73, s73, 8192
    v_accvgpr_read_b32 v217, a9
    v_accvgpr_read_b32 v218, a10
    v_accvgpr_read_b32 v219, a11
    v_mfma_f32_16x16x32_bf16 a[40:43], a[188:191], a[240:243], a[40:43]
    ds_read_b64_tr_b16 a[184:185], v2 offset:6272
    v_cvt_pk_bf16_f32 v68, v216, v217
    v_cvt_pk_bf16_f32 v69, v218, v219
    v_mfma_f32_16x16x32_bf16 a[40:43], a[192:195], a[244:247], a[40:43]
    v_accvgpr_read_b32 v220, a12
    v_accvgpr_read_b32 v221, a13
    v_accvgpr_read_b32 v222, a14
    v_mfma_f32_16x16x32_bf16 a[44:47], a[188:191], a[248:251], a[44:47]
    ds_read_b64_tr_b16 a[186:187], v2 offset:9344
    v_accvgpr_read_b32 v223, a15
    v_cvt_pk_bf16_f32 v72, v220, v221
    v_mfma_f32_16x16x32_bf16 a[44:47], a[192:195], a[252:255], a[44:47]
    s_waitcnt lgkmcnt(8)
    v_cvt_pk_bf16_f32 v73, v222, v223
    v_accvgpr_read_b32 v208, a16
    v_accvgpr_read_b32 v209, a17
    v_mfma_f32_16x16x32_bf16 a[48:51], a[196:199], a[100:103], a[48:51]
    ds_read_b64_tr_b16 a[188:189], v9 offset:128
    v_accvgpr_read_b32 v210, a18
    v_accvgpr_read_b32 v211, a19
    v_mfma_f32_16x16x32_bf16 a[48:51], a[200:203], a[104:107], a[48:51]
    buffer_load_dwordx4 v19, s[8:11], s38 offen offset:3072 lds
    v_cvt_pk_bf16_f32 v62, v208, v209
    v_cvt_pk_bf16_f32 v63, v210, v211
    v_mfma_f32_16x16x32_bf16 a[52:55], a[196:199], a[108:111], a[52:55]
    ds_read_b64_tr_b16 a[190:191], v9 offset:3200
    v_accvgpr_read_b32 v212, a20
    v_accvgpr_read_b32 v213, a21
    v_mfma_f32_16x16x32_bf16 a[52:55], a[200:203], a[112:115], a[52:55]
    s_lshl3_add_u32 s38, s7, s44
    v_accvgpr_read_b32 v214, a22
    v_accvgpr_read_b32 v215, a23
    v_cvt_pk_bf16_f32 v66, v212, v213
    v_mfma_f32_16x16x32_bf16 a[56:59], a[196:199], a[116:119], a[56:59]
    ds_read_b64_tr_b16 a[192:193], v9 offset:6272
    v_cvt_pk_bf16_f32 v67, v214, v215
    v_accvgpr_read_b32 v216, a24
    v_mfma_f32_16x16x32_bf16 a[56:59], a[200:203], a[120:123], a[56:59]
    s_add_u32 m0, s56, 49152
    v_accvgpr_read_b32 v217, a25
    v_accvgpr_read_b32 v218, a26
    v_accvgpr_read_b32 v219, a27
    v_mfma_f32_16x16x32_bf16 a[60:63], a[196:199], a[124:127], a[60:63]
    ds_read_b64_tr_b16 a[194:195], v9 offset:9344
    v_cvt_pk_bf16_f32 v70, v216, v217
    v_cvt_pk_bf16_f32 v71, v218, v219
    v_mfma_f32_16x16x32_bf16 a[60:63], a[200:203], a[128:131], a[60:63]
    s_waitcnt lgkmcnt(8)
    v_accvgpr_read_b32 v220, a28
    v_accvgpr_read_b32 v221, a29
    v_accvgpr_read_b32 v222, a30
    v_mfma_f32_16x16x32_bf16 a[48:51], a[204:207], a[224:227], a[48:51]
    ds_read_b64_tr_b16 a[196:197], v3 offset:128
    v_accvgpr_read_b32 v223, a31
    v_cvt_pk_bf16_f32 v74, v220, v221
    v_mfma_f32_16x16x32_bf16 a[48:51], a[208:211], a[228:231], a[48:51]
    buffer_load_dwordx4 v16, s[8:11], s38 offen offset:0 lds
    v_cvt_pk_bf16_f32 v75, v222, v223
    v_accvgpr_read_b32 v208, a32
    v_mfma_f32_16x16x32_bf16 a[52:55], a[204:207], a[232:235], a[52:55]
    ds_read_b64_tr_b16 a[198:199], v3 offset:3200
    v_accvgpr_read_b32 v209, a33
    v_accvgpr_read_b32 v210, a34
    v_mfma_f32_16x16x32_bf16 a[52:55], a[208:211], a[236:239], a[52:55]
    v_accvgpr_read_b32 v211, a35
    v_cvt_pk_bf16_f32 v80, v208, v209
    v_cvt_pk_bf16_f32 v81, v210, v211
    v_mfma_f32_16x16x32_bf16 a[56:59], a[204:207], a[240:243], a[56:59]
    ds_read_b64_tr_b16 a[200:201], v3 offset:6272
    v_accvgpr_read_b32 v212, a36
    v_accvgpr_read_b32 v213, a37
    v_mfma_f32_16x16x32_bf16 a[56:59], a[208:211], a[244:247], a[56:59]
    v_accvgpr_read_b32 v214, a38
    v_accvgpr_read_b32 v215, a39
    v_cvt_pk_bf16_f32 v84, v212, v213
    v_mfma_f32_16x16x32_bf16 a[60:63], a[204:207], a[248:251], a[60:63]
    ds_read_b64_tr_b16 a[202:203], v3 offset:9344
    v_cvt_pk_bf16_f32 v85, v214, v215
    v_accvgpr_read_b32 v216, a40
    v_mfma_f32_16x16x32_bf16 a[60:63], a[208:211], a[252:255], a[60:63]
    s_waitcnt lgkmcnt(8)
    v_accvgpr_read_b32 v217, a41
    v_accvgpr_read_b32 v218, a42
    v_accvgpr_read_b32 v219, a43
    v_mfma_f32_16x16x32_bf16 a[64:67], a[100:103], a[180:183], a[64:67]
    ds_read_b64_tr_b16 a[204:205], v10 offset:128
    v_cvt_pk_bf16_f32 v88, v216, v217
    v_cvt_pk_bf16_f32 v89, v218, v219
    v_mfma_f32_16x16x32_bf16 a[64:67], a[104:107], a[184:187], a[64:67]
    buffer_load_dwordx4 v17, s[8:11], s38 offen offset:1024 lds
    v_accvgpr_read_b32 v220, a44
    v_accvgpr_read_b32 v221, a45
    v_mfma_f32_16x16x32_bf16 a[68:71], a[108:111], a[180:183], a[68:71]
    ds_read_b64_tr_b16 a[206:207], v10 offset:3200
    v_accvgpr_read_b32 v222, a46
    v_accvgpr_read_b32 v223, a47
    v_mfma_f32_16x16x32_bf16 a[68:71], a[112:115], a[184:187], a[68:71]
    v_cvt_pk_bf16_f32 v92, v220, v221
    v_cvt_pk_bf16_f32 v93, v222, v223
    v_accvgpr_read_b32 v208, a48
    v_mfma_f32_16x16x32_bf16 a[72:75], a[116:119], a[180:183], a[72:75]
    ds_read_b64_tr_b16 a[208:209], v10 offset:6272
    v_accvgpr_read_b32 v209, a49
    v_accvgpr_read_b32 v210, a50
    v_mfma_f32_16x16x32_bf16 a[72:75], a[120:123], a[184:187], a[72:75]
    v_accvgpr_read_b32 v211, a51
    v_cvt_pk_bf16_f32 v82, v208, v209
    v_cvt_pk_bf16_f32 v83, v210, v211
    v_mfma_f32_16x16x32_bf16 a[76:79], a[124:127], a[180:183], a[76:79]
    ds_read_b64_tr_b16 a[210:211], v10 offset:9344
    v_accvgpr_read_b32 v212, a52
    v_accvgpr_read_b32 v213, a53
    v_mfma_f32_16x16x32_bf16 a[76:79], a[128:131], a[184:187], a[76:79]
    s_waitcnt lgkmcnt(8)
    v_accvgpr_read_b32 v214, a54
    v_accvgpr_read_b32 v215, a55
    v_cvt_pk_bf16_f32 v86, v212, v213
    v_mfma_f32_16x16x32_bf16 a[64:67], a[224:227], a[188:191], a[64:67]
    buffer_load_dwordx4 v18, s[8:11], s38 offen offset:2048 lds
    v_cvt_pk_bf16_f32 v87, v214, v215
    v_accvgpr_read_b32 v216, a56
    v_mfma_f32_16x16x32_bf16 a[64:67], a[228:231], a[192:195], a[64:67]
    s_waitcnt vmcnt(4)
    buffer_store_dword v7, v13, s[84:87], s92 offen sc1
    v_accvgpr_read_b32 v217, a57
    v_mfma_f32_16x16x32_bf16 a[68:71], a[232:235], a[188:191], a[68:71]
    v_accvgpr_read_b32 v218, a58
    v_accvgpr_read_b32 v219, a59
    v_cvt_pk_bf16_f32 v90, v216, v217
    v_mfma_f32_16x16x32_bf16 a[68:71], a[236:239], a[192:195], a[68:71]
    v_cvt_pk_bf16_f32 v91, v218, v219
    v_accvgpr_read_b32 v220, a60
    v_accvgpr_read_b32 v221, a61
    v_mfma_f32_16x16x32_bf16 a[72:75], a[240:243], a[188:191], a[72:75]
    v_accvgpr_read_b32 v222, a62
    v_accvgpr_read_b32 v223, a63
    v_cvt_pk_bf16_f32 v94, v220, v221
    v_mfma_f32_16x16x32_bf16 a[72:75], a[244:247], a[192:195], a[72:75]
    buffer_load_dwordx4 v19, s[8:11], s38 offen offset:3072 lds
    v_cvt_pk_bf16_f32 v95, v222, v223
    v_mfma_f32_16x16x32_bf16 a[76:79], a[248:251], a[188:191], a[76:79]
    s_add_u32 m0, s56, 4294926336
    v_mfma_f32_16x16x32_bf16 a[76:79], a[252:255], a[192:195], a[76:79]
    s_waitcnt lgkmcnt(4)
    s_bfe_u32 s38, s80, 0x4001c
    s_lshl_b32 s38, s38, 18
    s_add_u32 s38, s38, 0
    v_mfma_f32_16x16x32_bf16 a[80:83], a[100:103], a[196:199], a[80:83]
    v_mfma_f32_16x16x32_bf16 a[80:83], a[104:107], a[200:203], a[80:83]
    buffer_load_dword v12, v5, s[84:87], s34 offen sc1
    v_accvgpr_read_b32 v208, a64
    v_accvgpr_read_b32 v209, a65
    v_mfma_f32_16x16x32_bf16 a[84:87], a[108:111], a[196:199], a[84:87]
    buffer_load_dwordx4 v30, s[12:15], s38 offen offset:0 lds
    v_accvgpr_read_b32 v210, a66
    v_accvgpr_read_b32 v211, a67
    v_mfma_f32_16x16x32_bf16 a[84:87], a[112:115], a[200:203], a[84:87]
    s_bfe_u32 s38, s80, 0x4001c
    s_lshl_b32 s38, s38, 18
    s_add_u32 s38, s38, 15360
    v_cvt_pk_bf16_f32 v114, v208, v209
    v_cvt_pk_bf16_f32 v115, v210, v211
    v_accvgpr_read_b32 v212, a68
    v_mfma_f32_16x16x32_bf16 a[88:91], a[116:119], a[196:199], a[88:91]
    v_accvgpr_read_b32 v213, a69
    v_accvgpr_read_b32 v214, a70
    v_accvgpr_read_b32 v215, a71
    v_mfma_f32_16x16x32_bf16 a[88:91], a[120:123], a[200:203], a[88:91]
    v_cvt_pk_bf16_f32 v116, v212, v213
    v_cvt_pk_bf16_f32 v117, v214, v215
    v_accvgpr_read_b32 v216, a72
    v_mfma_f32_16x16x32_bf16 a[92:95], a[124:127], a[196:199], a[92:95]
    v_accvgpr_read_b32 v217, a73
    v_accvgpr_read_b32 v218, a74
    v_accvgpr_read_b32 v219, a75
    v_mfma_f32_16x16x32_bf16 a[92:95], a[128:131], a[200:203], a[92:95]
    s_waitcnt lgkmcnt(0)
    v_cvt_pk_bf16_f32 v118, v216, v217
    v_cvt_pk_bf16_f32 v119, v218, v219
    v_accvgpr_read_b32 v220, a76
    v_mfma_f32_16x16x32_bf16 a[80:83], a[224:227], a[204:207], a[80:83]
    buffer_load_dwordx4 v30, s[12:15], s38 offen offset:1024 lds
    v_accvgpr_read_b32 v221, a77
    v_accvgpr_read_b32 v222, a78
    v_mfma_f32_16x16x32_bf16 a[80:83], a[228:231], a[208:211], a[80:83]
    s_bfe_u32 s38, s80, 0x4001c
    s_lshl_b32 s38, s38, 18
    s_add_u32 s38, s38, 30720
    v_accvgpr_read_b32 v223, a79
    v_cvt_pk_bf16_f32 v120, v220, v221
    v_cvt_pk_bf16_f32 v121, v222, v223
    v_mfma_f32_16x16x32_bf16 a[84:87], a[232:235], a[204:207], a[84:87]
    v_mfma_f32_16x16x32_bf16 a[84:87], a[236:239], a[208:211], a[84:87]
    v_mfma_f32_16x16x32_bf16 a[88:91], a[240:243], a[204:207], a[88:91]
    v_mfma_f32_16x16x32_bf16 a[88:91], a[244:247], a[208:211], a[88:91]
    buffer_load_dwordx4 v30, s[12:15], s38 offen offset:2048 lds
    v_mfma_f32_16x16x32_bf16 a[92:95], a[248:251], a[204:207], a[92:95]
    s_bfe_u32 s38, s80, 0x4001c
    s_lshl_b32 s38, s38, 18
    s_add_u32 s38, s38, 46080
    v_mfma_f32_16x16x32_bf16 a[92:95], a[252:255], a[208:211], a[92:95]
    s_nop 1
    s_nop 1
    v_mfma_f32_16x16x32_bf16 v[188:191], v[84:87], v[64:67], 0
    v_mfma_f32_16x16x32_bf16 v[184:187], v[80:83], v[64:67], 0
    v_mfma_f32_16x16x32_bf16 v[196:199], v[88:91], v[68:71], 0
    v_mfma_f32_16x16x32_bf16 v[192:195], v[84:87], v[68:71], 0
    v_mfma_f32_16x16x32_bf16 v[204:207], v[92:95], v[72:75], 0
    v_mfma_f32_16x16x32_bf16 v[200:203], v[88:91], v[72:75], 0
    v_mfma_f32_16x16x32_bf16 v[180:183], v[80:83], v[60:63], 0
    v_accvgpr_read_b32 v136, a96
    v_accvgpr_read_b32 v137, a97
    v_accvgpr_read_b32 v138, a98
    v_accvgpr_read_b32 v139, a99
    v_cvt_pk_bf16_f32 v132, v136, v137
    v_cvt_pk_bf16_f32 v133, v138, v139
    v_add_u32 v134, s71, v24
    v_add_u32 v135, s71, v134
    v_add_u32 v140, s71, v135
    ds_write_b16 v24, v132
    ds_write_b16_d16_hi v134, v132
    ds_write_b16 v135, v133
    ds_write_b16_d16_hi v140, v133
    v_accvgpr_read_b32 v208, a92
    v_accvgpr_read_b32 v209, a93
    v_accvgpr_read_b32 v210, a94
    v_accvgpr_read_b32 v211, a95
    v_cvt_pk_bf16_f32 v130, v208, v209
    v_cvt_pk_bf16_f32 v131, v210, v211
    s_cmp_eq_u32 s32, 3
    s_cbranch_scc1 L_noexp
    ds_write_b128 v25, v[92:95] offset:2048
    ds_write_b64 v25, v[120:121] offset:3072
    ds_write_b64 v25, v[130:131] offset:3080
L_noexp:
    v_accvgpr_read_b32 v216, a88
    v_accvgpr_read_b32 v217, a89
    v_accvgpr_read_b32 v218, a90
    v_accvgpr_read_b32 v219, a91
    v_cvt_pk_bf16_f32 v128, v216, v217
    v_cvt_pk_bf16_f32 v129, v218, v219
    v_accvgpr_read_b32 v212, a84
    v_accvgpr_read_b32 v213, a85
    v_accvgpr_read_b32 v214, a86
    v_accvgpr_read_b32 v215, a87
    v_cvt_pk_bf16_f32 v126, v212, v213
    v_cvt_pk_bf16_f32 v127, v214, v215
    s_waitcnt lgkmcnt(0)
    s_barrier
    ds_read_b128 v[76:79], v25
    ds_read_b64 v[112:113], v25 offset:1024
    ds_read_b64 v[122:123], v25 offset:1032
    v_accvgpr_read_b32 v208, a80
    v_accvgpr_read_b32 v209, a81
    v_accvgpr_read_b32 v210, a82
    v_accvgpr_read_b32 v211, a83
    v_cvt_pk_bf16_f32 v124, v208, v209
    v_cvt_pk_bf16_f32 v125, v210, v211
    v_add_u32 v52, s95, v15
    v_add_u32 v53, 8192, v52
    v_add_u32 v54, 16384, v52
    v_add_u32 v55, 24576, v52
    v_xor_b32 v56, 0x800, v52
    v_xor_b32 v57, 0x800, v53
    v_mov_b32 v11, 0xce6e6b28
    s_waitcnt lgkmcnt(0)
    v_mfma_f32_16x16x32_bf16 v[176:179], v[76:79], v[60:63], 0
    s_waitcnt vmcnt(3)
    v_cmp_ne_u32 vcc, s96, v12
    s_nop 0
    s_cmp_eq_u64 vcc, 0
    s_cselect_b32 s60, s46, 1073741824
    buffer_load_dwordx4 v30, s[12:15], s38 offen offset:3072 lds
    s_add_u32 s39, s60, s4
    buffer_load_dwordx4 a[0:3], v52, s[28:31], s39 offen offset:0 sc1
    buffer_load_dwordx4 a[4:7], v52, s[28:31], s39 offen offset:1024 sc1
    v_cndmask_b32 v204, v204, v205, s[62:63]
    v_cndmask_b32 v206, v206, v207, s[62:63]
    v_cndmask_b32 v200, v200, v201, s[62:63]
    v_cndmask_b32 v202, v202, v203, s[62:63]
    v_cndmask_b32 v196, v196, v197, s[62:63]
    v_cndmask_b32 v198, v198, v199, s[62:63]
    v_cndmask_b32 v192, v192, v193, s[62:63]
    v_cndmask_b32 v194, v194, v195, s[62:63]
    v_cndmask_b32 v188, v188, v189, s[62:63]
    v_cndmask_b32 v190, v190, v191, s[62:63]
    buffer_load_dwordx4 a[8:11], v56, s[28:31], s39 offen offset:0 sc1
    v_cndmask_b32 v184, v184, v185, s[62:63]
    v_cndmask_b32 v186, v186, v187, s[62:63]
    v_cndmask_b32 v180, v180, v181, s[62:63]
    v_cndmask_b32 v182, v182, v183, s[62:63]
    v_cndmask_b32 v176, v176, v177, s[62:63]
    v_cndmask_b32 v178, v178, v179, s[62:63]
    v_cndmask_b32 v220, v200, v204, s[40:41]
    v_cndmask_b32 v221, v202, v206, s[42:43]
    v_cndmask_b32 v216, v192, v196, s[40:41]
    v_cndmask_b32 v217, v194, v198, s[42:43]
    buffer_load_dwordx4 a[12:15], v56, s[28:31], s39 offen offset:1024 sc1
    v_cndmask_b32 v212, v184, v188, s[40:41]
    v_cndmask_b32 v213, v186, v190, s[42:43]
    v_cndmask_b32 v208, v176, v180, s[40:41]
    v_cndmask_b32 v209, v178, v182, s[42:43]
    v_cvt_pk_bf16_f32 v222, v220, v221
    v_cvt_pk_bf16_f32 v218, v216, v217
    v_cvt_pk_bf16_f32 v214, v212, v213
    v_cvt_pk_bf16_f32 v210, v208, v209
    v_lshlrev_b32 v220, 16, v222
    v_and_b32 v221, s54, v222
    buffer_load_dwordx4 a[16:19], v53, s[28:31], s39 offen offset:0 sc1
    v_lshlrev_b32 v216, 16, v218
    v_and_b32 v217, s54, v218
    v_lshlrev_b32 v212, 16, v214
    v_and_b32 v213, s54, v214
    v_lshlrev_b32 v208, 16, v210
    v_and_b32 v209, s54, v210
    v_pk_mul_f32 v[220:221], v[220:221], s[48:49] op_sel_hi:[1,0]
    v_pk_mul_f32 v[216:217], v[216:217], s[48:49] op_sel_hi:[1,0]
    v_pk_mul_f32 v[212:213], v[212:213], s[48:49] op_sel_hi:[1,0]
    v_pk_mul_f32 v[208:209], v[208:209], s[48:49] op_sel_hi:[1,0]
    buffer_load_dwordx4 a[20:23], v53, s[28:31], s39 offen offset:1024 sc1
    v_cvt_pk_bf16_f32 v222, v220, v221
    v_cvt_pk_bf16_f32 v218, v216, v217
    v_cvt_pk_bf16_f32 v214, v212, v213
    v_cvt_pk_bf16_f32 v210, v208, v209
    v_lshlrev_b32 v220, 16, v222
    v_and_b32 v221, s54, v222
    v_lshlrev_b32 v216, 16, v218
    v_and_b32 v217, s54, v218
    v_lshlrev_b32 v212, 16, v214
    v_and_b32 v213, s54, v214
    buffer_load_dwordx4 a[24:27], v57, s[28:31], s39 offen offset:0 sc1
    v_lshlrev_b32 v208, 16, v210
    v_and_b32 v209, s54, v210
    v_cndmask_b32 v208, v208, v11, s[88:89]
    v_cndmask_b32 v209, v209, v11, s[90:91]
    v_max_f32 v222, v220, v221
    v_max_f32 v218, v216, v217
    v_max_f32 v214, v212, v213
    v_max_f32 v210, v208, v209
    v_mov_b32 v223, v222
    v_mov_b32 v219, v218
    buffer_load_dwordx4 a[28:31], v57, s[28:31], s39 offen offset:1024 sc1
    v_mov_b32 v215, v214
    v_mov_b32 v211, v210
    v_accvgpr_read_b32 v32, a220
    v_xor_b32 v33, 32, v32
    v_permlane16_swap_b32 v222, v223
    v_permlane16_swap_b32 v218, v219
    v_permlane16_swap_b32 v214, v215
    v_permlane16_swap_b32 v210, v211
    v_xor_b32 v34, 64, v32
    v_max_f32 v222, v222, v223
    s_add_u32 s39, s60, s5
    buffer_load_dwordx4 a[32:35], v52, s[28:31], s39 offen offset:0 sc1
    v_max_f32 v218, v218, v219
    v_max_f32 v214, v214, v215
    v_max_f32 v210, v210, v211
    v_mov_b32 v223, v222
    v_mov_b32 v219, v218
    v_mov_b32 v215, v214
    v_mov_b32 v211, v210
    v_xor_b32 v35, 96, v32
    v_xor_b32 v36, 128, v32
    v_permlane32_swap_b32 v222, v223
    buffer_load_dwordx4 a[36:39], v52, s[28:31], s39 offen offset:1024 sc1
    v_permlane32_swap_b32 v218, v219
    v_permlane32_swap_b32 v214, v215
    v_permlane32_swap_b32 v210, v211
    v_xor_b32 v37, 160, v32
    v_max_f32 v222, v222, v223
    v_max_f32 v218, v218, v219
    v_max_f32 v214, v214, v215
    v_max_f32 v210, v210, v211
    v_pk_add_f32 v[220:221], v[220:221], v[222:223] op_sel_hi:[1,0] neg_lo:[0,1] neg_hi:[0,1]
    v_pk_add_f32 v[216:217], v[216:217], v[218:219] op_sel_hi:[1,0] neg_lo:[0,1] neg_hi:[0,1]
    buffer_load_dwordx4 a[40:43], v56, s[28:31], s39 offen offset:0 sc1
    v_pk_add_f32 v[212:213], v[212:213], v[214:215] op_sel_hi:[1,0] neg_lo:[0,1] neg_hi:[0,1]
    v_pk_add_f32 v[208:209], v[208:209], v[210:211] op_sel_hi:[1,0] neg_lo:[0,1] neg_hi:[0,1]
    v_pk_mul_f32 v[220:221], v[220:221], s[48:49] op_sel:[0,1]
    v_pk_mul_f32 v[216:217], v[216:217], s[48:49] op_sel:[0,1]
    v_pk_mul_f32 v[212:213], v[212:213], s[48:49] op_sel:[0,1]
    v_pk_mul_f32 v[208:209], v[208:209], s[48:49] op_sel:[0,1]
    v_exp_f32 v220, v220
    v_exp_f32 v221, v221
    v_exp_f32 v216, v216
    v_exp_f32 v217, v217
    buffer_load_dwordx4 a[44:47], v56, s[28:31], s39 offen offset:1024 sc1
    v_exp_f32 v212, v212
    v_exp_f32 v213, v213
    v_exp_f32 v208, v208
    v_exp_f32 v209, v209
    v_xor_b32 v38, 192, v32
    v_add_f32 v222, v220, v221
    v_add_f32 v218, v216, v217
    v_add_f32 v214, v212, v213
    v_add_f32 v210, v208, v209
    v_mov_b32 v223, v222
    buffer_load_dwordx4 a[48:51], v53, s[28:31], s39 offen offset:0 sc1
    v_mov_b32 v219, v218
    v_mov_b32 v215, v214
    v_mov_b32 v211, v210
    v_xor_b32 v39, 224, v32
    v_accvgpr_read_b32 v20, a221
    v_permlane16_swap_b32 v222, v223
    v_permlane16_swap_b32 v218, v219
    v_permlane16_swap_b32 v214, v215
    v_permlane16_swap_b32 v210, v211
    v_xor_b32 v21, 32, v20
    buffer_load_dwordx4 a[52:55], v53, s[28:31], s39 offen offset:1024 sc1
    v_add_f32 v222, v222, v223
    v_add_f32 v218, v218, v219
    v_add_f32 v214, v214, v215
    v_add_f32 v210, v210, v211
    v_mov_b32 v223, v222
    v_mov_b32 v219, v218
    v_mov_b32 v215, v214
    v_mov_b32 v211, v210
    v_xor_b32 v22, 64, v20
    v_xor_b32 v23, 96, v20
    buffer_load_dwordx4 a[56:59], v57, s[28:31], s39 offen offset:0 sc1
    v_permlane32_swap_b32 v222, v223
    v_permlane32_swap_b32 v218, v219
    v_permlane32_swap_b32 v214, v215
    v_permlane32_swap_b32 v210, v211
    v_subrev_u32 v40, 40960, v20
    v_add_f32 v222, v222, v223
    v_add_f32 v218, v218, v219
    v_add_f32 v214, v214, v215
    v_add_f32 v210, v210, v211
    v_rcp_f32 v222, v222
    buffer_load_dwordx4 a[60:63], v57, s[28:31], s39 offen offset:1024 sc1
    v_rcp_f32 v218, v218
    v_rcp_f32 v214, v214
    v_rcp_f32 v210, v210
    v_subrev_u32 v41, 40960, v21
    v_pk_mul_f32 v[220:221], v[220:221], v[222:223] op_sel_hi:[1,0]
    v_pk_mul_f32 v[216:217], v[216:217], v[218:219] op_sel_hi:[1,0]
    v_pk_mul_f32 v[212:213], v[212:213], v[214:215] op_sel_hi:[1,0]
    v_pk_mul_f32 v[208:209], v[208:209], v[210:211] op_sel_hi:[1,0]
    v_cvt_pk_bf16_f32 v222, v220, v221
    v_cvt_pk_bf16_f32 v218, v216, v217
    v_cvt_pk_bf16_f32 v214, v212, v213
    v_cvt_pk_bf16_f32 v210, v208, v209
    v_and_b32 v220, 0xffff, v222
    v_lshrrev_b32 v221, 16, v222
    v_and_b32 v216, 0xffff, v218
    v_lshrrev_b32 v217, 16, v218
    v_and_b32 v212, 0xffff, v214
    v_lshrrev_b32 v213, 16, v214
    v_and_b32 v208, 0xffff, v210
    v_lshrrev_b32 v209, 16, v210
    v_lshlrev_b32 v220, v27, v220
    v_lshlrev_b32 v221, v27, v221
    v_lshlrev_b32 v216, v27, v216
    v_lshlrev_b32 v217, v27, v217
    v_lshlrev_b32 v212, v27, v212
    v_lshlrev_b32 v213, v27, v213
    v_lshlrev_b32 v208, v27, v208
    v_lshlrev_b32 v209, v27, v209
    v_cndmask_b32 v144, v220, 0, s[40:41]
    v_cndmask_b32 v145, v221, 0, s[42:43]
    v_cndmask_b32 v146, 0, v220, s[40:41]
    v_cndmask_b32 v147, 0, v221, s[42:43]
    v_cndmask_b32 v140, v216, 0, s[40:41]
    v_cndmask_b32 v141, v217, 0, s[42:43]
    v_cndmask_b32 v142, 0, v216, s[40:41]
    v_cndmask_b32 v143, 0, v217, s[42:43]
    v_cndmask_b32 v136, v212, 0, s[40:41]
    v_cndmask_b32 v137, v213, 0, s[42:43]
    v_cndmask_b32 v138, 0, v212, s[40:41]
    v_cndmask_b32 v139, 0, v213, s[42:43]
    v_cndmask_b32 v132, v208, 0, s[40:41]
    v_cndmask_b32 v133, v209, 0, s[42:43]
    v_cndmask_b32 v134, 0, v208, s[40:41]
    v_cndmask_b32 v135, 0, v209, s[42:43]
    v_subrev_u32 v42, 40960, v22
    v_subrev_u32 v43, 40960, v23
    v_add_u32 v44, 65536, v20
    v_add_u32 v45, 65536, v21
    v_add_u32 v46, 65536, v22
    v_add_u32 v47, 65536, v23
    v_accvgpr_read_b32 v2, a222
    v_mfma_f32_16x16x32_bf16 v[200:203], v[118:121], v[144:147], 0
    v_mfma_f32_16x16x32_bf16 v[204:207], v[128:131], v[144:147], 0
    v_mfma_f32_16x16x32_bf16 v[192:195], v[116:119], v[140:143], 0
    v_mfma_f32_16x16x32_bf16 v[196:199], v[126:129], v[140:143], 0
    v_mfma_f32_16x16x32_bf16 v[184:187], v[114:117], v[136:139], 0
    v_mfma_f32_16x16x32_bf16 v[188:191], v[124:127], v[136:139], 0
    v_mfma_f32_16x16x32_bf16 v[176:179], v[112:115], v[132:135], 0
    v_mfma_f32_16x16x32_bf16 v[180:183], v[122:125], v[132:135], 0
    ds_read_b64_tr_b16 a[128:129], v32 offset:0
    ds_read_b64_tr_b16 a[130:131], v32 offset:4096
    ds_read_b64_tr_b16 a[132:133], v32 offset:8192
    ds_read_b64_tr_b16 a[134:135], v32 offset:12288
    ds_read_b64_tr_b16 a[136:137], v33 offset:0
    ds_read_b64_tr_b16 a[138:139], v33 offset:4096
    ds_read_b64_tr_b16 a[140:141], v33 offset:8192
    ds_read_b64_tr_b16 a[142:143], v33 offset:12288
    ds_read_b64_tr_b16 a[144:145], v34 offset:0
    ds_read_b64_tr_b16 a[146:147], v34 offset:4096
    ds_read_b64_tr_b16 a[148:149], v34 offset:8192
    ds_read_b64_tr_b16 a[150:151], v34 offset:12288
    ds_read_b64_tr_b16 a[152:153], v35 offset:0
    ds_read_b64_tr_b16 a[154:155], v35 offset:4096
    ds_read_b64_tr_b16 a[156:157], v35 offset:8192
    ds_read_b64_tr_b16 a[158:159], v35 offset:12288
    v_cvt_pk_bf16_f32 v240, v176, v177
    v_cvt_pk_bf16_f32 v241, v178, v179
    v_cvt_pk_bf16_f32 v242, v180, v181
    v_cvt_pk_bf16_f32 v243, v182, v183
    v_cvt_pk_bf16_f32 v244, v184, v185
    v_cvt_pk_bf16_f32 v245, v186, v187
    v_cvt_pk_bf16_f32 v246, v188, v189
    v_cvt_pk_bf16_f32 v247, v190, v191
    v_cvt_pk_bf16_f32 v248, v192, v193
    v_cvt_pk_bf16_f32 v249, v194, v195
    v_cvt_pk_bf16_f32 v250, v196, v197
    v_cvt_pk_bf16_f32 v251, v198, v199
    v_cvt_pk_bf16_f32 v252, v200, v201
    v_cvt_pk_bf16_f32 v253, v202, v203
    v_cvt_pk_bf16_f32 v254, v204, v205
    v_cvt_pk_bf16_f32 v255, v206, v207
    s_waitcnt vmcnt(16)
    s_cmp_eq_u32 s60, s46
    s_cbranch_scc1 L_early
    s_mov_b32 s60, s46
    buffer_load_dword v12, v5, s[84:87], s34 offen sc1
    s_waitcnt vmcnt(0)
    v_cmp_ne_u32 vcc, s96, v12
    s_cbranch_vccz L_f1_ok
    s_mov_b32 s97, 0
L_f1_spin:
    s_sleep 1
    buffer_load_dword v12, v5, s[84:87], s34 offen sc1
    s_add_u32 s97, s97, 1
    s_waitcnt vmcnt(0)
    s_cmp_gt_u32 s97, 0x80000
    s_cbranch_scc1 L_f1_ok
    v_cmp_ne_u32 vcc, s96, v12
    s_cbranch_vccnz L_f1_spin
L_f1_ok:
    s_add_u32 s39, s60, s4
    buffer_load_dwordx4 a[0:3], v52, s[28:31], s39 offen offset:0 sc1
    buffer_load_dwordx4 a[4:7], v52, s[28:31], s39 offen offset:1024 sc1
    buffer_load_dwordx4 a[8:11], v56, s[28:31], s39 offen offset:0 sc1
    buffer_load_dwordx4 a[12:15], v56, s[28:31], s39 offen offset:1024 sc1
    buffer_load_dwordx4 a[16:19], v53, s[28:31], s39 offen offset:0 sc1
    buffer_load_dwordx4 a[20:23], v53, s[28:31], s39 offen offset:1024 sc1
    buffer_load_dwordx4 a[24:27], v57, s[28:31], s39 offen offset:0 sc1
    buffer_load_dwordx4 a[28:31], v57, s[28:31], s39 offen offset:1024 sc1
    s_add_u32 s39, s60, s5
    buffer_load_dwordx4 a[32:35], v52, s[28:31], s39 offen offset:0 sc1
    buffer_load_dwordx4 a[36:39], v52, s[28:31], s39 offen offset:1024 sc1
    buffer_load_dwordx4 a[40:43], v56, s[28:31], s39 offen offset:0 sc1
    buffer_load_dwordx4 a[44:47], v56, s[28:31], s39 offen offset:1024 sc1
    buffer_load_dwordx4 a[48:51], v53, s[28:31], s39 offen offset:0 sc1
    buffer_load_dwordx4 a[52:55], v53, s[28:31], s39 offen offset:1024 sc1
    buffer_load_dwordx4 a[56:59], v57, s[28:31], s39 offen offset:0 sc1
    buffer_load_dwordx4 a[60:63], v57, s[28:31], s39 offen offset:1024 sc1
L_early:
    s_mov_b32 s16, s64
    s_mov_b32 s17, s65
    s_mov_b32 s18, 0x400000
    s_mov_b32 s19, 0x20000
    s_add_u32 s20, s82, 0x1800000
    s_addc_u32 s21, s83, 0
    s_mov_b32 s22, 0x1800000
    s_mov_b32 s23, 0x20000
    s_mov_b32 s24, s78
    s_mov_b32 s25, s79
    s_mov_b32 s26, 0x400000
    s_mov_b32 s27, 0x20000
    s_add_u32 s73, s72, 32768
    s_lshl2_add_u32 s74, s2, s32
    s_lshl_b32 s88, s74, 2
    s_add_u32 s88, s88, 262144
    s_lshl_b32 s74, s74, 14
    v_and_b32 v14, 0x30, v15
    v_max_u32 v14, 16, v14
    v_lshlrev_b32 v14, 1, v14
    v_xor_b32 v14, s88, v14
    s_add_u32 s89, s88, 4096
    s_mov_b32 s94, 4096
    s_mov_b32 s92, s35
    s_waitcnt vmcnt(8)
    s_waitcnt lgkmcnt(12)
    v_mfma_f32_16x16x32_bf16 v[96:99], a[128:131], a[8:11], 0
    ds_read_b64_tr_b16 a[160:161], v36 offset:0
    v_mfma_f32_16x16x32_bf16 v[96:99], a[132:135], a[24:27], v[96:99]
    ds_read_b64_tr_b16 a[162:163], v36 offset:4096
    v_mfma_f32_16x16x32_bf16 v[112:115], a[128:131], a[12:15], 0
    buffer_store_dwordx4 v[240:243], v15, s[28:31], s75 offen offset:0 sc1
    s_add_u32 s39, s46, s6
    v_mfma_f32_16x16x32_bf16 v[112:115], a[132:135], a[28:31], v[112:115]
    ds_read_b64_tr_b16 a[164:165], v36 offset:8192
    v_mfma_f32_16x16x32_bf16 v[64:67], a[128:131], a[0:3], 0
    ds_read_b64_tr_b16 a[166:167], v36 offset:12288
    v_mfma_f32_16x16x32_bf16 v[64:67], a[132:135], a[16:19], v[64:67]
    buffer_load_dwordx4 a[64:67], v52, s[28:31], s39 offen offset:0 sc1
    v_mfma_f32_16x16x32_bf16 v[80:83], a[128:131], a[4:7], 0
    ds_read_b64_tr_b16 a[168:169], v37 offset:0
    v_mfma_f32_16x16x32_bf16 v[80:83], a[132:135], a[20:23], v[80:83]
    s_waitcnt lgkmcnt(13)
    v_mfma_f32_16x16x32_bf16 v[100:103], a[136:139], a[8:11], 0
    ds_read_b64_tr_b16 a[170:171], v37 offset:4096
    v_mfma_f32_16x16x32_bf16 v[100:103], a[140:143], a[24:27], v[100:103]
    ds_read_b64_tr_b16 a[172:173], v37 offset:8192
    v_mfma_f32_16x16x32_bf16 v[116:119], a[136:139], a[12:15], 0
    buffer_load_dwordx4 a[68:71], v52, s[28:31], s39 offen offset:1024 sc1
    v_mfma_f32_16x16x32_bf16 v[116:119], a[140:143], a[28:31], v[116:119]
    ds_read_b64_tr_b16 a[174:175], v37 offset:12288
    v_mfma_f32_16x16x32_bf16 v[68:71], a[136:139], a[0:3], 0
    v_mfma_f32_16x16x32_bf16 v[68:71], a[140:143], a[16:19], v[68:71]
    ds_read_b64_tr_b16 a[176:177], v38 offset:0
    v_mfma_f32_16x16x32_bf16 v[84:87], a[136:139], a[4:7], 0
    ds_read_b64_tr_b16 a[178:179], v38 offset:4096
    v_mfma_f32_16x16x32_bf16 v[84:87], a[140:143], a[20:23], v[84:87]
    s_waitcnt lgkmcnt(10)
    buffer_load_dwordx4 a[72:75], v56, s[28:31], s39 offen offset:0 sc1
    v_mfma_f32_16x16x32_bf16 v[104:107], a[144:147], a[8:11], 0
    ds_read_b64_tr_b16 a[180:181], v38 offset:8192
    v_mfma_f32_16x16x32_bf16 v[104:107], a[148:151], a[24:27], v[104:107]
    ds_read_b64_tr_b16 a[182:183], v38 offset:12288
    v_mfma_f32_16x16x32_bf16 v[120:123], a[144:147], a[12:15], 0
    v_mfma_f32_16x16x32_bf16 v[120:123], a[148:151], a[28:31], v[120:123]
    ds_read_b64_tr_b16 a[184:185], v39 offset:0
    v_mfma_f32_16x16x32_bf16 v[72:75], a[144:147], a[0:3], 0
    buffer_load_dwordx4 a[76:79], v56, s[28:31], s39 offen offset:1024 sc1
    v_mfma_f32_16x16x32_bf16 v[72:75], a[148:151], a[16:19], v[72:75]
    ds_read_b64_tr_b16 a[186:187], v39 offset:4096
    v_mfma_f32_16x16x32_bf16 v[88:91], a[144:147], a[4:7], 0
    ds_read_b64_tr_b16 a[188:189], v39 offset:8192
    v_mfma_f32_16x16x32_bf16 v[88:91], a[148:151], a[20:23], v[88:91]
    v_mfma_f32_16x16x32_bf16 v[108:111], a[152:155], a[8:11], 0
    ds_read_b64_tr_b16 a[190:191], v39 offset:12288
    v_mfma_f32_16x16x32_bf16 v[108:111], a[156:159], a[24:27], v[108:111]
    buffer_load_dwordx4 a[80:83], v53, s[28:31], s39 offen offset:0 sc1
    v_mfma_f32_16x16x32_bf16 v[124:127], a[152:155], a[12:15], 0
    v_mfma_f32_16x16x32_bf16 v[124:127], a[156:159], a[28:31], v[124:127]
    v_mfma_f32_16x16x32_bf16 v[76:79], a[152:155], a[0:3], 0
    v_mfma_f32_16x16x32_bf16 v[76:79], a[156:159], a[16:19], v[76:79]
    buffer_load_dwordx4 a[84:87], v53, s[28:31], s39 offen offset:1024 sc1
    v_mfma_f32_16x16x32_bf16 v[92:95], a[152:155], a[4:7], 0
    v_mfma_f32_16x16x32_bf16 v[92:95], a[156:159], a[20:23], v[92:95]
    s_waitcnt lgkmcnt(0)
    s_barrier
    v_mfma_f32_16x16x32_bf16 v[128:131], a[160:163], a[8:11], 0
    ds_read_b64_tr_b16 a[128:129], v32 offset:16384
    s_lshl3_add_u32 s38, s36, s44
    v_mfma_f32_16x16x32_bf16 v[128:131], a[164:167], a[24:27], v[128:131]
    s_add_u32 m0, s56, 0
    s_nop 0
    buffer_load_dwordx4 v16, s[8:11], s38 offen offset:0 lds
    v_mfma_f32_16x16x32_bf16 v[144:147], a[160:163], a[12:15], 0
    ds_read_b64_tr_b16 a[130:131], v32 offset:20480
    v_mfma_f32_16x16x32_bf16 v[144:147], a[164:167], a[28:31], v[144:147]
    v_mfma_f32_16x16x32_bf16 v[160:163], a[160:163], a[0:3], 0
    ds_read_b64_tr_b16 a[132:133], v32 offset:24576
    v_mfma_f32_16x16x32_bf16 v[160:163], a[164:167], a[16:19], v[160:163]
    buffer_load_dwordx4 v17, s[8:11], s38 offen offset:1024 lds
    v_mfma_f32_16x16x32_bf16 v[176:179], a[160:163], a[4:7], 0
    ds_read_b64_tr_b16 a[134:135], v32 offset:28672
    v_mfma_f32_16x16x32_bf16 v[176:179], a[164:167], a[20:23], v[176:179]
    v_mfma_f32_16x16x32_bf16 v[132:135], a[168:171], a[8:11], 0
    ds_read_b64_tr_b16 a[136:137], v33 offset:16384
    v_mfma_f32_16x16x32_bf16 v[132:135], a[172:175], a[24:27], v[132:135]
    buffer_load_dwordx4 v18, s[8:11], s38 offen offset:2048 lds
    v_mfma_f32_16x16x32_bf16 v[148:151], a[168:171], a[12:15], 0
    ds_read_b64_tr_b16 a[138:139], v33 offset:20480
    v_mfma_f32_16x16x32_bf16 v[148:151], a[172:175], a[28:31], v[148:151]
    v_mfma_f32_16x16x32_bf16 v[164:167], a[168:171], a[0:3], 0
    ds_read_b64_tr_b16 a[140:141], v33 offset:24576
    v_mfma_f32_16x16x32_bf16 v[164:167], a[172:175], a[16:19], v[164:167]
    buffer_load_dwordx4 v19, s[8:11], s38 offen offset:3072 lds
    v_mfma_f32_16x16x32_bf16 v[180:183], a[168:171], a[4:7], 0
    ds_read_b64_tr_b16 a[142:143], v33 offset:28672
    v_mfma_f32_16x16x32_bf16 v[180:183], a[172:175], a[20:23], v[180:183]
    v_mfma_f32_16x16x32_bf16 v[136:139], a[176:179], a[8:11], 0
    ds_read_b64_tr_b16 a[144:145], v34 offset:16384
    v_mfma_f32_16x16x32_bf16 v[136:139], a[180:183], a[24:27], v[136:139]
    buffer_store_dwordx4 v[244:247], v15, s[28:31], s75 offen offset:1024 sc1
    v_mfma_f32_16x16x32_bf16 v[152:155], a[176:179], a[12:15], 0
    ds_read_b64_tr_b16 a[146:147], v34 offset:20480
    v_mfma_f32_16x16x32_bf16 v[152:155], a[180:183], a[28:31], v[152:155]
    v_mfma_f32_16x16x32_bf16 v[168:171], a[176:179], a[0:3], 0
    ds_read_b64_tr_b16 a[148:149], v34 offset:24576
    v_mfma_f32_16x16x32_bf16 v[168:171], a[180:183], a[16:19], v[168:171]
    buffer_load_dwordx4 a[88:91], v57, s[28:31], s39 offen offset:0 sc1
    v_mfma_f32_16x16x32_bf16 v[184:187], a[176:179], a[4:7], 0
    ds_read_b64_tr_b16 a[150:151], v34 offset:28672
    v_mfma_f32_16x16x32_bf16 v[184:187], a[180:183], a[20:23], v[184:187]
    v_mfma_f32_16x16x32_bf16 v[140:143], a[184:187], a[8:11], 0
    ds_read_b64_tr_b16 a[152:153], v35 offset:16384
    v_mfma_f32_16x16x32_bf16 v[140:143], a[188:191], a[24:27], v[140:143]
    buffer_load_dwordx4 a[92:95], v57, s[28:31], s39 offen offset:1024 sc1
    s_add_u32 s39, s46, s7
    v_mfma_f32_16x16x32_bf16 v[156:159], a[184:187], a[12:15], 0
    ds_read_b64_tr_b16 a[154:155], v35 offset:20480
    v_mfma_f32_16x16x32_bf16 v[156:159], a[188:191], a[28:31], v[156:159]
    v_mfma_f32_16x16x32_bf16 v[172:175], a[184:187], a[0:3], 0
    ds_read_b64_tr_b16 a[156:157], v35 offset:24576
    v_mfma_f32_16x16x32_bf16 v[172:175], a[188:191], a[16:19], v[172:175]
    buffer_load_dwordx4 a[96:99], v52, s[28:31], s39 offen offset:0 sc1
    v_mfma_f32_16x16x32_bf16 v[188:191], a[184:187], a[4:7], 0
    ds_read_b64_tr_b16 a[158:159], v35 offset:28672
    s_waitcnt vmcnt(15)
    v_mfma_f32_16x16x32_bf16 v[188:191], a[188:191], a[20:23], v[188:191]
    s_waitcnt lgkmcnt(8)
    v_mfma_f32_16x16x32_bf16 v[96:99], a[128:131], a[40:43], v[96:99]
    ds_read_b64_tr_b16 a[160:161], v36 offset:16384
    v_mfma_f32_16x16x32_bf16 v[96:99], a[132:135], a[56:59], v[96:99]
    ds_read_b64_tr_b16 a[162:163], v36 offset:20480
    v_mfma_f32_16x16x32_bf16 v[112:115], a[128:131], a[44:47], v[112:115]
    buffer_store_dwordx4 v[248:251], v15, s[28:31], s75 offen offset:2048 sc1
    v_mfma_f32_16x16x32_bf16 v[112:115], a[132:135], a[60:63], v[112:115]
    ds_read_b64_tr_b16 a[164:165], v36 offset:24576
    v_mfma_f32_16x16x32_bf16 v[64:67], a[128:131], a[32:35], v[64:67]
    ds_read_b64_tr_b16 a[166:167], v36 offset:28672
    v_mfma_f32_16x16x32_bf16 v[64:67], a[132:135], a[48:51], v[64:67]
    buffer_load_dwordx4 a[100:103], v52, s[28:31], s39 offen offset:1024 sc1
    v_mfma_f32_16x16x32_bf16 v[80:83], a[128:131], a[36:39], v[80:83]
    ds_read_b64_tr_b16 a[168:169], v37 offset:16384
    v_mfma_f32_16x16x32_bf16 v[80:83], a[132:135], a[52:55], v[80:83]
    v_mfma_f32_16x16x32_bf16 v[100:103], a[136:139], a[40:43], v[100:103]
    ds_read_b64_tr_b16 a[170:171], v37 offset:20480
    v_mfma_f32_16x16x32_bf16 v[100:103], a[140:143], a[56:59], v[100:103]
    ds_read_b64_tr_b16 a[172:173], v37 offset:24576
    v_mfma_f32_16x16x32_bf16 v[116:119], a[136:139], a[44:47], v[116:119]
    buffer_load_dwordx4 a[104:107], v56, s[28:31], s39 offen offset:0 sc1
    v_mfma_f32_16x16x32_bf16 v[116:119], a[140:143], a[60:63], v[116:119]
    ds_read_b64_tr_b16 a[174:175], v37 offset:28672
    v_mfma_f32_16x16x32_bf16 v[68:71], a[136:139], a[32:35], v[68:71]
    v_mfma_f32_16x16x32_bf16 v[68:71], a[140:143], a[48:51], v[68:71]
    ds_read_b64_tr_b16 a[176:177], v38 offset:16384
    v_mfma_f32_16x16x32_bf16 v[84:87], a[136:139], a[36:39], v[84:87]
    ds_read_b64_tr_b16 a[178:179], v38 offset:20480
    v_mfma_f32_16x16x32_bf16 v[84:87], a[140:143], a[52:55], v[84:87]
    s_waitcnt lgkmcnt(10)
    buffer_load_dwordx4 a[108:111], v56, s[28:31], s39 offen offset:1024 sc1
    v_mfma_f32_16x16x32_bf16 v[104:107], a[144:147], a[40:43], v[104:107]
    ds_read_b64_tr_b16 a[180:181], v38 offset:24576
    v_mfma_f32_16x16x32_bf16 v[104:107], a[148:151], a[56:59], v[104:107]
    ds_read_b64_tr_b16 a[182:183], v38 offset:28672
    v_mfma_f32_16x16x32_bf16 v[120:123], a[144:147], a[44:47], v[120:123]
    v_mfma_f32_16x16x32_bf16 v[120:123], a[148:151], a[60:63], v[120:123]
    ds_read_b64_tr_b16 a[184:185], v39 offset:16384
    v_mfma_f32_16x16x32_bf16 v[72:75], a[144:147], a[32:35], v[72:75]
    buffer_load_dwordx4 a[112:115], v53, s[28:31], s39 offen offset:0 sc1
    v_mfma_f32_16x16x32_bf16 v[72:75], a[148:151], a[48:51], v[72:75]
    ds_read_b64_tr_b16 a[186:187], v39 offset:20480
    v_mfma_f32_16x16x32_bf16 v[88:91], a[144:147], a[36:39], v[88:91]
    ds_read_b64_tr_b16 a[188:189], v39 offset:24576
    v_mfma_f32_16x16x32_bf16 v[88:91], a[148:151], a[52:55], v[88:91]
    v_mfma_f32_16x16x32_bf16 v[108:111], a[152:155], a[40:43], v[108:111]
    ds_read_b64_tr_b16 a[190:191], v39 offset:28672
    v_mfma_f32_16x16x32_bf16 v[108:111], a[156:159], a[56:59], v[108:111]
    buffer_load_dwordx4 a[116:119], v53, s[28:31], s39 offen offset:1024 sc1
    v_mfma_f32_16x16x32_bf16 v[124:127], a[152:155], a[44:47], v[124:127]
    v_mfma_f32_16x16x32_bf16 v[124:127], a[156:159], a[60:63], v[124:127]
    v_mfma_f32_16x16x32_bf16 v[76:79], a[152:155], a[32:35], v[76:79]
    v_mfma_f32_16x16x32_bf16 v[76:79], a[156:159], a[48:51], v[76:79]
    buffer_load_dwordx4 a[120:123], v57, s[28:31], s39 offen offset:0 sc1
    v_mfma_f32_16x16x32_bf16 v[92:95], a[152:155], a[36:39], v[92:95]
    v_mfma_f32_16x16x32_bf16 v[92:95], a[156:159], a[52:55], v[92:95]
    s_waitcnt lgkmcnt(0)
    s_barrier
    v_mfma_f32_16x16x32_bf16 v[128:131], a[160:163], a[40:43], v[128:131]
    ds_read_b64_tr_b16 a[128:129], v32 offset:32768
    s_lshl3_add_u32 s38, s37, s44
    v_mfma_f32_16x16x32_bf16 v[128:131], a[164:167], a[56:59], v[128:131]
    s_add_u32 m0, s56, 16384
    s_nop 0
    buffer_load_dwordx4 v16, s[8:11], s38 offen offset:0 lds
    v_mfma_f32_16x16x32_bf16 v[144:147], a[160:163], a[44:47], v[144:147]
    ds_read_b64_tr_b16 a[130:131], v32 offset:36864
    v_mfma_f32_16x16x32_bf16 v[144:147], a[164:167], a[60:63], v[144:147]
    buffer_load_dwordx4 v17, s[8:11], s38 offen offset:1024 lds
    v_mfma_f32_16x16x32_bf16 v[160:163], a[160:163], a[32:35], v[160:163]
    ds_read_b64_tr_b16 a[132:133], v32 offset:40960
    v_mfma_f32_16x16x32_bf16 v[160:163], a[164:167], a[48:51], v[160:163]
    v_mfma_f32_16x16x32_bf16 v[176:179], a[160:163], a[36:39], v[176:179]
    ds_read_b64_tr_b16 a[134:135], v32 offset:45056
    v_mfma_f32_16x16x32_bf16 v[176:179], a[164:167], a[52:55], v[176:179]
    buffer_load_dwordx4 v18, s[8:11], s38 offen offset:2048 lds
    v_mfma_f32_16x16x32_bf16 v[132:135], a[168:171], a[40:43], v[132:135]
    ds_read_b64_tr_b16 a[136:137], v33 offset:32768
    v_mfma_f32_16x16x32_bf16 v[132:135], a[172:175], a[56:59], v[132:135]
    buffer_load_dwordx4 v19, s[8:11], s38 offen offset:3072 lds
    v_mfma_f32_16x16x32_bf16 v[148:151], a[168:171], a[44:47], v[148:151]
    ds_read_b64_tr_b16 a[138:139], v33 offset:36864
    v_mfma_f32_16x16x32_bf16 v[148:151], a[172:175], a[60:63], v[148:151]
    v_mfma_f32_16x16x32_bf16 v[164:167], a[168:171], a[32:35], v[164:167]
    ds_read_b64_tr_b16 a[140:141], v33 offset:40960
    v_mfma_f32_16x16x32_bf16 v[164:167], a[172:175], a[48:51], v[164:167]
    buffer_store_dwordx4 v[252:255], v15, s[28:31], s75 offen offset:3072 sc1
    v_mfma_f32_16x16x32_bf16 v[180:183], a[168:171], a[36:39], v[180:183]
    ds_read_b64_tr_b16 a[142:143], v33 offset:45056
    v_mfma_f32_16x16x32_bf16 v[180:183], a[172:175], a[52:55], v[180:183]
    buffer_load_dwordx4 a[124:127], v57, s[28:31], s39 offen offset:1024 sc1
    s_add_u32 s39, s46, s36
    v_mfma_f32_16x16x32_bf16 v[136:139], a[176:179], a[40:43], v[136:139]
    ds_read_b64_tr_b16 a[144:145], v34 offset:32768
    v_mfma_f32_16x16x32_bf16 v[136:139], a[180:183], a[56:59], v[136:139]
    buffer_load_dwordx4 a[192:195], v52, s[28:31], s39 offen offset:0 sc1
    v_lshlrev_b32 v4, 5, v15
    v_mfma_f32_16x16x32_bf16 v[152:155], a[176:179], a[44:47], v[152:155]
    ds_read_b64_tr_b16 a[146:147], v34 offset:36864
    s_or_b32 s3, s2, s32
    v_mfma_f32_16x16x32_bf16 v[152:155], a[180:183], a[60:63], v[152:155]
    s_cselect_b32 s3, 1073741824, 0
    v_mfma_f32_16x16x32_bf16 v[168:171], a[176:179], a[32:35], v[168:171]
    ds_read_b64_tr_b16 a[148:149], v34 offset:40960
    v_mfma_f32_16x16x32_bf16 v[168:171], a[180:183], a[48:51], v[168:171]
    buffer_load_dwordx4 v[224:227], v4, s[84:87], s3 offen offset:0 sc1
    v_mfma_f32_16x16x32_bf16 v[184:187], a[176:179], a[36:39], v[184:187]
    ds_read_b64_tr_b16 a[150:151], v34 offset:45056
    v_mfma_f32_16x16x32_bf16 v[184:187], a[180:183], a[52:55], v[184:187]
    buffer_load_dwordx4 v[228:231], v4, s[84:87], s3 offen offset:128 sc1
    v_mfma_f32_16x16x32_bf16 v[140:143], a[184:187], a[40:43], v[140:143]
    ds_read_b64_tr_b16 a[152:153], v35 offset:32768
    v_mfma_f32_16x16x32_bf16 v[140:143], a[188:191], a[56:59], v[140:143]
    v_mfma_f32_16x16x32_bf16 v[156:159], a[184:187], a[44:47], v[156:159]
    ds_read_b64_tr_b16 a[154:155], v35 offset:36864
    v_mfma_f32_16x16x32_bf16 v[156:159], a[188:191], a[60:63], v[156:159]
    buffer_load_dwordx4 v[232:235], v4, s[84:87], s3 offen offset:256 sc1
    v_mfma_f32_16x16x32_bf16 v[172:175], a[184:187], a[32:35], v[172:175]
    ds_read_b64_tr_b16 a[156:157], v35 offset:40960
    v_mfma_f32_16x16x32_bf16 v[172:175], a[188:191], a[48:51], v[172:175]
    buffer_load_dwordx4 v[236:239], v4, s[84:87], s3 offen offset:384 sc1
    v_mfma_f32_16x16x32_bf16 v[188:191], a[184:187], a[36:39], v[188:191]
    ds_read_b64_tr_b16 a[158:159], v35 offset:45056
    s_waitcnt vmcnt(19)
    v_mfma_f32_16x16x32_bf16 v[188:191], a[188:191], a[52:55], v[188:191]
    s_waitcnt lgkmcnt(8)
    v_mfma_f32_16x16x32_bf16 v[96:99], a[128:131], a[72:75], v[96:99]
    ds_read_b64_tr_b16 a[160:161], v36 offset:32768
    v_mfma_f32_16x16x32_bf16 v[96:99], a[132:135], a[88:91], v[96:99]
    ds_read_b64_tr_b16 a[162:163], v36 offset:36864
    v_mfma_f32_16x16x32_bf16 v[112:115], a[128:131], a[76:79], v[112:115]
    buffer_load_dwordx4 a[196:199], v52, s[28:31], s39 offen offset:1024 sc1
    v_mfma_f32_16x16x32_bf16 v[112:115], a[132:135], a[92:95], v[112:115]
    ds_read_b64_tr_b16 a[164:165], v36 offset:40960
    v_mfma_f32_16x16x32_bf16 v[64:67], a[128:131], a[64:67], v[64:67]
    ds_read_b64_tr_b16 a[166:167], v36 offset:45056
    v_mfma_f32_16x16x32_bf16 v[64:67], a[132:135], a[80:83], v[64:67]
    buffer_load_dwordx4 a[200:203], v56, s[28:31], s39 offen offset:0 sc1
    v_mfma_f32_16x16x32_bf16 v[80:83], a[128:131], a[68:71], v[80:83]
    ds_read_b64_tr_b16 a[168:169], v37 offset:32768
    v_mfma_f32_16x16x32_bf16 v[80:83], a[132:135], a[84:87], v[80:83]
    v_mfma_f32_16x16x32_bf16 v[100:103], a[136:139], a[72:75], v[100:103]
    ds_read_b64_tr_b16 a[170:171], v37 offset:36864
    v_mfma_f32_16x16x32_bf16 v[100:103], a[140:143], a[88:91], v[100:103]
    ds_read_b64_tr_b16 a[172:173], v37 offset:40960
    v_mfma_f32_16x16x32_bf16 v[116:119], a[136:139], a[76:79], v[116:119]
    buffer_load_dwordx4 a[204:207], v56, s[28:31], s39 offen offset:1024 sc1
    v_mfma_f32_16x16x32_bf16 v[116:119], a[140:143], a[92:95], v[116:119]
    ds_read_b64_tr_b16 a[174:175], v37 offset:45056
    v_mfma_f32_16x16x32_bf16 v[68:71], a[136:139], a[64:67], v[68:71]
    v_mfma_f32_16x16x32_bf16 v[68:71], a[140:143], a[80:83], v[68:71]
    ds_read_b64_tr_b16 a[176:177], v38 offset:32768
    v_mfma_f32_16x16x32_bf16 v[84:87], a[136:139], a[68:71], v[84:87]
    ds_read_b64_tr_b16 a[178:179], v38 offset:36864
    v_mfma_f32_16x16x32_bf16 v[84:87], a[140:143], a[84:87], v[84:87]
    s_waitcnt lgkmcnt(10)
    buffer_load_dwordx4 a[208:211], v53, s[28:31], s39 offen offset:0 sc1
    v_mfma_f32_16x16x32_bf16 v[104:107], a[144:147], a[72:75], v[104:107]
    ds_read_b64_tr_b16 a[180:181], v38 offset:40960
    v_mfma_f32_16x16x32_bf16 v[104:107], a[148:151], a[88:91], v[104:107]
    ds_read_b64_tr_b16 a[182:183], v38 offset:45056
    v_mfma_f32_16x16x32_bf16 v[120:123], a[144:147], a[76:79], v[120:123]
    buffer_load_dwordx4 a[212:215], v53, s[28:31], s39 offen offset:1024 sc1
    v_mfma_f32_16x16x32_bf16 v[120:123], a[148:151], a[92:95], v[120:123]
    ds_read_b64_tr_b16 a[184:185], v39 offset:32768
    v_mfma_f32_16x16x32_bf16 v[72:75], a[144:147], a[64:67], v[72:75]
    v_mfma_f32_16x16x32_bf16 v[72:75], a[148:151], a[80:83], v[72:75]
    ds_read_b64_tr_b16 a[186:187], v39 offset:36864
    v_mfma_f32_16x16x32_bf16 v[88:91], a[144:147], a[68:71], v[88:91]
    ds_read_b64_tr_b16 a[188:189], v39 offset:40960
    v_mfma_f32_16x16x32_bf16 v[88:91], a[148:151], a[84:87], v[88:91]
    buffer_load_dwordx4 a[216:219], v57, s[28:31], s39 offen offset:0 sc1
    v_mfma_f32_16x16x32_bf16 v[108:111], a[152:155], a[72:75], v[108:111]
    ds_read_b64_tr_b16 a[190:191], v39 offset:45056
    v_mfma_f32_16x16x32_bf16 v[108:111], a[156:159], a[88:91], v[108:111]
    v_mfma_f32_16x16x32_bf16 v[124:127], a[152:155], a[76:79], v[124:127]
    buffer_load_dwordx4 a[220:223], v57, s[28:31], s39 offen offset:1024 sc1
    s_add_u32 s39, s46, s37
    v_mfma_f32_16x16x32_bf16 v[124:127], a[156:159], a[92:95], v[124:127]
    v_mfma_f32_16x16x32_bf16 v[76:79], a[152:155], a[64:67], v[76:79]
    v_mfma_f32_16x16x32_bf16 v[76:79], a[156:159], a[80:83], v[76:79]
    v_mfma_f32_16x16x32_bf16 v[92:95], a[152:155], a[68:71], v[92:95]
    buffer_load_dwordx4 a[224:227], v52, s[28:31], s39 offen offset:0 sc1
    v_mfma_f32_16x16x32_bf16 v[92:95], a[156:159], a[84:87], v[92:95]
    s_waitcnt lgkmcnt(0)
    s_barrier
    v_mfma_f32_16x16x32_bf16 v[128:131], a[160:163], a[72:75], v[128:131]
    ds_read_b64_tr_b16 a[128:129], v32 offset:49152
    s_lshl3_add_u32 s38, s55, s44
    v_mfma_f32_16x16x32_bf16 v[128:131], a[164:167], a[88:91], v[128:131]
    s_add_u32 m0, s56, 32768
    s_nop 0
    buffer_load_dwordx4 v16, s[8:11], s38 offen offset:0 lds
    v_mfma_f32_16x16x32_bf16 v[144:147], a[160:163], a[76:79], v[144:147]
    ds_read_b64_tr_b16 a[130:131], v32 offset:53248
    v_mfma_f32_16x16x32_bf16 v[144:147], a[164:167], a[92:95], v[144:147]
    v_mfma_f32_16x16x32_bf16 v[160:163], a[160:163], a[64:67], v[160:163]
    ds_read_b64_tr_b16 a[132:133], v32 offset:57344
    v_mfma_f32_16x16x32_bf16 v[160:163], a[164:167], a[80:83], v[160:163]
    buffer_load_dwordx4 v17, s[8:11], s38 offen offset:1024 lds
    v_mfma_f32_16x16x32_bf16 v[176:179], a[160:163], a[68:71], v[176:179]
    ds_read_b64_tr_b16 a[134:135], v32 offset:61440
    v_mfma_f32_16x16x32_bf16 v[176:179], a[164:167], a[84:87], v[176:179]
    buffer_load_dwordx4 v18, s[8:11], s38 offen offset:2048 lds
    v_mfma_f32_16x16x32_bf16 v[132:135], a[168:171], a[72:75], v[132:135]
    ds_read_b64_tr_b16 a[136:137], v33 offset:49152
    v_mfma_f32_16x16x32_bf16 v[132:135], a[172:175], a[88:91], v[132:135]
    v_mfma_f32_16x16x32_bf16 v[148:151], a[168:171], a[76:79], v[148:151]
    ds_read_b64_tr_b16 a[138:139], v33 offset:53248
    v_mfma_f32_16x16x32_bf16 v[148:151], a[172:175], a[92:95], v[148:151]
    buffer_load_dwordx4 v19, s[8:11], s38 offen offset:3072 lds
    v_mfma_f32_16x16x32_bf16 v[164:167], a[168:171], a[64:67], v[164:167]
    ds_read_b64_tr_b16 a[140:141], v33 offset:57344
    v_mfma_f32_16x16x32_bf16 v[164:167], a[172:175], a[80:83], v[164:167]
    v_mfma_f32_16x16x32_bf16 v[180:183], a[168:171], a[68:71], v[180:183]
    ds_read_b64_tr_b16 a[142:143], v33 offset:61440
    v_mfma_f32_16x16x32_bf16 v[180:183], a[172:175], a[84:87], v[180:183]
    buffer_load_dwordx4 a[228:231], v52, s[28:31], s39 offen offset:1024 sc1
    v_mfma_f32_16x16x32_bf16 v[136:139], a[176:179], a[72:75], v[136:139]
    ds_read_b64_tr_b16 a[144:145], v34 offset:49152
    v_mfma_f32_16x16x32_bf16 v[136:139], a[180:183], a[88:91], v[136:139]
    v_mfma_f32_16x16x32_bf16 v[152:155], a[176:179], a[76:79], v[152:155]
    ds_read_b64_tr_b16 a[146:147], v34 offset:53248
    v_mfma_f32_16x16x32_bf16 v[152:155], a[180:183], a[92:95], v[152:155]
    buffer_load_dwordx4 a[232:235], v56, s[28:31], s39 offen offset:0 sc1
    v_mfma_f32_16x16x32_bf16 v[168:171], a[176:179], a[64:67], v[168:171]
    ds_read_b64_tr_b16 a[148:149], v34 offset:57344
    v_mfma_f32_16x16x32_bf16 v[168:171], a[180:183], a[80:83], v[168:171]
    v_mfma_f32_16x16x32_bf16 v[184:187], a[176:179], a[68:71], v[184:187]
    ds_read_b64_tr_b16 a[150:151], v34 offset:61440
    v_mfma_f32_16x16x32_bf16 v[184:187], a[180:183], a[84:87], v[184:187]
    buffer_load_dwordx4 a[236:239], v56, s[28:31], s39 offen offset:1024 sc1
    v_mfma_f32_16x16x32_bf16 v[140:143], a[184:187], a[72:75], v[140:143]
    ds_read_b64_tr_b16 a[152:153], v35 offset:49152
    v_mfma_f32_16x16x32_bf16 v[140:143], a[188:191], a[88:91], v[140:143]
    buffer_load_dwordx4 a[240:243], v53, s[28:31], s39 offen offset:0 sc1
    v_mfma_f32_16x16x32_bf16 v[156:159], a[184:187], a[76:79], v[156:159]
    ds_read_b64_tr_b16 a[154:155], v35 offset:53248
    v_mfma_f32_16x16x32_bf16 v[156:159], a[188:191], a[92:95], v[156:159]
    v_mfma_f32_16x16x32_bf16 v[172:175], a[184:187], a[64:67], v[172:175]
    ds_read_b64_tr_b16 a[156:157], v35 offset:57344
    v_mfma_f32_16x16x32_bf16 v[172:175], a[188:191], a[80:83], v[172:175]
    buffer_load_dword v12, v5, s[84:87], s58 offen sc1
    v_mfma_f32_16x16x32_bf16 v[188:191], a[184:187], a[68:71], v[188:191]
    ds_read_b64_tr_b16 a[158:159], v35 offset:61440
    s_waitcnt vmcnt(22)
    v_mfma_f32_16x16x32_bf16 v[188:191], a[188:191], a[84:87], v[188:191]
    s_waitcnt lgkmcnt(8)
    buffer_store_dword v7, v6, s[84:87], s92 offen sc1
    v_mfma_f32_16x16x32_bf16 v[96:99], a[128:131], a[104:107], v[96:99]
    ds_read_b64_tr_b16 a[160:161], v36 offset:49152
    v_mfma_f32_16x16x32_bf16 v[96:99], a[132:135], a[120:123], v[96:99]
    ds_read_b64_tr_b16 a[162:163], v36 offset:53248
    v_mfma_f32_16x16x32_bf16 v[112:115], a[128:131], a[108:111], v[112:115]
    buffer_load_dwordx4 a[244:247], v53, s[28:31], s39 offen offset:1024 sc1
    v_mfma_f32_16x16x32_bf16 v[112:115], a[132:135], a[124:127], v[112:115]
    ds_read_b64_tr_b16 a[164:165], v36 offset:57344
    v_mfma_f32_16x16x32_bf16 v[64:67], a[128:131], a[96:99], v[64:67]
    ds_read_b64_tr_b16 a[166:167], v36 offset:61440
    v_mfma_f32_16x16x32_bf16 v[64:67], a[132:135], a[112:115], v[64:67]
    buffer_load_dwordx4 a[248:251], v57, s[28:31], s39 offen offset:0 sc1
    v_mfma_f32_16x16x32_bf16 v[80:83], a[128:131], a[100:103], v[80:83]
    ds_read_b64_tr_b16 a[168:169], v37 offset:49152
    v_mfma_f32_16x16x32_bf16 v[80:83], a[132:135], a[116:119], v[80:83]
    v_mfma_f32_16x16x32_bf16 v[100:103], a[136:139], a[104:107], v[100:103]
    ds_read_b64_tr_b16 a[170:171], v37 offset:53248
    v_mfma_f32_16x16x32_bf16 v[100:103], a[140:143], a[120:123], v[100:103]
    ds_read_b64_tr_b16 a[172:173], v37 offset:57344
    v_mfma_f32_16x16x32_bf16 v[116:119], a[136:139], a[108:111], v[116:119]
    buffer_load_dwordx4 a[252:255], v57, s[28:31], s39 offen offset:1024 sc1
    s_add_u32 s39, s46, s55
    v_mfma_f32_16x16x32_bf16 v[116:119], a[140:143], a[124:127], v[116:119]
    ds_read_b64_tr_b16 a[174:175], v37 offset:61440
    v_mfma_f32_16x16x32_bf16 v[68:71], a[136:139], a[96:99], v[68:71]
    v_mfma_f32_16x16x32_bf16 v[68:71], a[140:143], a[112:115], v[68:71]
    ds_read_b64_tr_b16 a[176:177], v38 offset:49152
    v_mfma_f32_16x16x32_bf16 v[84:87], a[136:139], a[100:103], v[84:87]
    ds_read_b64_tr_b16 a[178:179], v38 offset:53248
    v_mfma_f32_16x16x32_bf16 v[84:87], a[140:143], a[116:119], v[84:87]
    s_waitcnt lgkmcnt(10)
    buffer_load_dwordx4 a[0:3], v52, s[28:31], s39 offen offset:0 sc1
    v_mfma_f32_16x16x32_bf16 v[104:107], a[144:147], a[104:107], v[104:107]
    ds_read_b64_tr_b16 a[180:181], v38 offset:57344
    v_mfma_f32_16x16x32_bf16 v[104:107], a[148:151], a[120:123], v[104:107]
    ds_read_b64_tr_b16 a[182:183], v38 offset:61440
    v_mfma_f32_16x16x32_bf16 v[120:123], a[144:147], a[108:111], v[120:123]
    v_mfma_f32_16x16x32_bf16 v[120:123], a[148:151], a[124:127], v[120:123]
    ds_read_b64_tr_b16 a[184:185], v39 offset:49152
    v_mfma_f32_16x16x32_bf16 v[72:75], a[144:147], a[96:99], v[72:75]
    buffer_load_dwordx4 a[4:7], v52, s[28:31], s39 offen offset:1024 sc1
    v_mfma_f32_16x16x32_bf16 v[72:75], a[148:151], a[112:115], v[72:75]
    ds_read_b64_tr_b16 a[186:187], v39 offset:53248
    v_mfma_f32_16x16x32_bf16 v[88:91], a[144:147], a[100:103], v[88:91]
    ds_read_b64_tr_b16 a[188:189], v39 offset:57344
    v_mfma_f32_16x16x32_bf16 v[88:91], a[148:151], a[116:119], v[88:91]
    v_mfma_f32_16x16x32_bf16 v[108:111], a[152:155], a[104:107], v[108:111]
    ds_read_b64_tr_b16 a[190:191], v39 offset:61440
    v_mfma_f32_16x16x32_bf16 v[108:111], a[156:159], a[120:123], v[108:111]
    buffer_load_dwordx4 a[8:11], v56, s[28:31], s39 offen offset:0 sc1
    v_mfma_f32_16x16x32_bf16 v[124:127], a[152:155], a[108:111], v[124:127]
    v_mfma_f32_16x16x32_bf16 v[124:127], a[156:159], a[124:127], v[124:127]
    v_mfma_f32_16x16x32_bf16 v[76:79], a[152:155], a[96:99], v[76:79]
    v_mfma_f32_16x16x32_bf16 v[76:79], a[156:159], a[112:115], v[76:79]
    buffer_load_dwordx4 a[12:15], v56, s[28:31], s39 offen offset:1024 sc1
    v_mfma_f32_16x16x32_bf16 v[92:95], a[152:155], a[100:103], v[92:95]
    v_mfma_f32_16x16x32_bf16 v[92:95], a[156:159], a[116:119], v[92:95]
    s_waitcnt lgkmcnt(0)
    s_barrier
    v_mfma_f32_16x16x32_bf16 v[128:131], a[160:163], a[104:107], v[128:131]
    ds_read_b64_tr_b16 a[128:129], v32 offset:0
    s_lshl3_add_u32 s38, s4, s45
    v_mfma_f32_16x16x32_bf16 v[128:131], a[164:167], a[120:123], v[128:131]
    s_add_u32 m0, s56, 49152
    s_nop 0
    buffer_load_dwordx4 v16, s[8:11], s38 offen offset:0 lds
    v_mfma_f32_16x16x32_bf16 v[144:147], a[160:163], a[108:111], v[144:147]
    ds_read_b64_tr_b16 a[130:131], v32 offset:4096
    v_mfma_f32_16x16x32_bf16 v[144:147], a[164:167], a[124:127], v[144:147]
    v_mfma_f32_16x16x32_bf16 v[160:163], a[160:163], a[96:99], v[160:163]
    ds_read_b64_tr_b16 a[132:133], v32 offset:8192
    v_mfma_f32_16x16x32_bf16 v[160:163], a[164:167], a[112:115], v[160:163]
    buffer_load_dwordx4 v17, s[8:11], s38 offen offset:1024 lds
    v_mfma_f32_16x16x32_bf16 v[176:179], a[160:163], a[100:103], v[176:179]
    ds_read_b64_tr_b16 a[134:135], v32 offset:12288
    v_mfma_f32_16x16x32_bf16 v[176:179], a[164:167], a[116:119], v[176:179]
    v_mfma_f32_16x16x32_bf16 v[132:135], a[168:171], a[104:107], v[132:135]
    ds_read_b64_tr_b16 a[136:137], v33 offset:0
    v_mfma_f32_16x16x32_bf16 v[132:135], a[172:175], a[120:123], v[132:135]
    buffer_load_dwordx4 v18, s[8:11], s38 offen offset:2048 lds
    v_mfma_f32_16x16x32_bf16 v[148:151], a[168:171], a[108:111], v[148:151]
    ds_read_b64_tr_b16 a[138:139], v33 offset:4096
    v_mfma_f32_16x16x32_bf16 v[148:151], a[172:175], a[124:127], v[148:151]
    v_mfma_f32_16x16x32_bf16 v[164:167], a[168:171], a[96:99], v[164:167]
    ds_read_b64_tr_b16 a[140:141], v33 offset:8192
    v_mfma_f32_16x16x32_bf16 v[164:167], a[172:175], a[112:115], v[164:167]
    buffer_load_dwordx4 v19, s[8:11], s38 offen offset:3072 lds
    v_mfma_f32_16x16x32_bf16 v[180:183], a[168:171], a[100:103], v[180:183]
    ds_read_b64_tr_b16 a[142:143], v33 offset:12288
    v_mfma_f32_16x16x32_bf16 v[180:183], a[172:175], a[116:119], v[180:183]
    v_mfma_f32_16x16x32_bf16 v[136:139], a[176:179], a[104:107], v[136:139]
    ds_read_b64_tr_b16 a[144:145], v34 offset:0
    v_mfma_f32_16x16x32_bf16 v[136:139], a[180:183], a[120:123], v[136:139]
    buffer_load_dwordx4 a[16:19], v53, s[28:31], s39 offen offset:0 sc1
    v_mfma_f32_16x16x32_bf16 v[152:155], a[176:179], a[108:111], v[152:155]
    ds_read_b64_tr_b16 a[146:147], v34 offset:4096
    v_mfma_f32_16x16x32_bf16 v[152:155], a[180:183], a[124:127], v[152:155]
    v_mfma_f32_16x16x32_bf16 v[168:171], a[176:179], a[96:99], v[168:171]
    ds_read_b64_tr_b16 a[148:149], v34 offset:8192
    v_mfma_f32_16x16x32_bf16 v[168:171], a[180:183], a[112:115], v[168:171]
    buffer_load_dwordx4 a[20:23], v53, s[28:31], s39 offen offset:1024 sc1
    v_mfma_f32_16x16x32_bf16 v[184:187], a[176:179], a[100:103], v[184:187]
    ds_read_b64_tr_b16 a[150:151], v34 offset:12288
    v_mfma_f32_16x16x32_bf16 v[184:187], a[180:183], a[116:119], v[184:187]
    v_mfma_f32_16x16x32_bf16 v[140:143], a[184:187], a[104:107], v[140:143]
    ds_read_b64_tr_b16 a[152:153], v35 offset:0
    v_mfma_f32_16x16x32_bf16 v[140:143], a[188:191], a[120:123], v[140:143]
    buffer_load_dwordx4 a[24:27], v57, s[28:31], s39 offen offset:0 sc1
    v_mfma_f32_16x16x32_bf16 v[156:159], a[184:187], a[108:111], v[156:159]
    ds_read_b64_tr_b16 a[154:155], v35 offset:4096
    v_mfma_f32_16x16x32_bf16 v[156:159], a[188:191], a[124:127], v[156:159]
    v_mfma_f32_16x16x32_bf16 v[172:175], a[184:187], a[96:99], v[172:175]
    ds_read_b64_tr_b16 a[156:157], v35 offset:8192
    v_mfma_f32_16x16x32_bf16 v[172:175], a[188:191], a[112:115], v[172:175]
    buffer_load_dwordx4 a[28:31], v57, s[28:31], s39 offen offset:1024 sc1
    v_mfma_f32_16x16x32_bf16 v[188:191], a[184:187], a[100:103], v[188:191]
    ds_read_b64_tr_b16 a[158:159], v35 offset:12288
    s_waitcnt vmcnt(26)
    v_mfma_f32_16x16x32_bf16 v[188:191], a[188:191], a[116:119], v[188:191]
    s_waitcnt lgkmcnt(8)
    s_waitcnt vmcnt(16)
    v_cmp_ne_u32 vcc, s96, v12
    s_cbranch_vccz L_f1b_ok
    s_mov_b32 s97, 0
L_f1b_spin:
    s_sleep 1
    buffer_load_dword v12, v5, s[84:87], s58 offen sc1
    s_add_u32 s97, s97, 1
    s_waitcnt vmcnt(0)
    s_cmp_gt_u32 s97, 0x80000
    s_cbranch_scc1 L_f1b_ok
    v_cmp_ne_u32 vcc, s96, v12
    s_cbranch_vccnz L_f1b_spin
L_f1b_ok:
    s_or_b32 s3, s2, s32
    s_cbranch_scc1 L_noep
    s_mov_b32 s97, 0
L_ep:
    v_xor_b32 v224, s96, v224
    v_xor_b32 v228, s96, v228
    v_xor_b32 v232, s96, v232
    v_xor_b32 v236, s96, v236
    v_or_b32 v224, v224, v228
    v_or_b32 v224, v224, v232
    v_or_b32 v224, v224, v236
    v_cmp_ne_u32 vcc, 0, v224
    s_cbranch_vccz L_epok
    buffer_load_dwordx4 v[224:227], v4, s[84:87], 0 offen offset:0 sc1
    buffer_load_dwordx4 v[228:231], v4, s[84:87], 0 offen offset:128 sc1
    buffer_load_dwordx4 v[232:235], v4, s[84:87], 0 offen offset:256 sc1
    buffer_load_dwordx4 v[236:239], v4, s[84:87], 0 offen offset:384 sc1
    s_add_u32 s97, s97, 1
    s_waitcnt vmcnt(0)
    s_cmp_lt_u32 s97, 0x80000
    s_cbranch_scc1 L_ep
L_epok:
    s_mov_b32 s3, 65536
    buffer_store_dword v7, v6, s[84:87], s3 offen sc1
L_noep:
    v_mfma_f32_16x16x32_bf16 v[96:99], a[128:131], a[200:203], v[96:99]
    ds_read_b64_tr_b16 a[160:161], v36 offset:0
    s_add_u32 s39, s47, s4
    v_mfma_f32_16x16x32_bf16 v[96:99], a[132:135], a[216:219], v[96:99]
    ds_read_b64_tr_b16 a[162:163], v36 offset:4096
    v_mfma_f32_16x16x32_bf16 v[112:115], a[128:131], a[204:207], v[112:115]
    buffer_load_dwordx4 a[32:35], v52, s[28:31], s39 offen offset:0 sc1
    v_mfma_f32_16x16x32_bf16 v[112:115], a[132:135], a[220:223], v[112:115]
    ds_read_b64_tr_b16 a[164:165], v36 offset:8192
    v_mfma_f32_16x16x32_bf16 v[64:67], a[128:131], a[192:195], v[64:67]
    ds_read_b64_tr_b16 a[166:167], v36 offset:12288
    v_mfma_f32_16x16x32_bf16 v[64:67], a[132:135], a[208:211], v[64:67]
    buffer_load_dwordx4 a[36:39], v52, s[28:31], s39 offen offset:1024 sc1
    v_mfma_f32_16x16x32_bf16 v[80:83], a[128:131], a[196:199], v[80:83]
    ds_read_b64_tr_b16 a[168:169], v37 offset:0
    v_mfma_f32_16x16x32_bf16 v[80:83], a[132:135], a[212:215], v[80:83]
    v_mfma_f32_16x16x32_bf16 v[100:103], a[136:139], a[200:203], v[100:103]
    ds_read_b64_tr_b16 a[170:171], v37 offset:4096
    v_mfma_f32_16x16x32_bf16 v[100:103], a[140:143], a[216:219], v[100:103]
    ds_read_b64_tr_b16 a[172:173], v37 offset:8192
    v_mfma_f32_16x16x32_bf16 v[116:119], a[136:139], a[204:207], v[116:119]
    buffer_load_dwordx4 a[40:43], v56, s[28:31], s39 offen offset:0 sc1
    v_mfma_f32_16x16x32_bf16 v[116:119], a[140:143], a[220:223], v[116:119]
    ds_read_b64_tr_b16 a[174:175], v37 offset:12288
    v_mfma_f32_16x16x32_bf16 v[68:71], a[136:139], a[192:195], v[68:71]
    v_mfma_f32_16x16x32_bf16 v[68:71], a[140:143], a[208:211], v[68:71]
    ds_read_b64_tr_b16 a[176:177], v38 offset:0
    v_mfma_f32_16x16x32_bf16 v[84:87], a[136:139], a[196:199], v[84:87]
    ds_read_b64_tr_b16 a[178:179], v38 offset:4096
    v_mfma_f32_16x16x32_bf16 v[84:87], a[140:143], a[212:215], v[84:87]
    s_waitcnt lgkmcnt(10)
    buffer_load_dwordx4 a[44:47], v56, s[28:31], s39 offen offset:1024 sc1
    v_mfma_f32_16x16x32_bf16 v[104:107], a[144:147], a[200:203], v[104:107]
    ds_read_b64_tr_b16 a[180:181], v38 offset:8192
    v_mfma_f32_16x16x32_bf16 v[104:107], a[148:151], a[216:219], v[104:107]
    ds_read_b64_tr_b16 a[182:183], v38 offset:12288
    v_mfma_f32_16x16x32_bf16 v[120:123], a[144:147], a[204:207], v[120:123]
    buffer_load_dwordx4 a[48:51], v53, s[28:31], s39 offen offset:0 sc1
    v_mfma_f32_16x16x32_bf16 v[120:123], a[148:151], a[220:223], v[120:123]
    ds_read_b64_tr_b16 a[184:185], v39 offset:0
    v_mfma_f32_16x16x32_bf16 v[72:75], a[144:147], a[192:195], v[72:75]
    v_mfma_f32_16x16x32_bf16 v[72:75], a[148:151], a[208:211], v[72:75]
    ds_read_b64_tr_b16 a[186:187], v39 offset:4096
    v_mfma_f32_16x16x32_bf16 v[88:91], a[144:147], a[196:199], v[88:91]
    ds_read_b64_tr_b16 a[188:189], v39 offset:8192
    v_mfma_f32_16x16x32_bf16 v[88:91], a[148:151], a[212:215], v[88:91]
    buffer_load_dwordx4 a[52:55], v53, s[28:31], s39 offen offset:1024 sc1
    v_mfma_f32_16x16x32_bf16 v[108:111], a[152:155], a[200:203], v[108:111]
    ds_read_b64_tr_b16 a[190:191], v39 offset:12288
    v_mfma_f32_16x16x32_bf16 v[108:111], a[156:159], a[216:219], v[108:111]
    v_mfma_f32_16x16x32_bf16 v[124:127], a[152:155], a[204:207], v[124:127]
    buffer_load_dwordx4 a[56:59], v57, s[28:31], s39 offen offset:0 sc1
    v_mfma_f32_16x16x32_bf16 v[124:127], a[156:159], a[220:223], v[124:127]
    v_mfma_f32_16x16x32_bf16 v[76:79], a[152:155], a[192:195], v[76:79]
    v_mfma_f32_16x16x32_bf16 v[76:79], a[156:159], a[208:211], v[76:79]
    v_mfma_f32_16x16x32_bf16 v[92:95], a[152:155], a[196:199], v[92:95]
    buffer_load_dwordx4 a[60:63], v57, s[28:31], s39 offen offset:1024 sc1
    v_mfma_f32_16x16x32_bf16 v[92:95], a[156:159], a[212:215], v[92:95]
    s_waitcnt lgkmcnt(0)
    s_barrier
    v_mfma_f32_16x16x32_bf16 v[128:131], a[160:163], a[200:203], v[128:131]
    ds_read_b64_tr_b16 a[128:129], v32 offset:16384
    s_lshl3_add_u32 s38, s5, s45
    v_mfma_f32_16x16x32_bf16 v[128:131], a[164:167], a[216:219], v[128:131]
    s_add_u32 m0, s56, 0
    s_nop 0
    buffer_load_dwordx4 v16, s[8:11], s38 offen offset:0 lds
    v_mfma_f32_16x16x32_bf16 v[144:147], a[160:163], a[204:207], v[144:147]
    ds_read_b64_tr_b16 a[130:131], v32 offset:20480
    v_mfma_f32_16x16x32_bf16 v[144:147], a[164:167], a[220:223], v[144:147]
    v_mfma_f32_16x16x32_bf16 v[160:163], a[160:163], a[192:195], v[160:163]
    ds_read_b64_tr_b16 a[132:133], v32 offset:24576
    v_mfma_f32_16x16x32_bf16 v[160:163], a[164:167], a[208:211], v[160:163]
    buffer_load_dwordx4 v17, s[8:11], s38 offen offset:1024 lds
    v_mfma_f32_16x16x32_bf16 v[176:179], a[160:163], a[196:199], v[176:179]
    ds_read_b64_tr_b16 a[134:135], v32 offset:28672
    v_mfma_f32_16x16x32_bf16 v[176:179], a[164:167], a[212:215], v[176:179]
    v_mfma_f32_16x16x32_bf16 v[132:135], a[168:171], a[200:203], v[132:135]
    ds_read_b64_tr_b16 a[136:137], v33 offset:16384
    v_mfma_f32_16x16x32_bf16 v[132:135], a[172:175], a[216:219], v[132:135]
    buffer_load_dwordx4 v18, s[8:11], s38 offen offset:2048 lds
    v_mfma_f32_16x16x32_bf16 v[148:151], a[168:171], a[204:207], v[148:151]
    ds_read_b64_tr_b16 a[138:139], v33 offset:20480
    v_mfma_f32_16x16x32_bf16 v[148:151], a[172:175], a[220:223], v[148:151]
    v_mfma_f32_16x16x32_bf16 v[164:167], a[168:171], a[192:195], v[164:167]
    ds_read_b64_tr_b16 a[140:141], v33 offset:24576
    v_mfma_f32_16x16x32_bf16 v[164:167], a[172:175], a[208:211], v[164:167]
    buffer_load_dwordx4 v19, s[8:11], s38 offen offset:3072 lds
    s_add_u32 s39, s47, s5
    v_mfma_f32_16x16x32_bf16 v[180:183], a[168:171], a[196:199], v[180:183]
    ds_read_b64_tr_b16 a[142:143], v33 offset:28672
    v_mfma_f32_16x16x32_bf16 v[180:183], a[172:175], a[212:215], v[180:183]
    v_mfma_f32_16x16x32_bf16 v[136:139], a[176:179], a[200:203], v[136:139]
    ds_read_b64_tr_b16 a[144:145], v34 offset:16384
    v_mfma_f32_16x16x32_bf16 v[136:139], a[180:183], a[216:219], v[136:139]
    buffer_load_dwordx4 a[64:67], v52, s[28:31], s39 offen offset:0 sc1
    v_mfma_f32_16x16x32_bf16 v[152:155], a[176:179], a[204:207], v[152:155]
    ds_read_b64_tr_b16 a[146:147], v34 offset:20480
    v_mfma_f32_16x16x32_bf16 v[152:155], a[180:183], a[220:223], v[152:155]
    v_mfma_f32_16x16x32_bf16 v[168:171], a[176:179], a[192:195], v[168:171]
    ds_read_b64_tr_b16 a[148:149], v34 offset:24576
    v_mfma_f32_16x16x32_bf16 v[168:171], a[180:183], a[208:211], v[168:171]
    buffer_load_dwordx4 a[68:71], v52, s[28:31], s39 offen offset:1024 sc1
    v_mfma_f32_16x16x32_bf16 v[184:187], a[176:179], a[196:199], v[184:187]
    ds_read_b64_tr_b16 a[150:151], v34 offset:28672
    v_mfma_f32_16x16x32_bf16 v[184:187], a[180:183], a[212:215], v[184:187]
    v_mfma_f32_16x16x32_bf16 v[140:143], a[184:187], a[200:203], v[140:143]
    ds_read_b64_tr_b16 a[152:153], v35 offset:16384
    v_mfma_f32_16x16x32_bf16 v[140:143], a[188:191], a[216:219], v[140:143]
    buffer_load_dwordx4 a[72:75], v56, s[28:31], s39 offen offset:0 sc1
    v_mfma_f32_16x16x32_bf16 v[156:159], a[184:187], a[204:207], v[156:159]
    ds_read_b64_tr_b16 a[154:155], v35 offset:20480
    v_mfma_f32_16x16x32_bf16 v[156:159], a[188:191], a[220:223], v[156:159]
    v_mfma_f32_16x16x32_bf16 v[172:175], a[184:187], a[192:195], v[172:175]
    ds_read_b64_tr_b16 a[156:157], v35 offset:24576
    v_mfma_f32_16x16x32_bf16 v[172:175], a[188:191], a[208:211], v[172:175]
    buffer_load_dwordx4 a[76:79], v56, s[28:31], s39 offen offset:1024 sc1
    v_mfma_f32_16x16x32_bf16 v[188:191], a[184:187], a[196:199], v[188:191]
    ds_read_b64_tr_b16 a[158:159], v35 offset:28672
    s_waitcnt vmcnt(28)
    v_mfma_f32_16x16x32_bf16 v[188:191], a[188:191], a[212:215], v[188:191]
    s_waitcnt lgkmcnt(8)
    v_mfma_f32_16x16x32_bf16 v[96:99], a[128:131], a[232:235], v[96:99]
    ds_read_b64_tr_b16 a[160:161], v36 offset:16384
    s_add_u32 m0, s56, 65536
    v_mfma_f32_16x16x32_bf16 v[96:99], a[132:135], a[248:251], v[96:99]
    ds_read_b64_tr_b16 a[162:163], v36 offset:20480
    s_bfe_u32 s38, s80, 0x4000c
    s_lshl_b32 s38, s38, 18
    s_add_u32 s38, s38, 0
    v_mfma_f32_16x16x32_bf16 v[112:115], a[128:131], a[236:239], v[112:115]
    buffer_load_dwordx4 v30, s[12:15], s38 offen offset:0 lds
    s_add_u32 m0, s56, 65536
    v_mfma_f32_16x16x32_bf16 v[112:115], a[132:135], a[252:255], v[112:115]
    ds_read_b64_tr_b16 a[164:165], v36 offset:24576
    s_bfe_u32 s38, s80, 0x4000c
    s_lshl_b32 s38, s38, 18
    s_add_u32 s38, s38, 15360
    v_mfma_f32_16x16x32_bf16 v[64:67], a[128:131], a[224:227], v[64:67]
    ds_read_b64_tr_b16 a[166:167], v36 offset:28672
    v_mfma_f32_16x16x32_bf16 v[64:67], a[132:135], a[240:243], v[64:67]
    buffer_load_dwordx4 v30, s[12:15], s38 offen offset:1024 lds
    v_mfma_f32_16x16x32_bf16 v[80:83], a[128:131], a[228:231], v[80:83]
    ds_read_b64_tr_b16 a[168:169], v37 offset:16384
    v_mfma_f32_16x16x32_bf16 v[80:83], a[132:135], a[244:247], v[80:83]
    v_mfma_f32_16x16x32_bf16 v[100:103], a[136:139], a[232:235], v[100:103]
    ds_read_b64_tr_b16 a[170:171], v37 offset:20480
    v_mfma_f32_16x16x32_bf16 v[100:103], a[140:143], a[248:251], v[100:103]
    ds_read_b64_tr_b16 a[172:173], v37 offset:24576
    v_mfma_f32_16x16x32_bf16 v[116:119], a[136:139], a[236:239], v[116:119]
    buffer_load_dwordx4 a[80:83], v53, s[28:31], s39 offen offset:0 sc1
    v_mfma_f32_16x16x32_bf16 v[116:119], a[140:143], a[252:255], v[116:119]
    ds_read_b64_tr_b16 a[174:175], v37 offset:28672
    v_mfma_f32_16x16x32_bf16 v[68:71], a[136:139], a[224:227], v[68:71]
    v_mfma_f32_16x16x32_bf16 v[68:71], a[140:143], a[240:243], v[68:71]
    ds_read_b64_tr_b16 a[176:177], v38 offset:16384
    v_mfma_f32_16x16x32_bf16 v[84:87], a[136:139], a[228:231], v[84:87]
    ds_read_b64_tr_b16 a[178:179], v38 offset:20480
    v_mfma_f32_16x16x32_bf16 v[84:87], a[140:143], a[244:247], v[84:87]
    s_waitcnt lgkmcnt(10)
    buffer_load_dwordx4 a[84:87], v53, s[28:31], s39 offen offset:1024 sc1
    v_mfma_f32_16x16x32_bf16 v[104:107], a[144:147], a[232:235], v[104:107]
    ds_read_b64_tr_b16 a[180:181], v38 offset:24576
    v_mfma_f32_16x16x32_bf16 v[104:107], a[148:151], a[248:251], v[104:107]
    ds_read_b64_tr_b16 a[182:183], v38 offset:28672
    v_mfma_f32_16x16x32_bf16 v[120:123], a[144:147], a[236:239], v[120:123]
    v_mfma_f32_16x16x32_bf16 v[120:123], a[148:151], a[252:255], v[120:123]
    ds_read_b64_tr_b16 a[184:185], v39 offset:16384
    v_mfma_f32_16x16x32_bf16 v[72:75], a[144:147], a[224:227], v[72:75]
    buffer_load_dwordx4 a[88:91], v57, s[28:31], s39 offen offset:0 sc1
    v_mfma_f32_16x16x32_bf16 v[72:75], a[148:151], a[240:243], v[72:75]
    ds_read_b64_tr_b16 a[186:187], v39 offset:20480
    v_mfma_f32_16x16x32_bf16 v[88:91], a[144:147], a[228:231], v[88:91]
    ds_read_b64_tr_b16 a[188:189], v39 offset:24576
    v_mfma_f32_16x16x32_bf16 v[88:91], a[148:151], a[244:247], v[88:91]
    v_mfma_f32_16x16x32_bf16 v[108:111], a[152:155], a[232:235], v[108:111]
    ds_read_b64_tr_b16 a[190:191], v39 offset:28672
    v_mfma_f32_16x16x32_bf16 v[108:111], a[156:159], a[248:251], v[108:111]
    buffer_load_dwordx4 a[92:95], v57, s[28:31], s39 offen offset:1024 sc1
    s_add_u32 s39, s47, s6
    v_mfma_f32_16x16x32_bf16 v[124:127], a[152:155], a[236:239], v[124:127]
    v_mfma_f32_16x16x32_bf16 v[124:127], a[156:159], a[252:255], v[124:127]
    v_mfma_f32_16x16x32_bf16 v[76:79], a[152:155], a[224:227], v[76:79]
    v_mfma_f32_16x16x32_bf16 v[76:79], a[156:159], a[240:243], v[76:79]
    buffer_load_dwordx4 a[96:99], v52, s[28:31], s39 offen offset:0 sc1
    v_mfma_f32_16x16x32_bf16 v[92:95], a[152:155], a[228:231], v[92:95]
    v_mfma_f32_16x16x32_bf16 v[92:95], a[156:159], a[244:247], v[92:95]
    s_waitcnt lgkmcnt(0)
    s_barrier
    v_mfma_f32_16x16x32_bf16 v[128:131], a[160:163], a[232:235], v[128:131]
    ds_read_b64_tr_b16 a[128:129], v32 offset:32768
    s_lshl3_add_u32 s38, s6, s45
    v_mfma_f32_16x16x32_bf16 v[128:131], a[164:167], a[248:251], v[128:131]
    s_add_u32 m0, s56, 16384
    s_nop 0
    buffer_load_dwordx4 v16, s[8:11], s38 offen offset:0 lds
    v_mfma_f32_16x16x32_bf16 v[144:147], a[160:163], a[236:239], v[144:147]
    ds_read_b64_tr_b16 a[130:131], v32 offset:36864
    v_mfma_f32_16x16x32_bf16 v[144:147], a[164:167], a[252:255], v[144:147]
    v_mfma_f32_16x16x32_bf16 v[160:163], a[160:163], a[224:227], v[160:163]
    ds_read_b64_tr_b16 a[132:133], v32 offset:40960
    v_mfma_f32_16x16x32_bf16 v[160:163], a[164:167], a[240:243], v[160:163]
    buffer_load_dwordx4 v17, s[8:11], s38 offen offset:1024 lds
    v_mfma_f32_16x16x32_bf16 v[176:179], a[160:163], a[228:231], v[176:179]
    ds_read_b64_tr_b16 a[134:135], v32 offset:45056
    v_mfma_f32_16x16x32_bf16 v[176:179], a[164:167], a[244:247], v[176:179]
    v_mfma_f32_16x16x32_bf16 v[132:135], a[168:171], a[232:235], v[132:135]
    ds_read_b64_tr_b16 a[136:137], v33 offset:32768
    v_mfma_f32_16x16x32_bf16 v[132:135], a[172:175], a[248:251], v[132:135]
    buffer_load_dwordx4 v18, s[8:11], s38 offen offset:2048 lds
    v_mfma_f32_16x16x32_bf16 v[148:151], a[168:171], a[236:239], v[148:151]
    ds_read_b64_tr_b16 a[138:139], v33 offset:36864
    v_mfma_f32_16x16x32_bf16 v[148:151], a[172:175], a[252:255], v[148:151]
    v_mfma_f32_16x16x32_bf16 v[164:167], a[168:171], a[224:227], v[164:167]
    ds_read_b64_tr_b16 a[140:141], v33 offset:40960
    v_mfma_f32_16x16x32_bf16 v[164:167], a[172:175], a[240:243], v[164:167]
    buffer_load_dwordx4 v19, s[8:11], s38 offen offset:3072 lds
    v_mfma_f32_16x16x32_bf16 v[180:183], a[168:171], a[228:231], v[180:183]
    ds_read_b64_tr_b16 a[142:143], v33 offset:45056
    v_mfma_f32_16x16x32_bf16 v[180:183], a[172:175], a[244:247], v[180:183]
    v_mfma_f32_16x16x32_bf16 v[136:139], a[176:179], a[232:235], v[136:139]
    ds_read_b64_tr_b16 a[144:145], v34 offset:32768
    v_mfma_f32_16x16x32_bf16 v[136:139], a[180:183], a[248:251], v[136:139]
    buffer_load_dwordx4 a[100:103], v52, s[28:31], s39 offen offset:1024 sc1
    v_mfma_f32_16x16x32_bf16 v[152:155], a[176:179], a[236:239], v[152:155]
    ds_read_b64_tr_b16 a[146:147], v34 offset:36864
    v_mfma_f32_16x16x32_bf16 v[152:155], a[180:183], a[252:255], v[152:155]
    v_mfma_f32_16x16x32_bf16 v[168:171], a[176:179], a[224:227], v[168:171]
    ds_read_b64_tr_b16 a[148:149], v34 offset:40960
    v_mfma_f32_16x16x32_bf16 v[168:171], a[180:183], a[240:243], v[168:171]
    buffer_load_dwordx4 a[104:107], v56, s[28:31], s39 offen offset:0 sc1
    v_mfma_f32_16x16x32_bf16 v[184:187], a[176:179], a[228:231], v[184:187]
    ds_read_b64_tr_b16 a[150:151], v34 offset:45056
    v_mfma_f32_16x16x32_bf16 v[184:187], a[180:183], a[244:247], v[184:187]
    v_mfma_f32_16x16x32_bf16 v[140:143], a[184:187], a[232:235], v[140:143]
    ds_read_b64_tr_b16 a[152:153], v35 offset:32768
    v_mfma_f32_16x16x32_bf16 v[140:143], a[188:191], a[248:251], v[140:143]
    buffer_load_dwordx4 a[108:111], v56, s[28:31], s39 offen offset:1024 sc1
    v_mfma_f32_16x16x32_bf16 v[156:159], a[184:187], a[236:239], v[156:159]
    ds_read_b64_tr_b16 a[154:155], v35 offset:36864
    v_mfma_f32_16x16x32_bf16 v[156:159], a[188:191], a[252:255], v[156:159]
    v_mfma_f32_16x16x32_bf16 v[172:175], a[184:187], a[224:227], v[172:175]
    ds_read_b64_tr_b16 a[156:157], v35 offset:40960
    v_mfma_f32_16x16x32_bf16 v[172:175], a[188:191], a[240:243], v[172:175]
    buffer_load_dwordx4 a[112:115], v53, s[28:31], s39 offen offset:0 sc1
    v_mfma_f32_16x16x32_bf16 v[188:191], a[184:187], a[228:231], v[188:191]
    ds_read_b64_tr_b16 a[158:159], v35 offset:45056
    s_waitcnt vmcnt(31)
    v_mfma_f32_16x16x32_bf16 v[188:191], a[188:191], a[244:247], v[188:191]
    s_waitcnt lgkmcnt(8)
    v_mfma_f32_16x16x32_bf16 v[96:99], a[128:131], a[8:11], v[96:99]
    ds_read_b64_tr_b16 a[160:161], v36 offset:32768
    s_add_u32 m0, s56, 65536
    v_mfma_f32_16x16x32_bf16 v[96:99], a[132:135], a[24:27], v[96:99]
    ds_read_b64_tr_b16 a[162:163], v36 offset:36864
    s_bfe_u32 s38, s80, 0x4000c
    s_lshl_b32 s38, s38, 18
    s_add_u32 s38, s38, 30720
    v_mfma_f32_16x16x32_bf16 v[112:115], a[128:131], a[12:15], v[112:115]
    buffer_load_dwordx4 v30, s[12:15], s38 offen offset:2048 lds
    s_add_u32 m0, s56, 65536
    v_mfma_f32_16x16x32_bf16 v[112:115], a[132:135], a[28:31], v[112:115]
    ds_read_b64_tr_b16 a[164:165], v36 offset:40960
    s_bfe_u32 s38, s80, 0x4000c
    s_lshl_b32 s38, s38, 18
    s_add_u32 s38, s38, 46080
    v_mfma_f32_16x16x32_bf16 v[64:67], a[128:131], a[0:3], v[64:67]
    ds_read_b64_tr_b16 a[166:167], v36 offset:45056
    v_mfma_f32_16x16x32_bf16 v[64:67], a[132:135], a[16:19], v[64:67]
    buffer_load_dwordx4 v30, s[12:15], s38 offen offset:3072 lds
    v_mfma_f32_16x16x32_bf16 v[80:83], a[128:131], a[4:7], v[80:83]
    ds_read_b64_tr_b16 a[168:169], v37 offset:32768
    v_mfma_f32_16x16x32_bf16 v[80:83], a[132:135], a[20:23], v[80:83]
    v_mfma_f32_16x16x32_bf16 v[100:103], a[136:139], a[8:11], v[100:103]
    ds_read_b64_tr_b16 a[170:171], v37 offset:36864
    v_mfma_f32_16x16x32_bf16 v[100:103], a[140:143], a[24:27], v[100:103]
    ds_read_b64_tr_b16 a[172:173], v37 offset:40960
    v_mfma_f32_16x16x32_bf16 v[116:119], a[136:139], a[12:15], v[116:119]
    buffer_load_dwordx4 a[116:119], v53, s[28:31], s39 offen offset:1024 sc1
    v_mfma_f32_16x16x32_bf16 v[116:119], a[140:143], a[28:31], v[116:119]
    ds_read_b64_tr_b16 a[174:175], v37 offset:45056
    v_mfma_f32_16x16x32_bf16 v[68:71], a[136:139], a[0:3], v[68:71]
    v_mfma_f32_16x16x32_bf16 v[68:71], a[140:143], a[16:19], v[68:71]
    ds_read_b64_tr_b16 a[176:177], v38 offset:32768
    v_mfma_f32_16x16x32_bf16 v[84:87], a[136:139], a[4:7], v[84:87]
    ds_read_b64_tr_b16 a[178:179], v38 offset:36864
    v_mfma_f32_16x16x32_bf16 v[84:87], a[140:143], a[20:23], v[84:87]
    s_waitcnt lgkmcnt(10)
    buffer_load_dwordx4 a[120:123], v57, s[28:31], s39 offen offset:0 sc1
    v_mfma_f32_16x16x32_bf16 v[104:107], a[144:147], a[8:11], v[104:107]
    ds_read_b64_tr_b16 a[180:181], v38 offset:40960
    v_mfma_f32_16x16x32_bf16 v[104:107], a[148:151], a[24:27], v[104:107]
    ds_read_b64_tr_b16 a[182:183], v38 offset:45056
    v_mfma_f32_16x16x32_bf16 v[120:123], a[144:147], a[12:15], v[120:123]
    buffer_load_dwordx4 a[124:127], v57, s[28:31], s39 offen offset:1024 sc1
    s_add_u32 s39, s47, s7
    v_mfma_f32_16x16x32_bf16 v[120:123], a[148:151], a[28:31], v[120:123]
    ds_read_b64_tr_b16 a[184:185], v39 offset:32768
    v_mfma_f32_16x16x32_bf16 v[72:75], a[144:147], a[0:3], v[72:75]
    v_mfma_f32_16x16x32_bf16 v[72:75], a[148:151], a[16:19], v[72:75]
    ds_read_b64_tr_b16 a[186:187], v39 offset:36864
    v_mfma_f32_16x16x32_bf16 v[88:91], a[144:147], a[4:7], v[88:91]
    ds_read_b64_tr_b16 a[188:189], v39 offset:40960
    v_mfma_f32_16x16x32_bf16 v[88:91], a[148:151], a[20:23], v[88:91]
    buffer_load_dwordx4 a[192:195], v52, s[28:31], s39 offen offset:0 sc1
    v_mfma_f32_16x16x32_bf16 v[108:111], a[152:155], a[8:11], v[108:111]
    ds_read_b64_tr_b16 a[190:191], v39 offset:45056
    v_mfma_f32_16x16x32_bf16 v[108:111], a[156:159], a[24:27], v[108:111]
    v_mfma_f32_16x16x32_bf16 v[124:127], a[152:155], a[12:15], v[124:127]
    buffer_load_dwordx4 a[196:199], v52, s[28:31], s39 offen offset:1024 sc1
    v_mfma_f32_16x16x32_bf16 v[124:127], a[156:159], a[28:31], v[124:127]
    v_mfma_f32_16x16x32_bf16 v[76:79], a[152:155], a[0:3], v[76:79]
    v_mfma_f32_16x16x32_bf16 v[76:79], a[156:159], a[16:19], v[76:79]
    v_mfma_f32_16x16x32_bf16 v[92:95], a[152:155], a[4:7], v[92:95]
    buffer_load_dwordx4 a[200:203], v56, s[28:31], s39 offen offset:0 sc1
    v_mfma_f32_16x16x32_bf16 v[92:95], a[156:159], a[20:23], v[92:95]
    s_waitcnt lgkmcnt(0)
    s_barrier
    v_mfma_f32_16x16x32_bf16 v[128:131], a[160:163], a[8:11], v[128:131]
    ds_read_b64_tr_b16 a[128:129], v32 offset:49152
    s_lshl3_add_u32 s38, s7, s45
    v_mfma_f32_16x16x32_bf16 v[128:131], a[164:167], a[24:27], v[128:131]
    s_add_u32 m0, s56, 32768
    s_nop 0
    buffer_load_dwordx4 v16, s[8:11], s38 offen offset:0 lds
    v_mfma_f32_16x16x32_bf16 v[144:147], a[160:163], a[12:15], v[144:147]
    ds_read_b64_tr_b16 a[130:131], v32 offset:53248
    v_mfma_f32_16x16x32_bf16 v[144:147], a[164:167], a[28:31], v[144:147]
    v_mfma_f32_16x16x32_bf16 v[160:163], a[160:163], a[0:3], v[160:163]
    ds_read_b64_tr_b16 a[132:133], v32 offset:57344
    v_mfma_f32_16x16x32_bf16 v[160:163], a[164:167], a[16:19], v[160:163]
    buffer_load_dwordx4 v17, s[8:11], s38 offen offset:1024 lds
    v_mfma_f32_16x16x32_bf16 v[176:179], a[160:163], a[4:7], v[176:179]
    ds_read_b64_tr_b16 a[134:135], v32 offset:61440
    v_mfma_f32_16x16x32_bf16 v[176:179], a[164:167], a[20:23], v[176:179]
    v_mfma_f32_16x16x32_bf16 v[132:135], a[168:171], a[8:11], v[132:135]
    ds_read_b64_tr_b16 a[136:137], v33 offset:49152
    v_mfma_f32_16x16x32_bf16 v[132:135], a[172:175], a[24:27], v[132:135]
    buffer_load_dwordx4 v18, s[8:11], s38 offen offset:2048 lds
    v_mfma_f32_16x16x32_bf16 v[148:151], a[168:171], a[12:15], v[148:151]
    ds_read_b64_tr_b16 a[138:139], v33 offset:53248
    v_mfma_f32_16x16x32_bf16 v[148:151], a[172:175], a[28:31], v[148:151]
    v_mfma_f32_16x16x32_bf16 v[164:167], a[168:171], a[0:3], v[164:167]
    ds_read_b64_tr_b16 a[140:141], v33 offset:57344
    v_mfma_f32_16x16x32_bf16 v[164:167], a[172:175], a[16:19], v[164:167]
    buffer_load_dwordx4 v19, s[8:11], s38 offen offset:3072 lds
    v_mfma_f32_16x16x32_bf16 v[180:183], a[168:171], a[4:7], v[180:183]
    ds_read_b64_tr_b16 a[142:143], v33 offset:61440
    v_mfma_f32_16x16x32_bf16 v[180:183], a[172:175], a[20:23], v[180:183]
    v_mfma_f32_16x16x32_bf16 v[136:139], a[176:179], a[8:11], v[136:139]
    ds_read_b64_tr_b16 a[144:145], v34 offset:49152
    v_mfma_f32_16x16x32_bf16 v[136:139], a[180:183], a[24:27], v[136:139]
    buffer_load_dwordx4 a[204:207], v56, s[28:31], s39 offen offset:1024 sc1
    v_mfma_f32_16x16x32_bf16 v[152:155], a[176:179], a[12:15], v[152:155]
    ds_read_b64_tr_b16 a[146:147], v34 offset:53248
    v_mfma_f32_16x16x32_bf16 v[152:155], a[180:183], a[28:31], v[152:155]
    v_mfma_f32_16x16x32_bf16 v[168:171], a[176:179], a[0:3], v[168:171]
    ds_read_b64_tr_b16 a[148:149], v34 offset:57344
    v_mfma_f32_16x16x32_bf16 v[168:171], a[180:183], a[16:19], v[168:171]
    buffer_load_dwordx4 a[208:211], v53, s[28:31], s39 offen offset:0 sc1
    v_mfma_f32_16x16x32_bf16 v[184:187], a[176:179], a[4:7], v[184:187]
    ds_read_b64_tr_b16 a[150:151], v34 offset:61440
    v_mfma_f32_16x16x32_bf16 v[184:187], a[180:183], a[20:23], v[184:187]
    v_mfma_f32_16x16x32_bf16 v[140:143], a[184:187], a[8:11], v[140:143]
    ds_read_b64_tr_b16 a[152:153], v35 offset:49152
    v_mfma_f32_16x16x32_bf16 v[140:143], a[188:191], a[24:27], v[140:143]
    buffer_load_dwordx4 a[212:215], v53, s[28:31], s39 offen offset:1024 sc1
    v_mfma_f32_16x16x32_bf16 v[156:159], a[184:187], a[12:15], v[156:159]
    ds_read_b64_tr_b16 a[154:155], v35 offset:53248
    v_mfma_f32_16x16x32_bf16 v[156:159], a[188:191], a[28:31], v[156:159]
    v_mfma_f32_16x16x32_bf16 v[172:175], a[184:187], a[0:3], v[172:175]
    ds_read_b64_tr_b16 a[156:157], v35 offset:57344
    v_mfma_f32_16x16x32_bf16 v[172:175], a[188:191], a[16:19], v[172:175]
    buffer_load_dwordx4 a[216:219], v57, s[28:31], s39 offen offset:0 sc1
    v_mfma_f32_16x16x32_bf16 v[188:191], a[184:187], a[4:7], v[188:191]
    ds_read_b64_tr_b16 a[158:159], v35 offset:61440
    s_waitcnt vmcnt(39)
    v_mfma_f32_16x16x32_bf16 v[188:191], a[188:191], a[20:23], v[188:191]
    s_waitcnt lgkmcnt(8)
    v_mfma_f32_16x16x32_bf16 v[96:99], a[128:131], a[40:43], v[96:99]
    ds_read_b64_tr_b16 a[160:161], v36 offset:49152
    s_add_u32 m0, s56, 4294942720
    v_mfma_f32_16x16x32_bf16 v[96:99], a[132:135], a[56:59], v[96:99]
    ds_read_b64_tr_b16 a[162:163], v36 offset:53248
    s_bfe_u32 s38, s80, 0x40010
    s_lshl_b32 s38, s38, 18
    s_add_u32 s38, s38, 0
    v_mfma_f32_16x16x32_bf16 v[112:115], a[128:131], a[44:47], v[112:115]
    buffer_load_dwordx4 v30, s[12:15], s38 offen offset:0 lds
    s_add_u32 m0, s56, 4294942720
    v_mfma_f32_16x16x32_bf16 v[112:115], a[132:135], a[60:63], v[112:115]
    ds_read_b64_tr_b16 a[164:165], v36 offset:57344
    s_bfe_u32 s38, s80, 0x40010
    s_lshl_b32 s38, s38, 18
    s_add_u32 s38, s38, 15360
    v_mfma_f32_16x16x32_bf16 v[64:67], a[128:131], a[32:35], v[64:67]
    ds_read_b64_tr_b16 a[166:167], v36 offset:61440
    v_mfma_f32_16x16x32_bf16 v[64:67], a[132:135], a[48:51], v[64:67]
    buffer_load_dwordx4 v30, s[12:15], s38 offen offset:1024 lds
    v_mfma_f32_16x16x32_bf16 v[80:83], a[128:131], a[36:39], v[80:83]
    ds_read_b64_tr_b16 a[168:169], v37 offset:49152
    v_mfma_f32_16x16x32_bf16 v[80:83], a[132:135], a[52:55], v[80:83]
    v_mfma_f32_16x16x32_bf16 v[100:103], a[136:139], a[40:43], v[100:103]
    ds_read_b64_tr_b16 a[170:171], v37 offset:53248
    v_mfma_f32_16x16x32_bf16 v[100:103], a[140:143], a[56:59], v[100:103]
    ds_read_b64_tr_b16 a[172:173], v37 offset:57344
    v_mfma_f32_16x16x32_bf16 v[116:119], a[136:139], a[44:47], v[116:119]
    buffer_load_dwordx4 a[220:223], v57, s[28:31], s39 offen offset:1024 sc1
    s_add_u32 s39, s47, s36
    v_mfma_f32_16x16x32_bf16 v[116:119], a[140:143], a[60:63], v[116:119]
    ds_read_b64_tr_b16 a[174:175], v37 offset:61440
    v_mfma_f32_16x16x32_bf16 v[68:71], a[136:139], a[32:35], v[68:71]
    v_mfma_f32_16x16x32_bf16 v[68:71], a[140:143], a[48:51], v[68:71]
    ds_read_b64_tr_b16 a[176:177], v38 offset:49152
    v_mfma_f32_16x16x32_bf16 v[84:87], a[136:139], a[36:39], v[84:87]
    ds_read_b64_tr_b16 a[178:179], v38 offset:53248
    v_mfma_f32_16x16x32_bf16 v[84:87], a[140:143], a[52:55], v[84:87]
    s_waitcnt lgkmcnt(10)
    buffer_load_dwordx4 a[224:227], v52, s[28:31], s39 offen offset:0 sc1
    v_mfma_f32_16x16x32_bf16 v[104:107], a[144:147], a[40:43], v[104:107]
    ds_read_b64_tr_b16 a[180:181], v38 offset:57344
    v_mfma_f32_16x16x32_bf16 v[104:107], a[148:151], a[56:59], v[104:107]
    ds_read_b64_tr_b16 a[182:183], v38 offset:61440
    v_mfma_f32_16x16x32_bf16 v[120:123], a[144:147], a[44:47], v[120:123]
    v_mfma_f32_16x16x32_bf16 v[120:123], a[148:151], a[60:63], v[120:123]
    ds_read_b64_tr_b16 a[184:185], v39 offset:49152
    v_mfma_f32_16x16x32_bf16 v[72:75], a[144:147], a[32:35], v[72:75]
    buffer_load_dwordx4 a[228:231], v52, s[28:31], s39 offen offset:1024 sc1
    v_mfma_f32_16x16x32_bf16 v[72:75], a[148:151], a[48:51], v[72:75]
    ds_read_b64_tr_b16 a[186:187], v39 offset:53248
    v_mfma_f32_16x16x32_bf16 v[88:91], a[144:147], a[36:39], v[88:91]
    ds_read_b64_tr_b16 a[188:189], v39 offset:57344
    v_mfma_f32_16x16x32_bf16 v[88:91], a[148:151], a[52:55], v[88:91]
    v_mfma_f32_16x16x32_bf16 v[108:111], a[152:155], a[40:43], v[108:111]
    ds_read_b64_tr_b16 a[190:191], v39 offset:61440
    v_mfma_f32_16x16x32_bf16 v[108:111], a[156:159], a[56:59], v[108:111]
    buffer_load_dwordx4 a[232:235], v56, s[28:31], s39 offen offset:0 sc1
    v_mfma_f32_16x16x32_bf16 v[124:127], a[152:155], a[44:47], v[124:127]
    v_mfma_f32_16x16x32_bf16 v[124:127], a[156:159], a[60:63], v[124:127]
    v_mfma_f32_16x16x32_bf16 v[76:79], a[152:155], a[32:35], v[76:79]
    v_mfma_f32_16x16x32_bf16 v[76:79], a[156:159], a[48:51], v[76:79]
    buffer_load_dwordx4 a[236:239], v56, s[28:31], s39 offen offset:1024 sc1
    v_mfma_f32_16x16x32_bf16 v[92:95], a[152:155], a[36:39], v[92:95]
    v_mfma_f32_16x16x32_bf16 v[92:95], a[156:159], a[52:55], v[92:95]
    s_waitcnt vmcnt(42) lgkmcnt(0)
    s_barrier
    v_mfma_f32_16x16x32_bf16 v[128:131], a[160:163], a[40:43], v[128:131]
    ds_read_b64_tr_b16 a[128:129], v32 offset:0
    s_lshl3_add_u32 s38, s36, s45
    v_mfma_f32_16x16x32_bf16 v[128:131], a[164:167], a[56:59], v[128:131]
    s_add_u32 m0, s56, 49152
    s_nop 0
    buffer_load_dwordx4 v16, s[8:11], s38 offen offset:0 lds
    v_mfma_f32_16x16x32_bf16 v[144:147], a[160:163], a[44:47], v[144:147]
    ds_read_b64_tr_b16 a[130:131], v32 offset:4096
    v_mfma_f32_16x16x32_bf16 v[144:147], a[164:167], a[60:63], v[144:147]
    v_mfma_f32_16x16x32_bf16 v[160:163], a[160:163], a[32:35], v[160:163]
    ds_read_b64_tr_b16 a[132:133], v32 offset:8192
    v_mfma_f32_16x16x32_bf16 v[160:163], a[164:167], a[48:51], v[160:163]
    buffer_load_dwordx4 v17, s[8:11], s38 offen offset:1024 lds
    v_mfma_f32_16x16x32_bf16 v[176:179], a[160:163], a[36:39], v[176:179]
    ds_read_b64_tr_b16 a[134:135], v32 offset:12288
    v_mfma_f32_16x16x32_bf16 v[176:179], a[164:167], a[52:55], v[176:179]
    buffer_load_dwordx4 v18, s[8:11], s38 offen offset:2048 lds
    v_mfma_f32_16x16x32_bf16 v[132:135], a[168:171], a[40:43], v[132:135]
    ds_read_b64_tr_b16 a[136:137], v33 offset:0
    v_mfma_f32_16x16x32_bf16 v[132:135], a[172:175], a[56:59], v[132:135]
    v_mfma_f32_16x16x32_bf16 v[148:151], a[168:171], a[44:47], v[148:151]
    ds_read_b64_tr_b16 a[138:139], v33 offset:4096
    v_mfma_f32_16x16x32_bf16 v[148:151], a[172:175], a[60:63], v[148:151]
    buffer_load_dwordx4 v19, s[8:11], s38 offen offset:3072 lds
    v_mfma_f32_16x16x32_bf16 v[164:167], a[168:171], a[32:35], v[164:167]
    ds_read_b64_tr_b16 a[140:141], v33 offset:8192
    v_mfma_f32_16x16x32_bf16 v[164:167], a[172:175], a[48:51], v[164:167]
    v_mfma_f32_16x16x32_bf16 v[180:183], a[168:171], a[36:39], v[180:183]
    ds_read_b64_tr_b16 a[142:143], v33 offset:12288
    v_mfma_f32_16x16x32_bf16 v[180:183], a[172:175], a[52:55], v[180:183]
    buffer_load_dwordx4 a[240:243], v53, s[28:31], s39 offen offset:0 sc1
    v_mfma_f32_16x16x32_bf16 v[136:139], a[176:179], a[40:43], v[136:139]
    ds_read_b64_tr_b16 a[144:145], v34 offset:0
    v_mfma_f32_16x16x32_bf16 v[136:139], a[180:183], a[56:59], v[136:139]
    v_mfma_f32_16x16x32_bf16 v[152:155], a[176:179], a[44:47], v[152:155]
    ds_read_b64_tr_b16 a[146:147], v34 offset:4096
    v_mfma_f32_16x16x32_bf16 v[152:155], a[180:183], a[60:63], v[152:155]
    buffer_load_dwordx4 a[244:247], v53, s[28:31], s39 offen offset:1024 sc1
    v_mfma_f32_16x16x32_bf16 v[168:171], a[176:179], a[32:35], v[168:171]
    ds_read_b64_tr_b16 a[148:149], v34 offset:8192
    v_mfma_f32_16x16x32_bf16 v[168:171], a[180:183], a[48:51], v[168:171]
    v_mfma_f32_16x16x32_bf16 v[184:187], a[176:179], a[36:39], v[184:187]
    ds_read_b64_tr_b16 a[150:151], v34 offset:12288
    v_mfma_f32_16x16x32_bf16 v[184:187], a[180:183], a[52:55], v[184:187]
    buffer_load_dwordx4 a[248:251], v57, s[28:31], s39 offen offset:0 sc1
    v_mfma_f32_16x16x32_bf16 v[140:143], a[184:187], a[40:43], v[140:143]
    ds_read_b64_tr_b16 a[152:153], v35 offset:0
    v_mfma_f32_16x16x32_bf16 v[140:143], a[188:191], a[56:59], v[140:143]
    buffer_load_dwordx4 a[252:255], v57, s[28:31], s39 offen offset:1024 sc1
    v_mfma_f32_16x16x32_bf16 v[156:159], a[184:187], a[44:47], v[156:159]
    ds_read_b64_tr_b16 a[154:155], v35 offset:4096
    v_mfma_f32_16x16x32_bf16 v[156:159], a[188:191], a[60:63], v[156:159]
    v_mfma_f32_16x16x32_bf16 v[172:175], a[184:187], a[32:35], v[172:175]
    ds_read_b64_tr_b16 a[156:157], v35 offset:8192
    v_mfma_f32_16x16x32_bf16 v[172:175], a[188:191], a[48:51], v[172:175]
    buffer_load_dword v3, v13, s[84:87], s59 offen sc1
    v_mfma_f32_16x16x32_bf16 v[188:191], a[184:187], a[36:39], v[188:191]
    ds_read_b64_tr_b16 a[158:159], v35 offset:12288
    s_waitcnt vmcnt(41)
    v_mfma_f32_16x16x32_bf16 v[188:191], a[188:191], a[52:55], v[188:191]
    s_waitcnt lgkmcnt(8)
    v_mfma_f32_16x16x32_bf16 v[96:99], a[128:131], a[72:75], v[96:99]
    ds_read_b64_tr_b16 a[160:161], v36 offset:0
    s_add_u32 m0, s56, 4294942720
    v_mfma_f32_16x16x32_bf16 v[96:99], a[132:135], a[88:91], v[96:99]
    ds_read_b64_tr_b16 a[162:163], v36 offset:4096
    s_bfe_u32 s38, s80, 0x40010
    s_lshl_b32 s38, s38, 18
    s_add_u32 s38, s38, 30720
    v_mfma_f32_16x16x32_bf16 v[112:115], a[128:131], a[76:79], v[112:115]
    buffer_load_dwordx4 v30, s[12:15], s38 offen offset:2048 lds
    s_add_u32 m0, s56, 4294942720
    v_mfma_f32_16x16x32_bf16 v[112:115], a[132:135], a[92:95], v[112:115]
    ds_read_b64_tr_b16 a[164:165], v36 offset:8192
    s_bfe_u32 s38, s80, 0x40010
    s_lshl_b32 s38, s38, 18
    s_add_u32 s38, s38, 46080
    v_mfma_f32_16x16x32_bf16 v[64:67], a[128:131], a[64:67], v[64:67]
    ds_read_b64_tr_b16 a[166:167], v36 offset:12288
    v_mfma_f32_16x16x32_bf16 v[64:67], a[132:135], a[80:83], v[64:67]
    buffer_load_dwordx4 v30, s[12:15], s38 offen offset:3072 lds
    s_add_u32 s39, s47, s37
    v_mfma_f32_16x16x32_bf16 v[80:83], a[128:131], a[68:71], v[80:83]
    ds_read_b64_tr_b16 a[168:169], v37 offset:0
    v_mfma_f32_16x16x32_bf16 v[80:83], a[132:135], a[84:87], v[80:83]
    v_mfma_f32_16x16x32_bf16 v[100:103], a[136:139], a[72:75], v[100:103]
    ds_read_b64_tr_b16 a[170:171], v37 offset:4096
    v_mfma_f32_16x16x32_bf16 v[100:103], a[140:143], a[88:91], v[100:103]
    ds_read_b64_tr_b16 a[172:173], v37 offset:8192
    v_mfma_f32_16x16x32_bf16 v[116:119], a[136:139], a[76:79], v[116:119]
    buffer_load_dwordx4 a[0:3], v52, s[28:31], s39 offen offset:0 sc1
    v_mfma_f32_16x16x32_bf16 v[116:119], a[140:143], a[92:95], v[116:119]
    ds_read_b64_tr_b16 a[174:175], v37 offset:12288
    v_mfma_f32_16x16x32_bf16 v[68:71], a[136:139], a[64:67], v[68:71]
    v_mfma_f32_16x16x32_bf16 v[68:71], a[140:143], a[80:83], v[68:71]
    ds_read_b64_tr_b16 a[176:177], v38 offset:0
    v_mfma_f32_16x16x32_bf16 v[84:87], a[136:139], a[68:71], v[84:87]
    ds_read_b64_tr_b16 a[178:179], v38 offset:4096
    v_mfma_f32_16x16x32_bf16 v[84:87], a[140:143], a[84:87], v[84:87]
    s_waitcnt lgkmcnt(10)
    buffer_load_dwordx4 a[4:7], v52, s[28:31], s39 offen offset:1024 sc1
    v_mfma_f32_16x16x32_bf16 v[104:107], a[144:147], a[72:75], v[104:107]
    ds_read_b64_tr_b16 a[180:181], v38 offset:8192
    v_mfma_f32_16x16x32_bf16 v[104:107], a[148:151], a[88:91], v[104:107]
    ds_read_b64_tr_b16 a[182:183], v38 offset:12288
    v_mfma_f32_16x16x32_bf16 v[120:123], a[144:147], a[76:79], v[120:123]
    buffer_load_dwordx4 a[8:11], v56, s[28:31], s39 offen offset:0 sc1
    v_mfma_f32_16x16x32_bf16 v[120:123], a[148:151], a[92:95], v[120:123]
    ds_read_b64_tr_b16 a[184:185], v39 offset:0
    v_mfma_f32_16x16x32_bf16 v[72:75], a[144:147], a[64:67], v[72:75]
    v_mfma_f32_16x16x32_bf16 v[72:75], a[148:151], a[80:83], v[72:75]
    ds_read_b64_tr_b16 a[186:187], v39 offset:4096
    v_mfma_f32_16x16x32_bf16 v[88:91], a[144:147], a[68:71], v[88:91]
    ds_read_b64_tr_b16 a[188:189], v39 offset:8192
    v_mfma_f32_16x16x32_bf16 v[88:91], a[148:151], a[84:87], v[88:91]
    buffer_load_dwordx4 a[12:15], v56, s[28:31], s39 offen offset:1024 sc1
    v_mfma_f32_16x16x32_bf16 v[108:111], a[152:155], a[72:75], v[108:111]
    ds_read_b64_tr_b16 a[190:191], v39 offset:12288
    v_mfma_f32_16x16x32_bf16 v[108:111], a[156:159], a[88:91], v[108:111]
    v_mfma_f32_16x16x32_bf16 v[124:127], a[152:155], a[76:79], v[124:127]
    buffer_load_dwordx4 a[16:19], v53, s[28:31], s39 offen offset:0 sc1
    v_mfma_f32_16x16x32_bf16 v[124:127], a[156:159], a[92:95], v[124:127]
    v_mfma_f32_16x16x32_bf16 v[76:79], a[152:155], a[64:67], v[76:79]
    v_mfma_f32_16x16x32_bf16 v[76:79], a[156:159], a[80:83], v[76:79]
    v_mfma_f32_16x16x32_bf16 v[92:95], a[152:155], a[68:71], v[92:95]
    buffer_load_dwordx4 a[20:23], v53, s[28:31], s39 offen offset:1024 sc1
    v_mfma_f32_16x16x32_bf16 v[92:95], a[156:159], a[84:87], v[92:95]
    s_waitcnt vmcnt(44) lgkmcnt(0)
    s_barrier
    v_mfma_f32_16x16x32_bf16 v[128:131], a[160:163], a[72:75], v[128:131]
    ds_read_b64_tr_b16 a[128:129], v32 offset:16384
    s_lshl3_add_u32 s38, s37, s45
    v_mfma_f32_16x16x32_bf16 v[128:131], a[164:167], a[88:91], v[128:131]
    s_add_u32 m0, s56, 0
    s_nop 0
    buffer_load_dwordx4 v16, s[8:11], s38 offen offset:0 lds
    v_mfma_f32_16x16x32_bf16 v[144:147], a[160:163], a[76:79], v[144:147]
    ds_read_b64_tr_b16 a[130:131], v32 offset:20480
    v_mfma_f32_16x16x32_bf16 v[144:147], a[164:167], a[92:95], v[144:147]
    v_mfma_f32_16x16x32_bf16 v[160:163], a[160:163], a[64:67], v[160:163]
    ds_read_b64_tr_b16 a[132:133], v32 offset:24576
    v_mfma_f32_16x16x32_bf16 v[160:163], a[164:167], a[80:83], v[160:163]
    buffer_load_dwordx4 v17, s[8:11], s38 offen offset:1024 lds
    v_mfma_f32_16x16x32_bf16 v[176:179], a[160:163], a[68:71], v[176:179]
    ds_read_b64_tr_b16 a[134:135], v32 offset:28672
    v_mfma_f32_16x16x32_bf16 v[176:179], a[164:167], a[84:87], v[176:179]
    v_mfma_f32_16x16x32_bf16 v[132:135], a[168:171], a[72:75], v[132:135]
    ds_read_b64_tr_b16 a[136:137], v33 offset:16384
    v_mfma_f32_16x16x32_bf16 v[132:135], a[172:175], a[88:91], v[132:135]
    buffer_load_dwordx4 v18, s[8:11], s38 offen offset:2048 lds
    v_mfma_f32_16x16x32_bf16 v[148:151], a[168:171], a[76:79], v[148:151]
    ds_read_b64_tr_b16 a[138:139], v33 offset:20480
    v_mfma_f32_16x16x32_bf16 v[148:151], a[172:175], a[92:95], v[148:151]
    v_mfma_f32_16x16x32_bf16 v[164:167], a[168:171], a[64:67], v[164:167]
    ds_read_b64_tr_b16 a[140:141], v33 offset:24576
    v_mfma_f32_16x16x32_bf16 v[164:167], a[172:175], a[80:83], v[164:167]
    buffer_load_dwordx4 v19, s[8:11], s38 offen offset:3072 lds
    v_mfma_f32_16x16x32_bf16 v[180:183], a[168:171], a[68:71], v[180:183]
    ds_read_b64_tr_b16 a[142:143], v33 offset:28672
    v_mfma_f32_16x16x32_bf16 v[180:183], a[172:175], a[84:87], v[180:183]
    v_mfma_f32_16x16x32_bf16 v[136:139], a[176:179], a[72:75], v[136:139]
    ds_read_b64_tr_b16 a[144:145], v34 offset:16384
    v_mfma_f32_16x16x32_bf16 v[136:139], a[180:183], a[88:91], v[136:139]
    buffer_load_dwordx4 a[24:27], v57, s[28:31], s39 offen offset:0 sc1
    v_mfma_f32_16x16x32_bf16 v[152:155], a[176:179], a[76:79], v[152:155]
    ds_read_b64_tr_b16 a[146:147], v34 offset:20480
    v_mfma_f32_16x16x32_bf16 v[152:155], a[180:183], a[92:95], v[152:155]
    v_mfma_f32_16x16x32_bf16 v[168:171], a[176:179], a[64:67], v[168:171]
    ds_read_b64_tr_b16 a[148:149], v34 offset:24576
    v_mfma_f32_16x16x32_bf16 v[168:171], a[180:183], a[80:83], v[168:171]
    buffer_load_dwordx4 a[28:31], v57, s[28:31], s39 offen offset:1024 sc1
    s_add_u32 s39, s47, s55
    v_mfma_f32_16x16x32_bf16 v[184:187], a[176:179], a[68:71], v[184:187]
    ds_read_b64_tr_b16 a[150:151], v34 offset:28672
    v_mfma_f32_16x16x32_bf16 v[184:187], a[180:183], a[84:87], v[184:187]
    v_mfma_f32_16x16x32_bf16 v[140:143], a[184:187], a[72:75], v[140:143]
    ds_read_b64_tr_b16 a[152:153], v35 offset:16384
    v_mfma_f32_16x16x32_bf16 v[140:143], a[188:191], a[88:91], v[140:143]
    buffer_load_dwordx4 a[32:35], v52, s[28:31], s39 offen offset:0 sc1
    v_mfma_f32_16x16x32_bf16 v[156:159], a[184:187], a[76:79], v[156:159]
    ds_read_b64_tr_b16 a[154:155], v35 offset:20480
    v_mfma_f32_16x16x32_bf16 v[156:159], a[188:191], a[92:95], v[156:159]
    v_mfma_f32_16x16x32_bf16 v[172:175], a[184:187], a[64:67], v[172:175]
    ds_read_b64_tr_b16 a[156:157], v35 offset:24576
    v_mfma_f32_16x16x32_bf16 v[172:175], a[188:191], a[80:83], v[172:175]
    buffer_load_dwordx4 a[36:39], v52, s[28:31], s39 offen offset:1024 sc1
    v_mfma_f32_16x16x32_bf16 v[188:191], a[184:187], a[68:71], v[188:191]
    ds_read_b64_tr_b16 a[158:159], v35 offset:28672
    s_waitcnt vmcnt(43)
    v_mfma_f32_16x16x32_bf16 v[188:191], a[188:191], a[84:87], v[188:191]
    s_waitcnt lgkmcnt(8)
    s_waitcnt vmcnt(16)
    v_cmp_ne_u32 vcc, s96, v3
    s_cbranch_vccz L_f2_ok
    s_mov_b32 s97, 0
L_f2_spin:
    s_sleep 1
    buffer_load_dword v3, v13, s[84:87], s59 offen sc1
    s_add_u32 s97, s97, 1
    s_waitcnt vmcnt(0)
    s_cmp_gt_u32 s97, 0x80000
    s_cbranch_scc1 L_f2_ok
    v_cmp_ne_u32 vcc, s96, v3
    s_cbranch_vccnz L_f2_spin
L_f2_ok:
    v_mfma_f32_16x16x32_bf16 v[96:99], a[128:131], a[104:107], v[96:99]
    ds_read_b64_tr_b16 a[160:161], v36 offset:16384
    v_mfma_f32_16x16x32_bf16 v[96:99], a[132:135], a[120:123], v[96:99]
    ds_read_b64_tr_b16 a[162:163], v36 offset:20480
    v_mfma_f32_16x16x32_bf16 v[112:115], a[128:131], a[108:111], v[112:115]
    buffer_load_dwordx4 v[240:243], v2, s[16:19], s72 offen offset:0
    v_mfma_f32_16x16x32_bf16 v[112:115], a[132:135], a[124:127], v[112:115]
    ds_read_b64_tr_b16 a[164:165], v36 offset:24576
    v_mfma_f32_16x16x32_bf16 v[64:67], a[128:131], a[96:99], v[64:67]
    ds_read_b64_tr_b16 a[166:167], v36 offset:28672
    v_mfma_f32_16x16x32_bf16 v[64:67], a[132:135], a[112:115], v[64:67]
    v_mfma_f32_16x16x32_bf16 v[80:83], a[128:131], a[100:103], v[80:83]
    ds_read_b64_tr_b16 a[168:169], v37 offset:16384
    v_mfma_f32_16x16x32_bf16 v[80:83], a[132:135], a[116:119], v[80:83]
    v_mfma_f32_16x16x32_bf16 v[100:103], a[136:139], a[104:107], v[100:103]
    ds_read_b64_tr_b16 a[170:171], v37 offset:20480
    v_mfma_f32_16x16x32_bf16 v[100:103], a[140:143], a[120:123], v[100:103]
    ds_read_b64_tr_b16 a[172:173], v37 offset:24576
    v_mfma_f32_16x16x32_bf16 v[116:119], a[136:139], a[108:111], v[116:119]
    buffer_load_dwordx4 v[244:247], v2, s[16:19], s72 offen offset:64
    v_mfma_f32_16x16x32_bf16 v[116:119], a[140:143], a[124:127], v[116:119]
    ds_read_b64_tr_b16 a[174:175], v37 offset:28672
    v_mfma_f32_16x16x32_bf16 v[68:71], a[136:139], a[96:99], v[68:71]
    v_mfma_f32_16x16x32_bf16 v[68:71], a[140:143], a[112:115], v[68:71]
    ds_read_b64_tr_b16 a[176:177], v38 offset:16384
    v_mfma_f32_16x16x32_bf16 v[84:87], a[136:139], a[100:103], v[84:87]
    ds_read_b64_tr_b16 a[178:179], v38 offset:20480
    v_mfma_f32_16x16x32_bf16 v[84:87], a[140:143], a[116:119], v[84:87]
    s_waitcnt lgkmcnt(10)
    buffer_load_dwordx4 a[40:43], v56, s[28:31], s39 offen offset:0 sc1
    v_mfma_f32_16x16x32_bf16 v[104:107], a[144:147], a[104:107], v[104:107]
    ds_read_b64_tr_b16 a[180:181], v38 offset:24576
    v_mfma_f32_16x16x32_bf16 v[104:107], a[148:151], a[120:123], v[104:107]
    ds_read_b64_tr_b16 a[182:183], v38 offset:28672
    v_mfma_f32_16x16x32_bf16 v[120:123], a[144:147], a[108:111], v[120:123]
    v_mfma_f32_16x16x32_bf16 v[120:123], a[148:151], a[124:127], v[120:123]
    ds_read_b64_tr_b16 a[184:185], v39 offset:16384
    v_mfma_f32_16x16x32_bf16 v[72:75], a[144:147], a[96:99], v[72:75]
    v_mfma_f32_16x16x32_bf16 v[72:75], a[148:151], a[112:115], v[72:75]
    ds_read_b64_tr_b16 a[186:187], v39 offset:20480
    v_mfma_f32_16x16x32_bf16 v[88:91], a[144:147], a[100:103], v[88:91]
    ds_read_b64_tr_b16 a[188:189], v39 offset:24576
    v_mfma_f32_16x16x32_bf16 v[88:91], a[148:151], a[116:119], v[88:91]
    buffer_load_dwordx4 a[44:47], v56, s[28:31], s39 offen offset:1024 sc1
    v_mfma_f32_16x16x32_bf16 v[108:111], a[152:155], a[104:107], v[108:111]
    ds_read_b64_tr_b16 a[190:191], v39 offset:28672
    v_mfma_f32_16x16x32_bf16 v[108:111], a[156:159], a[120:123], v[108:111]
    v_mfma_f32_16x16x32_bf16 v[124:127], a[152:155], a[108:111], v[124:127]
    v_mfma_f32_16x16x32_bf16 v[124:127], a[156:159], a[124:127], v[124:127]
    v_mfma_f32_16x16x32_bf16 v[76:79], a[152:155], a[96:99], v[76:79]
    buffer_load_dwordx4 a[48:51], v53, s[28:31], s39 offen offset:0 sc1
    v_mfma_f32_16x16x32_bf16 v[76:79], a[156:159], a[112:115], v[76:79]
    v_mfma_f32_16x16x32_bf16 v[92:95], a[152:155], a[100:103], v[92:95]
    v_mfma_f32_16x16x32_bf16 v[92:95], a[156:159], a[116:119], v[92:95]
    s_waitcnt lgkmcnt(0)
    s_barrier
    v_mfma_f32_16x16x32_bf16 v[128:131], a[160:163], a[104:107], v[128:131]
    ds_read_b64_tr_b16 a[128:129], v32 offset:32768
    s_lshl3_add_u32 s38, s55, s45
    v_mfma_f32_16x16x32_bf16 v[128:131], a[164:167], a[120:123], v[128:131]
    s_add_u32 m0, s56, 16384
    s_nop 0
    buffer_load_dwordx4 v16, s[8:11], s38 offen offset:0 lds
    v_mfma_f32_16x16x32_bf16 v[144:147], a[160:163], a[108:111], v[144:147]
    ds_read_b64_tr_b16 a[130:131], v32 offset:36864
    v_mfma_f32_16x16x32_bf16 v[144:147], a[164:167], a[124:127], v[144:147]
    v_mfma_f32_16x16x32_bf16 v[160:163], a[160:163], a[96:99], v[160:163]
    ds_read_b64_tr_b16 a[132:133], v32 offset:40960
    v_mfma_f32_16x16x32_bf16 v[160:163], a[164:167], a[112:115], v[160:163]
    buffer_load_dwordx4 v17, s[8:11], s38 offen offset:1024 lds
    v_mfma_f32_16x16x32_bf16 v[176:179], a[160:163], a[100:103], v[176:179]
    ds_read_b64_tr_b16 a[134:135], v32 offset:45056
    v_mfma_f32_16x16x32_bf16 v[176:179], a[164:167], a[116:119], v[176:179]
    v_mfma_f32_16x16x32_bf16 v[132:135], a[168:171], a[104:107], v[132:135]
    ds_read_b64_tr_b16 a[136:137], v33 offset:32768
    v_mfma_f32_16x16x32_bf16 v[132:135], a[172:175], a[120:123], v[132:135]
    buffer_load_dwordx4 v18, s[8:11], s38 offen offset:2048 lds
    v_mfma_f32_16x16x32_bf16 v[148:151], a[168:171], a[108:111], v[148:151]
    ds_read_b64_tr_b16 a[138:139], v33 offset:36864
    v_mfma_f32_16x16x32_bf16 v[148:151], a[172:175], a[124:127], v[148:151]
    v_mfma_f32_16x16x32_bf16 v[164:167], a[168:171], a[96:99], v[164:167]
    ds_read_b64_tr_b16 a[140:141], v33 offset:40960
    v_mfma_f32_16x16x32_bf16 v[164:167], a[172:175], a[112:115], v[164:167]
    buffer_load_dwordx4 v19, s[8:11], s38 offen offset:3072 lds
    v_mfma_f32_16x16x32_bf16 v[180:183], a[168:171], a[100:103], v[180:183]
    ds_read_b64_tr_b16 a[142:143], v33 offset:45056
    v_mfma_f32_16x16x32_bf16 v[180:183], a[172:175], a[116:119], v[180:183]
    v_mfma_f32_16x16x32_bf16 v[136:139], a[176:179], a[104:107], v[136:139]
    ds_read_b64_tr_b16 a[144:145], v34 offset:32768
    v_mfma_f32_16x16x32_bf16 v[136:139], a[180:183], a[120:123], v[136:139]
    buffer_load_dwordx4 a[52:55], v53, s[28:31], s39 offen offset:1024 sc1
    v_mfma_f32_16x16x32_bf16 v[152:155], a[176:179], a[108:111], v[152:155]
    ds_read_b64_tr_b16 a[146:147], v34 offset:36864
    v_mfma_f32_16x16x32_bf16 v[152:155], a[180:183], a[124:127], v[152:155]
    v_mfma_f32_16x16x32_bf16 v[168:171], a[176:179], a[96:99], v[168:171]
    ds_read_b64_tr_b16 a[148:149], v34 offset:40960
    v_mfma_f32_16x16x32_bf16 v[168:171], a[180:183], a[112:115], v[168:171]
    buffer_load_dwordx4 a[56:59], v57, s[28:31], s39 offen offset:0 sc1
    v_mfma_f32_16x16x32_bf16 v[184:187], a[176:179], a[100:103], v[184:187]
    ds_read_b64_tr_b16 a[150:151], v34 offset:45056
    v_mfma_f32_16x16x32_bf16 v[184:187], a[180:183], a[116:119], v[184:187]
    v_mfma_f32_16x16x32_bf16 v[140:143], a[184:187], a[104:107], v[140:143]
    ds_read_b64_tr_b16 a[152:153], v35 offset:32768
    v_mfma_f32_16x16x32_bf16 v[140:143], a[188:191], a[120:123], v[140:143]
    buffer_load_dwordx4 a[60:63], v57, s[28:31], s39 offen offset:1024 sc1
    s_bfe_u32 s39, s80, 0x40000
    s_lshl_b32 s39, s39, 15
    s_add_u32 s39, s39, s81
    v_mfma_f32_16x16x32_bf16 v[156:159], a[184:187], a[108:111], v[156:159]
    ds_read_b64_tr_b16 a[154:155], v35 offset:36864
    v_mfma_f32_16x16x32_bf16 v[156:159], a[188:191], a[124:127], v[156:159]
    v_mfma_f32_16x16x32_bf16 v[172:175], a[184:187], a[96:99], v[172:175]
    ds_read_b64_tr_b16 a[156:157], v35 offset:40960
    v_mfma_f32_16x16x32_bf16 v[172:175], a[188:191], a[112:115], v[172:175]
    buffer_load_dwordx4 a[64:67], v52, s[28:31], s39 offen offset:0 sc1
    v_mfma_f32_16x16x32_bf16 v[188:191], a[184:187], a[100:103], v[188:191]
    ds_read_b64_tr_b16 a[158:159], v35 offset:45056
    v_mfma_f32_16x16x32_bf16 v[188:191], a[188:191], a[116:119], v[188:191]
    s_waitcnt lgkmcnt(8)
    v_mfma_f32_16x16x32_bf16 v[96:99], a[128:131], a[200:203], v[96:99]
    ds_read_b64_tr_b16 a[160:161], v36 offset:32768
    v_mfma_f32_16x16x32_bf16 v[96:99], a[132:135], a[216:219], v[96:99]
    ds_read_b64_tr_b16 a[162:163], v36 offset:36864
    v_mfma_f32_16x16x32_bf16 v[112:115], a[128:131], a[204:207], v[112:115]
    buffer_load_dwordx4 v[248:251], v2, s[16:19], s73 offen offset:0
    v_mfma_f32_16x16x32_bf16 v[112:115], a[132:135], a[220:223], v[112:115]
    ds_read_b64_tr_b16 a[164:165], v36 offset:40960
    v_mfma_f32_16x16x32_bf16 v[64:67], a[128:131], a[192:195], v[64:67]
    ds_read_b64_tr_b16 a[166:167], v36 offset:45056
    v_mfma_f32_16x16x32_bf16 v[64:67], a[132:135], a[208:211], v[64:67]
    v_mfma_f32_16x16x32_bf16 v[80:83], a[128:131], a[196:199], v[80:83]
    ds_read_b64_tr_b16 a[168:169], v37 offset:32768
    v_mfma_f32_16x16x32_bf16 v[80:83], a[132:135], a[212:215], v[80:83]
    buffer_load_dwordx4 v[252:255], v2, s[16:19], s73 offen offset:64
    v_mfma_f32_16x16x32_bf16 v[100:103], a[136:139], a[200:203], v[100:103]
    ds_read_b64_tr_b16 a[170:171], v37 offset:36864
    v_mfma_f32_16x16x32_bf16 v[100:103], a[140:143], a[216:219], v[100:103]
    ds_read_b64_tr_b16 a[172:173], v37 offset:40960
    v_mfma_f32_16x16x32_bf16 v[116:119], a[136:139], a[204:207], v[116:119]
    v_mfma_f32_16x16x32_bf16 v[116:119], a[140:143], a[220:223], v[116:119]
    ds_read_b64_tr_b16 a[174:175], v37 offset:45056
    v_mfma_f32_16x16x32_bf16 v[68:71], a[136:139], a[192:195], v[68:71]
    buffer_load_dwordx4 a[68:71], v52, s[28:31], s39 offen offset:1024 sc1
    v_mfma_f32_16x16x32_bf16 v[68:71], a[140:143], a[208:211], v[68:71]
    ds_read_b64_tr_b16 a[176:177], v38 offset:32768
    v_mfma_f32_16x16x32_bf16 v[84:87], a[136:139], a[196:199], v[84:87]
    ds_read_b64_tr_b16 a[178:179], v38 offset:36864
    v_mfma_f32_16x16x32_bf16 v[84:87], a[140:143], a[212:215], v[84:87]
    s_waitcnt lgkmcnt(10)
    v_mfma_f32_16x16x32_bf16 v[104:107], a[144:147], a[200:203], v[104:107]
    ds_read_b64_tr_b16 a[180:181], v38 offset:40960
    v_mfma_f32_16x16x32_bf16 v[104:107], a[148:151], a[216:219], v[104:107]
    ds_read_b64_tr_b16 a[182:183], v38 offset:45056
    v_mfma_f32_16x16x32_bf16 v[120:123], a[144:147], a[204:207], v[120:123]
    buffer_load_dwordx4 a[72:75], v53, s[28:31], s39 offen offset:0 sc1
    v_mfma_f32_16x16x32_bf16 v[120:123], a[148:151], a[220:223], v[120:123]
    ds_read_b64_tr_b16 a[184:185], v39 offset:32768
    v_mfma_f32_16x16x32_bf16 v[72:75], a[144:147], a[192:195], v[72:75]
    v_mfma_f32_16x16x32_bf16 v[72:75], a[148:151], a[208:211], v[72:75]
    ds_read_b64_tr_b16 a[186:187], v39 offset:36864
    v_mfma_f32_16x16x32_bf16 v[88:91], a[144:147], a[196:199], v[88:91]
    ds_read_b64_tr_b16 a[188:189], v39 offset:40960
    v_mfma_f32_16x16x32_bf16 v[88:91], a[148:151], a[212:215], v[88:91]
    buffer_load_dwordx4 a[76:79], v53, s[28:31], s39 offen offset:1024 sc1
    v_mfma_f32_16x16x32_bf16 v[108:111], a[152:155], a[200:203], v[108:111]
    ds_read_b64_tr_b16 a[190:191], v39 offset:45056
    v_mfma_f32_16x16x32_bf16 v[108:111], a[156:159], a[216:219], v[108:111]
    v_mfma_f32_16x16x32_bf16 v[124:127], a[152:155], a[204:207], v[124:127]
    v_mfma_f32_16x16x32_bf16 v[124:127], a[156:159], a[220:223], v[124:127]
    v_mfma_f32_16x16x32_bf16 v[76:79], a[152:155], a[192:195], v[76:79]
    v_mfma_f32_16x16x32_bf16 v[76:79], a[156:159], a[208:211], v[76:79]
    buffer_load_dwordx4 a[80:83], v54, s[28:31], s39 offen offset:0 sc1
    v_mfma_f32_16x16x32_bf16 v[92:95], a[152:155], a[196:199], v[92:95]
    v_mfma_f32_16x16x32_bf16 v[92:95], a[156:159], a[212:215], v[92:95]
    s_waitcnt lgkmcnt(0)
    s_barrier
    v_mfma_f32_16x16x32_bf16 v[128:131], a[160:163], a[200:203], v[128:131]
    ds_read_b64_tr_b16 a[128:129], v32 offset:49152
    s_add_u32 m0, s56, 32768
    v_mfma_f32_16x16x32_bf16 v[128:131], a[164:167], a[216:219], v[128:131]
    s_bfe_u32 s38, s80, 0x40000
    s_lshl_b32 s38, s38, 18
    s_add_u32 s38, s38, 0
    buffer_load_dwordx4 v30, s[12:15], s38 offen offset:0 lds
    v_mfma_f32_16x16x32_bf16 v[144:147], a[160:163], a[204:207], v[144:147]
    ds_read_b64_tr_b16 a[130:131], v32 offset:53248
    s_bfe_u32 s38, s80, 0x40000
    s_lshl_b32 s38, s38, 18
    s_add_u32 s38, s38, 15360
    v_mfma_f32_16x16x32_bf16 v[144:147], a[164:167], a[220:223], v[144:147]
    v_mfma_f32_16x16x32_bf16 v[160:163], a[160:163], a[192:195], v[160:163]
    ds_read_b64_tr_b16 a[132:133], v32 offset:57344
    v_mfma_f32_16x16x32_bf16 v[160:163], a[164:167], a[208:211], v[160:163]
    buffer_load_dwordx4 v30, s[12:15], s38 offen offset:1024 lds
    s_bfe_u32 s38, s80, 0x40000
    s_lshl_b32 s38, s38, 18
    s_add_u32 s38, s38, 30720
    v_mfma_f32_16x16x32_bf16 v[176:179], a[160:163], a[196:199], v[176:179]
    ds_read_b64_tr_b16 a[134:135], v32 offset:61440
    v_mfma_f32_16x16x32_bf16 v[176:179], a[164:167], a[212:215], v[176:179]
    v_mfma_f32_16x16x32_bf16 v[132:135], a[168:171], a[200:203], v[132:135]
    ds_read_b64_tr_b16 a[136:137], v33 offset:49152
    v_mfma_f32_16x16x32_bf16 v[132:135], a[172:175], a[216:219], v[132:135]
    buffer_load_dwordx4 v30, s[12:15], s38 offen offset:2048 lds
    s_bfe_u32 s38, s80, 0x40000
    s_lshl_b32 s38, s38, 18
    s_add_u32 s38, s38, 46080
    v_mfma_f32_16x16x32_bf16 v[148:151], a[168:171], a[204:207], v[148:151]
    ds_read_b64_tr_b16 a[138:139], v33 offset:53248
    v_mfma_f32_16x16x32_bf16 v[148:151], a[172:175], a[220:223], v[148:151]
    v_mfma_f32_16x16x32_bf16 v[164:167], a[168:171], a[192:195], v[164:167]
    ds_read_b64_tr_b16 a[140:141], v33 offset:57344
    v_mfma_f32_16x16x32_bf16 v[164:167], a[172:175], a[208:211], v[164:167]
    buffer_load_dwordx4 v30, s[12:15], s38 offen offset:3072 lds
    v_mfma_f32_16x16x32_bf16 v[180:183], a[168:171], a[196:199], v[180:183]
    ds_read_b64_tr_b16 a[142:143], v33 offset:61440
    v_mfma_f32_16x16x32_bf16 v[180:183], a[172:175], a[212:215], v[180:183]
    v_mfma_f32_16x16x32_bf16 v[136:139], a[176:179], a[200:203], v[136:139]
    ds_read_b64_tr_b16 a[144:145], v34 offset:49152
    v_mfma_f32_16x16x32_bf16 v[136:139], a[180:183], a[216:219], v[136:139]
    buffer_load_dwordx4 a[84:87], v54, s[28:31], s39 offen offset:1024 sc1
    v_mfma_f32_16x16x32_bf16 v[152:155], a[176:179], a[204:207], v[152:155]
    ds_read_b64_tr_b16 a[146:147], v34 offset:53248
    v_mfma_f32_16x16x32_bf16 v[152:155], a[180:183], a[220:223], v[152:155]
    v_mfma_f32_16x16x32_bf16 v[168:171], a[176:179], a[192:195], v[168:171]
    ds_read_b64_tr_b16 a[148:149], v34 offset:57344
    v_mfma_f32_16x16x32_bf16 v[168:171], a[180:183], a[208:211], v[168:171]
    buffer_load_dwordx4 a[88:91], v55, s[28:31], s39 offen offset:0 sc1
    v_mfma_f32_16x16x32_bf16 v[184:187], a[176:179], a[196:199], v[184:187]
    ds_read_b64_tr_b16 a[150:151], v34 offset:61440
    v_mfma_f32_16x16x32_bf16 v[184:187], a[180:183], a[212:215], v[184:187]
    v_mfma_f32_16x16x32_bf16 v[140:143], a[184:187], a[200:203], v[140:143]
    ds_read_b64_tr_b16 a[152:153], v35 offset:49152
    v_mfma_f32_16x16x32_bf16 v[140:143], a[188:191], a[216:219], v[140:143]
    buffer_load_dwordx4 a[92:95], v55, s[28:31], s39 offen offset:1024 sc1
    s_bfe_u32 s39, s80, 0x40004
    s_lshl_b32 s39, s39, 15
    s_add_u32 s39, s39, s81
    v_mfma_f32_16x16x32_bf16 v[156:159], a[184:187], a[204:207], v[156:159]
    ds_read_b64_tr_b16 a[154:155], v35 offset:53248
    v_mfma_f32_16x16x32_bf16 v[156:159], a[188:191], a[220:223], v[156:159]
    v_mfma_f32_16x16x32_bf16 v[172:175], a[184:187], a[192:195], v[172:175]
    ds_read_b64_tr_b16 a[156:157], v35 offset:57344
    v_mfma_f32_16x16x32_bf16 v[172:175], a[188:191], a[208:211], v[172:175]
    buffer_load_dwordx4 a[96:99], v52, s[28:31], s39 offen offset:0 sc1
    v_mfma_f32_16x16x32_bf16 v[188:191], a[184:187], a[196:199], v[188:191]
    ds_read_b64_tr_b16 a[158:159], v35 offset:61440
    v_mfma_f32_16x16x32_bf16 v[188:191], a[188:191], a[212:215], v[188:191]
    s_waitcnt lgkmcnt(8)
    v_mfma_f32_16x16x32_bf16 v[96:99], a[128:131], a[232:235], v[96:99]
    ds_read_b64_tr_b16 a[160:161], v36 offset:49152
    v_mfma_f32_16x16x32_bf16 v[96:99], a[132:135], a[248:251], v[96:99]
    ds_read_b64_tr_b16 a[162:163], v36 offset:53248
    v_mfma_f32_16x16x32_bf16 v[112:115], a[128:131], a[236:239], v[112:115]
    buffer_load_dwordx4 a[100:103], v52, s[28:31], s39 offen offset:1024 sc1
    v_mfma_f32_16x16x32_bf16 v[112:115], a[132:135], a[252:255], v[112:115]
    ds_read_b64_tr_b16 a[164:165], v36 offset:57344
    v_mfma_f32_16x16x32_bf16 v[64:67], a[128:131], a[224:227], v[64:67]
    ds_read_b64_tr_b16 a[166:167], v36 offset:61440
    v_mfma_f32_16x16x32_bf16 v[64:67], a[132:135], a[240:243], v[64:67]
    buffer_load_dwordx4 a[104:107], v53, s[28:31], s39 offen offset:0 sc1
    v_mfma_f32_16x16x32_bf16 v[80:83], a[128:131], a[228:231], v[80:83]
    ds_read_b64_tr_b16 a[168:169], v37 offset:49152
    v_mfma_f32_16x16x32_bf16 v[80:83], a[132:135], a[244:247], v[80:83]
    v_mfma_f32_16x16x32_bf16 v[100:103], a[136:139], a[232:235], v[100:103]
    ds_read_b64_tr_b16 a[170:171], v37 offset:53248
    v_mfma_f32_16x16x32_bf16 v[100:103], a[140:143], a[248:251], v[100:103]
    ds_read_b64_tr_b16 a[172:173], v37 offset:57344
    v_mfma_f32_16x16x32_bf16 v[116:119], a[136:139], a[236:239], v[116:119]
    buffer_load_dwordx4 a[108:111], v53, s[28:31], s39 offen offset:1024 sc1
    v_mfma_f32_16x16x32_bf16 v[116:119], a[140:143], a[252:255], v[116:119]
    ds_read_b64_tr_b16 a[174:175], v37 offset:61440
    v_mfma_f32_16x16x32_bf16 v[68:71], a[136:139], a[224:227], v[68:71]
    v_mfma_f32_16x16x32_bf16 v[68:71], a[140:143], a[240:243], v[68:71]
    ds_read_b64_tr_b16 a[176:177], v38 offset:49152
    v_mfma_f32_16x16x32_bf16 v[84:87], a[136:139], a[228:231], v[84:87]
    ds_read_b64_tr_b16 a[178:179], v38 offset:53248
    v_mfma_f32_16x16x32_bf16 v[84:87], a[140:143], a[244:247], v[84:87]
    s_waitcnt lgkmcnt(10)
    buffer_load_dwordx4 a[112:115], v54, s[28:31], s39 offen offset:0 sc1
    v_mfma_f32_16x16x32_bf16 v[104:107], a[144:147], a[232:235], v[104:107]
    ds_read_b64_tr_b16 a[180:181], v38 offset:57344
    v_mfma_f32_16x16x32_bf16 v[104:107], a[148:151], a[248:251], v[104:107]
    ds_read_b64_tr_b16 a[182:183], v38 offset:61440
    v_mfma_f32_16x16x32_bf16 v[120:123], a[144:147], a[236:239], v[120:123]
    v_mfma_f32_16x16x32_bf16 v[120:123], a[148:151], a[252:255], v[120:123]
    ds_read_b64_tr_b16 a[184:185], v39 offset:49152
    v_mfma_f32_16x16x32_bf16 v[72:75], a[144:147], a[224:227], v[72:75]
    buffer_load_dwordx4 a[116:119], v54, s[28:31], s39 offen offset:1024 sc1
    v_mfma_f32_16x16x32_bf16 v[72:75], a[148:151], a[240:243], v[72:75]
    ds_read_b64_tr_b16 a[186:187], v39 offset:53248
    v_mfma_f32_16x16x32_bf16 v[88:91], a[144:147], a[228:231], v[88:91]
    ds_read_b64_tr_b16 a[188:189], v39 offset:57344
    v_mfma_f32_16x16x32_bf16 v[88:91], a[148:151], a[244:247], v[88:91]
    v_mfma_f32_16x16x32_bf16 v[108:111], a[152:155], a[232:235], v[108:111]
    ds_read_b64_tr_b16 a[190:191], v39 offset:61440
    v_mfma_f32_16x16x32_bf16 v[108:111], a[156:159], a[248:251], v[108:111]
    buffer_load_dwordx4 a[120:123], v55, s[28:31], s39 offen offset:0 sc1
    v_mfma_f32_16x16x32_bf16 v[124:127], a[152:155], a[236:239], v[124:127]
    v_mfma_f32_16x16x32_bf16 v[124:127], a[156:159], a[252:255], v[124:127]
    v_mfma_f32_16x16x32_bf16 v[76:79], a[152:155], a[224:227], v[76:79]
    v_mfma_f32_16x16x32_bf16 v[76:79], a[156:159], a[240:243], v[76:79]
    buffer_load_dwordx4 a[124:127], v55, s[28:31], s39 offen offset:1024 sc1
    v_mfma_f32_16x16x32_bf16 v[92:95], a[152:155], a[228:231], v[92:95]
    v_mfma_f32_16x16x32_bf16 v[92:95], a[156:159], a[244:247], v[92:95]
    s_waitcnt vmcnt(38) lgkmcnt(0)
    s_barrier
    v_mfma_f32_16x16x32_bf16 v[128:131], a[160:163], a[232:235], v[128:131]
    ds_read_b64_tr_b16 a[128:129], v32 offset:0
    s_add_u32 m0, s56, 49152
    v_mfma_f32_16x16x32_bf16 v[128:131], a[164:167], a[248:251], v[128:131]
    s_bfe_u32 s38, s80, 0x40004
    s_lshl_b32 s38, s38, 18
    s_add_u32 s38, s38, 0
    buffer_load_dwordx4 v30, s[12:15], s38 offen offset:0 lds
    v_mfma_f32_16x16x32_bf16 v[144:147], a[160:163], a[236:239], v[144:147]
    ds_read_b64_tr_b16 a[130:131], v32 offset:4096
    s_bfe_u32 s38, s80, 0x40004
    s_lshl_b32 s38, s38, 18
    s_add_u32 s38, s38, 15360
    v_mfma_f32_16x16x32_bf16 v[144:147], a[164:167], a[252:255], v[144:147]
    v_mfma_f32_16x16x32_bf16 v[160:163], a[160:163], a[224:227], v[160:163]
    ds_read_b64_tr_b16 a[132:133], v32 offset:8192
    v_mfma_f32_16x16x32_bf16 v[160:163], a[164:167], a[240:243], v[160:163]
    buffer_load_dwordx4 v30, s[12:15], s38 offen offset:1024 lds
    s_bfe_u32 s38, s80, 0x40004
    s_lshl_b32 s38, s38, 18
    s_add_u32 s38, s38, 30720
    v_mfma_f32_16x16x32_bf16 v[176:179], a[160:163], a[228:231], v[176:179]
    ds_read_b64_tr_b16 a[134:135], v32 offset:12288
    v_mfma_f32_16x16x32_bf16 v[176:179], a[164:167], a[244:247], v[176:179]
    v_mfma_f32_16x16x32_bf16 v[132:135], a[168:171], a[232:235], v[132:135]
    ds_read_b64_tr_b16 a[136:137], v33 offset:0
    v_mfma_f32_16x16x32_bf16 v[132:135], a[172:175], a[248:251], v[132:135]
    buffer_load_dwordx4 v30, s[12:15], s38 offen offset:2048 lds
    s_bfe_u32 s38, s80, 0x40004
    s_lshl_b32 s38, s38, 18
    s_add_u32 s38, s38, 46080
    v_mfma_f32_16x16x32_bf16 v[148:151], a[168:171], a[236:239], v[148:151]
    ds_read_b64_tr_b16 a[138:139], v33 offset:4096
    v_mfma_f32_16x16x32_bf16 v[148:151], a[172:175], a[252:255], v[148:151]
    v_mfma_f32_16x16x32_bf16 v[164:167], a[168:171], a[224:227], v[164:167]
    ds_read_b64_tr_b16 a[140:141], v33 offset:8192
    v_mfma_f32_16x16x32_bf16 v[164:167], a[172:175], a[240:243], v[164:167]
    buffer_load_dwordx4 v30, s[12:15], s38 offen offset:3072 lds
    s_bfe_u32 s39, s80, 0x40008
    s_lshl_b32 s39, s39, 15
    s_add_u32 s39, s39, s81
    v_mfma_f32_16x16x32_bf16 v[180:183], a[168:171], a[228:231], v[180:183]
    ds_read_b64_tr_b16 a[142:143], v33 offset:12288
    v_mfma_f32_16x16x32_bf16 v[180:183], a[172:175], a[244:247], v[180:183]
    v_mfma_f32_16x16x32_bf16 v[136:139], a[176:179], a[232:235], v[136:139]
    ds_read_b64_tr_b16 a[144:145], v34 offset:0
    v_mfma_f32_16x16x32_bf16 v[136:139], a[180:183], a[248:251], v[136:139]
    buffer_load_dwordx4 a[192:195], v52, s[28:31], s39 offen offset:0 sc1
    v_mfma_f32_16x16x32_bf16 v[152:155], a[176:179], a[236:239], v[152:155]
    ds_read_b64_tr_b16 a[146:147], v34 offset:4096
    v_mfma_f32_16x16x32_bf16 v[152:155], a[180:183], a[252:255], v[152:155]
    v_mfma_f32_16x16x32_bf16 v[168:171], a[176:179], a[224:227], v[168:171]
    ds_read_b64_tr_b16 a[148:149], v34 offset:8192
    v_mfma_f32_16x16x32_bf16 v[168:171], a[180:183], a[240:243], v[168:171]
    buffer_load_dwordx4 a[196:199], v52, s[28:31], s39 offen offset:1024 sc1
    v_mfma_f32_16x16x32_bf16 v[184:187], a[176:179], a[228:231], v[184:187]
    ds_read_b64_tr_b16 a[150:151], v34 offset:12288
    v_mfma_f32_16x16x32_bf16 v[184:187], a[180:183], a[244:247], v[184:187]
    v_mfma_f32_16x16x32_bf16 v[140:143], a[184:187], a[232:235], v[140:143]
    ds_read_b64_tr_b16 a[152:153], v35 offset:0
    v_mfma_f32_16x16x32_bf16 v[140:143], a[188:191], a[248:251], v[140:143]
    buffer_load_dwordx4 a[200:203], v53, s[28:31], s39 offen offset:0 sc1
    v_mfma_f32_16x16x32_bf16 v[156:159], a[184:187], a[236:239], v[156:159]
    ds_read_b64_tr_b16 a[154:155], v35 offset:4096
    v_mfma_f32_16x16x32_bf16 v[156:159], a[188:191], a[252:255], v[156:159]
    v_mfma_f32_16x16x32_bf16 v[172:175], a[184:187], a[224:227], v[172:175]
    ds_read_b64_tr_b16 a[156:157], v35 offset:8192
    v_mfma_f32_16x16x32_bf16 v[172:175], a[188:191], a[240:243], v[172:175]
    buffer_load_dwordx4 a[204:207], v53, s[28:31], s39 offen offset:1024 sc1
    v_mfma_f32_16x16x32_bf16 v[188:191], a[184:187], a[228:231], v[188:191]
    ds_read_b64_tr_b16 a[158:159], v35 offset:12288
    s_waitcnt vmcnt(44)
    v_mfma_f32_16x16x32_bf16 v[188:191], a[188:191], a[244:247], v[188:191]
    s_waitcnt lgkmcnt(8)
    v_mfma_f32_16x16x32_bf16 v[96:99], a[128:131], a[8:11], v[96:99]
    ds_read_b64_tr_b16 a[160:161], v36 offset:0
    v_mfma_f32_16x16x32_bf16 v[96:99], a[132:135], a[24:27], v[96:99]
    ds_read_b64_tr_b16 a[162:163], v36 offset:4096
    v_mfma_f32_16x16x32_bf16 v[112:115], a[128:131], a[12:15], v[112:115]
    buffer_load_dwordx4 a[208:211], v54, s[28:31], s39 offen offset:0 sc1
    v_mfma_f32_16x16x32_bf16 v[112:115], a[132:135], a[28:31], v[112:115]
    ds_read_b64_tr_b16 a[164:165], v36 offset:8192
    v_mfma_f32_16x16x32_bf16 v[64:67], a[128:131], a[0:3], v[64:67]
    ds_read_b64_tr_b16 a[166:167], v36 offset:12288
    v_mfma_f32_16x16x32_bf16 v[64:67], a[132:135], a[16:19], v[64:67]
    buffer_load_dwordx4 a[212:215], v54, s[28:31], s39 offen offset:1024 sc1
    v_mfma_f32_16x16x32_bf16 v[80:83], a[128:131], a[4:7], v[80:83]
    ds_read_b64_tr_b16 a[168:169], v37 offset:0
    v_mfma_f32_16x16x32_bf16 v[80:83], a[132:135], a[20:23], v[80:83]
    v_mfma_f32_16x16x32_bf16 v[100:103], a[136:139], a[8:11], v[100:103]
    ds_read_b64_tr_b16 a[170:171], v37 offset:4096
    v_mfma_f32_16x16x32_bf16 v[100:103], a[140:143], a[24:27], v[100:103]
    ds_read_b64_tr_b16 a[172:173], v37 offset:8192
    v_mfma_f32_16x16x32_bf16 v[116:119], a[136:139], a[12:15], v[116:119]
    buffer_load_dwordx4 a[216:219], v55, s[28:31], s39 offen offset:0 sc1
    v_mfma_f32_16x16x32_bf16 v[116:119], a[140:143], a[28:31], v[116:119]
    ds_read_b64_tr_b16 a[174:175], v37 offset:12288
    v_mfma_f32_16x16x32_bf16 v[68:71], a[136:139], a[0:3], v[68:71]
    v_mfma_f32_16x16x32_bf16 v[68:71], a[140:143], a[16:19], v[68:71]
    ds_read_b64_tr_b16 a[176:177], v38 offset:0
    v_mfma_f32_16x16x32_bf16 v[84:87], a[136:139], a[4:7], v[84:87]
    ds_read_b64_tr_b16 a[178:179], v38 offset:4096
    v_mfma_f32_16x16x32_bf16 v[84:87], a[140:143], a[20:23], v[84:87]
    s_waitcnt lgkmcnt(10)
    buffer_load_dwordx4 a[220:223], v55, s[28:31], s39 offen offset:1024 sc1
    v_mfma_f32_16x16x32_bf16 v[104:107], a[144:147], a[8:11], v[104:107]
    ds_read_b64_tr_b16 a[180:181], v38 offset:8192
    s_bfe_u32 s39, s80, 0x4000c
    s_lshl_b32 s39, s39, 15
    s_add_u32 s39, s39, s81
    v_mfma_f32_16x16x32_bf16 v[104:107], a[148:151], a[24:27], v[104:107]
    ds_read_b64_tr_b16 a[182:183], v38 offset:12288
    v_mfma_f32_16x16x32_bf16 v[120:123], a[144:147], a[12:15], v[120:123]
    buffer_load_dwordx4 a[224:227], v52, s[28:31], s39 offen offset:0 sc1
    v_mfma_f32_16x16x32_bf16 v[120:123], a[148:151], a[28:31], v[120:123]
    ds_read_b64_tr_b16 a[184:185], v39 offset:0
    v_mfma_f32_16x16x32_bf16 v[72:75], a[144:147], a[0:3], v[72:75]
    v_mfma_f32_16x16x32_bf16 v[72:75], a[148:151], a[16:19], v[72:75]
    ds_read_b64_tr_b16 a[186:187], v39 offset:4096
    v_mfma_f32_16x16x32_bf16 v[88:91], a[144:147], a[4:7], v[88:91]
    ds_read_b64_tr_b16 a[188:189], v39 offset:8192
    v_mfma_f32_16x16x32_bf16 v[88:91], a[148:151], a[20:23], v[88:91]
    buffer_load_dwordx4 a[228:231], v52, s[28:31], s39 offen offset:1024 sc1
    v_mfma_f32_16x16x32_bf16 v[108:111], a[152:155], a[8:11], v[108:111]
    ds_read_b64_tr_b16 a[190:191], v39 offset:12288
    v_mfma_f32_16x16x32_bf16 v[108:111], a[156:159], a[24:27], v[108:111]
    v_mfma_f32_16x16x32_bf16 v[124:127], a[152:155], a[12:15], v[124:127]
    buffer_load_dwordx4 a[232:235], v53, s[28:31], s39 offen offset:0 sc1
    v_mfma_f32_16x16x32_bf16 v[124:127], a[156:159], a[28:31], v[124:127]
    v_mfma_f32_16x16x32_bf16 v[76:79], a[152:155], a[0:3], v[76:79]
    v_mfma_f32_16x16x32_bf16 v[76:79], a[156:159], a[16:19], v[76:79]
    v_mfma_f32_16x16x32_bf16 v[92:95], a[152:155], a[4:7], v[92:95]
    buffer_load_dwordx4 a[236:239], v53, s[28:31], s39 offen offset:1024 sc1
    v_mfma_f32_16x16x32_bf16 v[92:95], a[156:159], a[20:23], v[92:95]
    s_waitcnt vmcnt(41) lgkmcnt(0)
    s_barrier
    v_mfma_f32_16x16x32_bf16 v[128:131], a[160:163], a[8:11], v[128:131]
    ds_read_b64_tr_b16 a[128:129], v32 offset:16384
    s_add_u32 m0, s56, 0
    v_mfma_f32_16x16x32_bf16 v[128:131], a[164:167], a[24:27], v[128:131]
    s_bfe_u32 s38, s80, 0x40008
    s_lshl_b32 s38, s38, 18
    s_add_u32 s38, s38, 0
    buffer_load_dwordx4 v30, s[12:15], s38 offen offset:0 lds
    v_mfma_f32_16x16x32_bf16 v[144:147], a[160:163], a[12:15], v[144:147]
    ds_read_b64_tr_b16 a[130:131], v32 offset:20480
    s_bfe_u32 s38, s80, 0x40008
    s_lshl_b32 s38, s38, 18
    s_add_u32 s38, s38, 15360
    v_mfma_f32_16x16x32_bf16 v[144:147], a[164:167], a[28:31], v[144:147]
    v_mfma_f32_16x16x32_bf16 v[160:163], a[160:163], a[0:3], v[160:163]
    ds_read_b64_tr_b16 a[132:133], v32 offset:24576
    v_mfma_f32_16x16x32_bf16 v[160:163], a[164:167], a[16:19], v[160:163]
    buffer_load_dwordx4 v30, s[12:15], s38 offen offset:1024 lds
    s_bfe_u32 s38, s80, 0x40008
    s_lshl_b32 s38, s38, 18
    s_add_u32 s38, s38, 30720
    v_mfma_f32_16x16x32_bf16 v[176:179], a[160:163], a[4:7], v[176:179]
    ds_read_b64_tr_b16 a[134:135], v32 offset:28672
    v_mfma_f32_16x16x32_bf16 v[176:179], a[164:167], a[20:23], v[176:179]
    v_mfma_f32_16x16x32_bf16 v[132:135], a[168:171], a[8:11], v[132:135]
    ds_read_b64_tr_b16 a[136:137], v33 offset:16384
    v_mfma_f32_16x16x32_bf16 v[132:135], a[172:175], a[24:27], v[132:135]
    buffer_load_dwordx4 v30, s[12:15], s38 offen offset:2048 lds
    s_bfe_u32 s38, s80, 0x40008
    s_lshl_b32 s38, s38, 18
    s_add_u32 s38, s38, 46080
    v_mfma_f32_16x16x32_bf16 v[148:151], a[168:171], a[12:15], v[148:151]
    ds_read_b64_tr_b16 a[138:139], v33 offset:20480
    v_mfma_f32_16x16x32_bf16 v[148:151], a[172:175], a[28:31], v[148:151]
    v_mfma_f32_16x16x32_bf16 v[164:167], a[168:171], a[0:3], v[164:167]
    ds_read_b64_tr_b16 a[140:141], v33 offset:24576
    v_mfma_f32_16x16x32_bf16 v[164:167], a[172:175], a[16:19], v[164:167]
    buffer_load_dwordx4 v30, s[12:15], s38 offen offset:3072 lds
    v_mfma_f32_16x16x32_bf16 v[180:183], a[168:171], a[4:7], v[180:183]
    ds_read_b64_tr_b16 a[142:143], v33 offset:28672
    v_mfma_f32_16x16x32_bf16 v[180:183], a[172:175], a[20:23], v[180:183]
    v_mfma_f32_16x16x32_bf16 v[136:139], a[176:179], a[8:11], v[136:139]
    ds_read_b64_tr_b16 a[144:145], v34 offset:16384
    v_mfma_f32_16x16x32_bf16 v[136:139], a[180:183], a[24:27], v[136:139]
    buffer_load_dwordx4 a[240:243], v54, s[28:31], s39 offen offset:0 sc1
    v_mfma_f32_16x16x32_bf16 v[152:155], a[176:179], a[12:15], v[152:155]
    ds_read_b64_tr_b16 a[146:147], v34 offset:20480
    v_mfma_f32_16x16x32_bf16 v[152:155], a[180:183], a[28:31], v[152:155]
    v_mfma_f32_16x16x32_bf16 v[168:171], a[176:179], a[0:3], v[168:171]
    ds_read_b64_tr_b16 a[148:149], v34 offset:24576
    v_mfma_f32_16x16x32_bf16 v[168:171], a[180:183], a[16:19], v[168:171]
    buffer_load_dwordx4 a[244:247], v54, s[28:31], s39 offen offset:1024 sc1
    v_mfma_f32_16x16x32_bf16 v[184:187], a[176:179], a[4:7], v[184:187]
    ds_read_b64_tr_b16 a[150:151], v34 offset:28672
    v_mfma_f32_16x16x32_bf16 v[184:187], a[180:183], a[20:23], v[184:187]
    v_mfma_f32_16x16x32_bf16 v[140:143], a[184:187], a[8:11], v[140:143]
    ds_read_b64_tr_b16 a[152:153], v35 offset:16384
    v_mfma_f32_16x16x32_bf16 v[140:143], a[188:191], a[24:27], v[140:143]
    buffer_load_dwordx4 a[248:251], v55, s[28:31], s39 offen offset:0 sc1
    v_mfma_f32_16x16x32_bf16 v[156:159], a[184:187], a[12:15], v[156:159]
    ds_read_b64_tr_b16 a[154:155], v35 offset:20480
    v_mfma_f32_16x16x32_bf16 v[156:159], a[188:191], a[28:31], v[156:159]
    v_mfma_f32_16x16x32_bf16 v[172:175], a[184:187], a[0:3], v[172:175]
    ds_read_b64_tr_b16 a[156:157], v35 offset:24576
    v_mfma_f32_16x16x32_bf16 v[172:175], a[188:191], a[16:19], v[172:175]
    buffer_load_dwordx4 a[252:255], v55, s[28:31], s39 offen offset:1024 sc1
    v_mfma_f32_16x16x32_bf16 v[188:191], a[184:187], a[4:7], v[188:191]
    ds_read_b64_tr_b16 a[158:159], v35 offset:28672
    s_waitcnt vmcnt(46)
    v_mfma_f32_16x16x32_bf16 v[188:191], a[188:191], a[20:23], v[188:191]
    s_waitcnt lgkmcnt(8)
    v_mfma_f32_16x16x32_bf16 v[96:99], a[128:131], a[40:43], v[96:99]
    ds_read_b64_tr_b16 a[160:161], v36 offset:16384
    s_bfe_u32 s39, s80, 0x40010
    s_lshl_b32 s39, s39, 15
    s_add_u32 s39, s39, s81
    v_mfma_f32_16x16x32_bf16 v[96:99], a[132:135], a[56:59], v[96:99]
    ds_read_b64_tr_b16 a[162:163], v36 offset:20480
    v_mfma_f32_16x16x32_bf16 v[112:115], a[128:131], a[44:47], v[112:115]
    buffer_load_dwordx4 a[0:3], v52, s[28:31], s39 offen offset:0 sc1
    v_mfma_f32_16x16x32_bf16 v[112:115], a[132:135], a[60:63], v[112:115]
    ds_read_b64_tr_b16 a[164:165], v36 offset:24576
    v_mfma_f32_16x16x32_bf16 v[64:67], a[128:131], a[32:35], v[64:67]
    ds_read_b64_tr_b16 a[166:167], v36 offset:28672
    v_mfma_f32_16x16x32_bf16 v[64:67], a[132:135], a[48:51], v[64:67]
    buffer_load_dwordx4 a[4:7], v52, s[28:31], s39 offen offset:1024 sc1
    v_mfma_f32_16x16x32_bf16 v[80:83], a[128:131], a[36:39], v[80:83]
    ds_read_b64_tr_b16 a[168:169], v37 offset:16384
    v_mfma_f32_16x16x32_bf16 v[80:83], a[132:135], a[52:55], v[80:83]
    v_mfma_f32_16x16x32_bf16 v[100:103], a[136:139], a[40:43], v[100:103]
    ds_read_b64_tr_b16 a[170:171], v37 offset:20480
    v_mfma_f32_16x16x32_bf16 v[100:103], a[140:143], a[56:59], v[100:103]
    ds_read_b64_tr_b16 a[172:173], v37 offset:24576
    v_mfma_f32_16x16x32_bf16 v[116:119], a[136:139], a[44:47], v[116:119]
    buffer_load_dwordx4 a[8:11], v53, s[28:31], s39 offen offset:0 sc1
    v_mfma_f32_16x16x32_bf16 v[116:119], a[140:143], a[60:63], v[116:119]
    ds_read_b64_tr_b16 a[174:175], v37 offset:28672
    v_mfma_f32_16x16x32_bf16 v[68:71], a[136:139], a[32:35], v[68:71]
    v_mfma_f32_16x16x32_bf16 v[68:71], a[140:143], a[48:51], v[68:71]
    ds_read_b64_tr_b16 a[176:177], v38 offset:16384
    v_mfma_f32_16x16x32_bf16 v[84:87], a[136:139], a[36:39], v[84:87]
    ds_read_b64_tr_b16 a[178:179], v38 offset:20480
    v_mfma_f32_16x16x32_bf16 v[84:87], a[140:143], a[52:55], v[84:87]
    s_waitcnt lgkmcnt(10)
    buffer_load_dwordx4 a[12:15], v53, s[28:31], s39 offen offset:1024 sc1
    v_mfma_f32_16x16x32_bf16 v[104:107], a[144:147], a[40:43], v[104:107]
    ds_read_b64_tr_b16 a[180:181], v38 offset:24576
    v_mfma_f32_16x16x32_bf16 v[104:107], a[148:151], a[56:59], v[104:107]
    ds_read_b64_tr_b16 a[182:183], v38 offset:28672
    v_mfma_f32_16x16x32_bf16 v[120:123], a[144:147], a[44:47], v[120:123]
    v_mfma_f32_16x16x32_bf16 v[120:123], a[148:151], a[60:63], v[120:123]
    ds_read_b64_tr_b16 a[184:185], v39 offset:16384
    v_mfma_f32_16x16x32_bf16 v[72:75], a[144:147], a[32:35], v[72:75]
    buffer_load_dwordx4 a[16:19], v54, s[28:31], s39 offen offset:0 sc1
    v_mfma_f32_16x16x32_bf16 v[72:75], a[148:151], a[48:51], v[72:75]
    ds_read_b64_tr_b16 a[186:187], v39 offset:20480
    v_mfma_f32_16x16x32_bf16 v[88:91], a[144:147], a[36:39], v[88:91]
    ds_read_b64_tr_b16 a[188:189], v39 offset:24576
    v_mfma_f32_16x16x32_bf16 v[88:91], a[148:151], a[52:55], v[88:91]
    v_mfma_f32_16x16x32_bf16 v[108:111], a[152:155], a[40:43], v[108:111]
    ds_read_b64_tr_b16 a[190:191], v39 offset:28672
    v_mfma_f32_16x16x32_bf16 v[108:111], a[156:159], a[56:59], v[108:111]
    buffer_load_dwordx4 a[20:23], v54, s[28:31], s39 offen offset:1024 sc1
    v_mfma_f32_16x16x32_bf16 v[124:127], a[152:155], a[44:47], v[124:127]
    v_mfma_f32_16x16x32_bf16 v[124:127], a[156:159], a[60:63], v[124:127]
    v_mfma_f32_16x16x32_bf16 v[76:79], a[152:155], a[32:35], v[76:79]
    v_mfma_f32_16x16x32_bf16 v[76:79], a[156:159], a[48:51], v[76:79]
    buffer_load_dwordx4 a[24:27], v55, s[28:31], s39 offen offset:0 sc1
    v_mfma_f32_16x16x32_bf16 v[92:95], a[152:155], a[36:39], v[92:95]
    v_mfma_f32_16x16x32_bf16 v[92:95], a[156:159], a[52:55], v[92:95]
    s_waitcnt vmcnt(42) lgkmcnt(0)
    s_barrier
    v_mfma_f32_16x16x32_bf16 v[128:131], a[160:163], a[40:43], v[128:131]
    ds_read_b64_tr_b16 a[128:129], v20 offset:32768
    s_add_u32 s75, s74, 0
    v_mfma_f32_16x16x32_bf16 v[128:131], a[164:167], a[56:59], v[128:131]
    v_cvt_pk_bf16_f32 v64, v64, v65
    v_cvt_pk_bf16_f32 v65, v66, v67
    v_mfma_f32_16x16x32_bf16 v[144:147], a[160:163], a[44:47], v[144:147]
    ds_read_b64_tr_b16 a[130:131], v20 offset:34816
    v_cvt_pk_bf16_f32 v66, v68, v69
    v_cvt_pk_bf16_f32 v67, v70, v71
    v_mfma_f32_16x16x32_bf16 v[144:147], a[164:167], a[60:63], v[144:147]
    buffer_store_dwordx4 v[64:67], v15, s[20:23], s75 offen offset:0 sc1
    v_cvt_pk_bf16_f32 v72, v72, v73
    v_mfma_f32_16x16x32_bf16 v[160:163], a[160:163], a[32:35], v[160:163]
    ds_read_b64_tr_b16 a[132:133], v20 offset:36864
    v_cvt_pk_bf16_f32 v73, v74, v75
    v_mfma_f32_16x16x32_bf16 v[160:163], a[164:167], a[48:51], v[160:163]
    v_cvt_pk_bf16_f32 v74, v76, v77
    v_cvt_pk_bf16_f32 v75, v78, v79
    v_mfma_f32_16x16x32_bf16 v[176:179], a[160:163], a[36:39], v[176:179]
    ds_read_b64_tr_b16 a[134:135], v20 offset:38912
    v_mfma_f32_16x16x32_bf16 v[176:179], a[164:167], a[52:55], v[176:179]
    v_mfma_f32_16x16x32_bf16 v[132:135], a[168:171], a[40:43], v[132:135]
    ds_read_b64_tr_b16 a[136:137], v21 offset:32768
    v_mfma_f32_16x16x32_bf16 v[132:135], a[172:175], a[56:59], v[132:135]
    buffer_store_dwordx4 v[72:75], v15, s[20:23], s75 offen offset:1024 sc1
    s_add_u32 s75, s74, 4096
    v_mfma_f32_16x16x32_bf16 v[148:151], a[168:171], a[44:47], v[148:151]
    ds_read_b64_tr_b16 a[138:139], v21 offset:34816
    v_cvt_pk_bf16_f32 v96, v96, v97
    v_mfma_f32_16x16x32_bf16 v[148:151], a[172:175], a[60:63], v[148:151]
    v_cvt_pk_bf16_f32 v97, v98, v99
    v_cvt_pk_bf16_f32 v98, v100, v101
    v_mfma_f32_16x16x32_bf16 v[164:167], a[168:171], a[32:35], v[164:167]
    ds_read_b64_tr_b16 a[140:141], v21 offset:36864
    v_cvt_pk_bf16_f32 v99, v102, v103
    v_mfma_f32_16x16x32_bf16 v[164:167], a[172:175], a[48:51], v[164:167]
    v_mfma_f32_16x16x32_bf16 v[180:183], a[168:171], a[36:39], v[180:183]
    ds_read_b64_tr_b16 a[142:143], v21 offset:38912
    v_mfma_f32_16x16x32_bf16 v[180:183], a[172:175], a[52:55], v[180:183]
    buffer_store_dwordx4 v[96:99], v15, s[20:23], s75 offen offset:0 sc1
    v_cvt_pk_bf16_f32 v104, v104, v105
    v_mfma_f32_16x16x32_bf16 v[136:139], a[176:179], a[40:43], v[136:139]
    ds_read_b64_tr_b16 a[144:145], v22 offset:32768
    v_cvt_pk_bf16_f32 v105, v106, v107
    v_mfma_f32_16x16x32_bf16 v[136:139], a[180:183], a[56:59], v[136:139]
    v_cvt_pk_bf16_f32 v106, v108, v109
    v_cvt_pk_bf16_f32 v107, v110, v111
    v_mfma_f32_16x16x32_bf16 v[152:155], a[176:179], a[44:47], v[152:155]
    ds_read_b64_tr_b16 a[146:147], v22 offset:34816
    v_mfma_f32_16x16x32_bf16 v[152:155], a[180:183], a[60:63], v[152:155]
    v_mfma_f32_16x16x32_bf16 v[168:171], a[176:179], a[32:35], v[168:171]
    ds_read_b64_tr_b16 a[148:149], v22 offset:36864
    v_mfma_f32_16x16x32_bf16 v[168:171], a[180:183], a[48:51], v[168:171]
    buffer_store_dwordx4 v[104:107], v15, s[20:23], s75 offen offset:1024 sc1
    v_mfma_f32_16x16x32_bf16 v[184:187], a[176:179], a[36:39], v[184:187]
    ds_read_b64_tr_b16 a[150:151], v22 offset:38912
    v_mfma_f32_16x16x32_bf16 v[184:187], a[180:183], a[52:55], v[184:187]
    v_mfma_f32_16x16x32_bf16 v[140:143], a[184:187], a[40:43], v[140:143]
    ds_read_b64_tr_b16 a[152:153], v23 offset:32768
    v_mfma_f32_16x16x32_bf16 v[140:143], a[188:191], a[56:59], v[140:143]
    v_mfma_f32_16x16x32_bf16 v[156:159], a[184:187], a[44:47], v[156:159]
    ds_read_b64_tr_b16 a[154:155], v23 offset:34816
    v_mfma_f32_16x16x32_bf16 v[156:159], a[188:191], a[60:63], v[156:159]
    buffer_load_dwordx4 a[28:31], v55, s[28:31], s39 offen offset:1024 sc1
    v_mfma_f32_16x16x32_bf16 v[172:175], a[184:187], a[32:35], v[172:175]
    ds_read_b64_tr_b16 a[156:157], v23 offset:36864
    v_mfma_f32_16x16x32_bf16 v[172:175], a[188:191], a[48:51], v[172:175]
    v_mfma_f32_16x16x32_bf16 v[188:191], a[184:187], a[36:39], v[188:191]
    ds_read_b64_tr_b16 a[158:159], v23 offset:38912
    s_waitcnt vmcnt(44)
    v_mfma_f32_16x16x32_bf16 v[188:191], a[188:191], a[52:55], v[188:191]
    s_waitcnt lgkmcnt(8)
    v_mfma_f32_16x16x32_bf16 v[192:195], a[128:131], a[64:67], 0
    ds_read_b64_tr_b16 a[160:161], v20 offset:40960
    ds_read_b64_tr_b16 a[162:163], v20 offset:43008
    s_add_u32 s75, s74, 8192
    v_cvt_pk_bf16_f32 v128, v128, v129
    v_cvt_pk_bf16_f32 v129, v130, v131
    v_cvt_pk_bf16_f32 v130, v132, v133
    v_cvt_pk_bf16_f32 v131, v134, v135
    v_mfma_f32_16x16x32_bf16 v[192:195], a[132:135], a[72:75], v[192:195]
    ds_read_b64_tr_b16 a[164:165], v20 offset:45056
    buffer_store_dwordx4 v[128:131], v15, s[20:23], s75 offen offset:0 sc1
    v_mfma_f32_16x16x32_bf16 v[208:211], a[128:131], a[68:71], 0
    ds_read_b64_tr_b16 a[166:167], v20 offset:47104
    v_cvt_pk_bf16_f32 v136, v136, v137
    v_cvt_pk_bf16_f32 v137, v138, v139
    v_cvt_pk_bf16_f32 v138, v140, v141
    v_cvt_pk_bf16_f32 v139, v142, v143
    v_mfma_f32_16x16x32_bf16 v[208:211], a[132:135], a[76:79], v[208:211]
    ds_read_b64_tr_b16 a[168:169], v21 offset:40960
    buffer_store_dwordx4 v[136:139], v15, s[20:23], s75 offen offset:1024 sc1
    v_mfma_f32_16x16x32_bf16 v[196:199], a[136:139], a[64:67], 0
    ds_read_b64_tr_b16 a[170:171], v21 offset:43008
    ds_read_b64_tr_b16 a[172:173], v21 offset:45056
    v_mfma_f32_16x16x32_bf16 v[196:199], a[140:143], a[72:75], v[196:199]
    ds_read_b64_tr_b16 a[174:175], v21 offset:47104
    s_bfe_u32 s39, s80, 0x40014
    s_lshl_b32 s39, s39, 15
    s_add_u32 s39, s39, s81
    v_mfma_f32_16x16x32_bf16 v[212:215], a[136:139], a[68:71], 0
    ds_read_b64_tr_b16 a[176:177], v22 offset:40960
    v_mfma_f32_16x16x32_bf16 v[212:215], a[140:143], a[76:79], v[212:215]
    ds_read_b64_tr_b16 a[178:179], v22 offset:43008
    s_waitcnt lgkmcnt(10)
    v_mfma_f32_16x16x32_bf16 v[200:203], a[144:147], a[64:67], 0
    ds_read_b64_tr_b16 a[180:181], v22 offset:45056
    ds_read_b64_tr_b16 a[182:183], v22 offset:47104
    v_mfma_f32_16x16x32_bf16 v[200:203], a[148:151], a[72:75], v[200:203]
    ds_read_b64_tr_b16 a[184:185], v23 offset:40960
    buffer_load_dwordx4 a[32:35], v52, s[28:31], s39 offen offset:0 sc1
    v_mfma_f32_16x16x32_bf16 v[216:219], a[144:147], a[68:71], 0
    ds_read_b64_tr_b16 a[186:187], v23 offset:43008
    v_mfma_f32_16x16x32_bf16 v[216:219], a[148:151], a[76:79], v[216:219]
    ds_read_b64_tr_b16 a[188:189], v23 offset:45056
    buffer_load_dwordx4 a[36:39], v52, s[28:31], s39 offen offset:1024 sc1
    v_mfma_f32_16x16x32_bf16 v[204:207], a[152:155], a[64:67], 0
    ds_read_b64_tr_b16 a[190:191], v23 offset:47104
    v_mfma_f32_16x16x32_bf16 v[204:207], a[156:159], a[72:75], v[204:207]
    v_mfma_f32_16x16x32_bf16 v[220:223], a[152:155], a[68:71], 0
    buffer_load_dwordx4 a[40:43], v53, s[28:31], s39 offen offset:0 sc1
    v_mfma_f32_16x16x32_bf16 v[220:223], a[156:159], a[76:79], v[220:223]
    s_waitcnt vmcnt(37) lgkmcnt(0)
    s_barrier
    v_mfma_f32_16x16x32_bf16 v[192:195], a[160:163], a[80:83], v[192:195]
    ds_read_b64_tr_b16 a[128:129], v20 offset:49152
    s_add_u32 s75, s74, 0
    v_cvt_pk_bf16_f32 v80, v80, v81
    v_cvt_pk_bf16_f32 v81, v82, v83
    v_cvt_pk_bf16_f32 v82, v84, v85
    v_cvt_pk_bf16_f32 v83, v86, v87
    v_mfma_f32_16x16x32_bf16 v[192:195], a[164:167], a[88:91], v[192:195]
    ds_read_b64_tr_b16 a[130:131], v20 offset:51200
    buffer_store_dwordx4 v[80:83], v15, s[20:23], s75 offen offset:2048 sc1
    v_mfma_f32_16x16x32_bf16 v[208:211], a[160:163], a[84:87], v[208:211]
    ds_read_b64_tr_b16 a[132:133], v20 offset:53248
    v_mfma_f32_16x16x32_bf16 v[208:211], a[164:167], a[92:95], v[208:211]
    ds_read_b64_tr_b16 a[134:135], v20 offset:55296
    v_mfma_f32_16x16x32_bf16 v[196:199], a[168:171], a[80:83], v[196:199]
    ds_read_b64_tr_b16 a[136:137], v21 offset:49152
    buffer_load_dwordx4 a[44:47], v53, s[28:31], s39 offen offset:1024 sc1
    v_mfma_f32_16x16x32_bf16 v[196:199], a[172:175], a[88:91], v[196:199]
    ds_read_b64_tr_b16 a[138:139], v21 offset:51200
    v_mfma_f32_16x16x32_bf16 v[212:215], a[168:171], a[84:87], v[212:215]
    ds_read_b64_tr_b16 a[140:141], v21 offset:53248
    v_mfma_f32_16x16x32_bf16 v[212:215], a[172:175], a[92:95], v[212:215]
    ds_read_b64_tr_b16 a[142:143], v21 offset:55296
    v_mfma_f32_16x16x32_bf16 v[200:203], a[176:179], a[80:83], v[200:203]
    ds_read_b64_tr_b16 a[144:145], v22 offset:49152
    buffer_load_dwordx4 a[48:51], v54, s[28:31], s39 offen offset:0 sc1
    v_mfma_f32_16x16x32_bf16 v[200:203], a[180:183], a[88:91], v[200:203]
    ds_read_b64_tr_b16 a[146:147], v22 offset:51200
    v_mfma_f32_16x16x32_bf16 v[216:219], a[176:179], a[84:87], v[216:219]
    ds_read_b64_tr_b16 a[148:149], v22 offset:53248
    v_mfma_f32_16x16x32_bf16 v[216:219], a[180:183], a[92:95], v[216:219]
    ds_read_b64_tr_b16 a[150:151], v22 offset:55296
    buffer_load_dwordx4 a[52:55], v54, s[28:31], s39 offen offset:1024 sc1
    v_mfma_f32_16x16x32_bf16 v[204:207], a[184:187], a[80:83], v[204:207]
    ds_read_b64_tr_b16 a[152:153], v23 offset:49152
    v_mfma_f32_16x16x32_bf16 v[204:207], a[188:191], a[88:91], v[204:207]
    ds_read_b64_tr_b16 a[154:155], v23 offset:51200
    v_mfma_f32_16x16x32_bf16 v[220:223], a[184:187], a[84:87], v[220:223]
    ds_read_b64_tr_b16 a[156:157], v23 offset:53248
    buffer_load_dwordx4 a[56:59], v55, s[28:31], s39 offen offset:0 sc1
    v_mfma_f32_16x16x32_bf16 v[220:223], a[188:191], a[92:95], v[220:223]
    ds_read_b64_tr_b16 a[158:159], v23 offset:55296
    s_waitcnt lgkmcnt(8)
    v_mfma_f32_16x16x32_bf16 v[192:195], a[128:131], a[96:99], v[192:195]
    ds_read_b64_tr_b16 a[160:161], v20 offset:57344
    ds_read_b64_tr_b16 a[162:163], v20 offset:59392
    v_cvt_pk_bf16_f32 v88, v88, v89
    v_cvt_pk_bf16_f32 v89, v90, v91
    v_cvt_pk_bf16_f32 v90, v92, v93
    v_cvt_pk_bf16_f32 v91, v94, v95
    v_mfma_f32_16x16x32_bf16 v[192:195], a[132:135], a[104:107], v[192:195]
    ds_read_b64_tr_b16 a[164:165], v20 offset:61440
    buffer_store_dwordx4 v[88:91], v15, s[20:23], s75 offen offset:3072 sc1
    v_mfma_f32_16x16x32_bf16 v[208:211], a[128:131], a[100:103], v[208:211]
    ds_read_b64_tr_b16 a[166:167], v20 offset:63488
    v_mfma_f32_16x16x32_bf16 v[208:211], a[132:135], a[108:111], v[208:211]
    ds_read_b64_tr_b16 a[168:169], v21 offset:57344
    buffer_load_dwordx4 a[60:63], v55, s[28:31], s39 offen offset:1024 sc1
    v_mfma_f32_16x16x32_bf16 v[196:199], a[136:139], a[96:99], v[196:199]
    ds_read_b64_tr_b16 a[170:171], v21 offset:59392
    ds_read_b64_tr_b16 a[172:173], v21 offset:61440
    v_mfma_f32_16x16x32_bf16 v[196:199], a[140:143], a[104:107], v[196:199]
    ds_read_b64_tr_b16 a[174:175], v21 offset:63488
    s_bfe_u32 s39, s80, 0x40018
    s_lshl_b32 s39, s39, 15
    s_add_u32 s39, s39, s81
    v_mfma_f32_16x16x32_bf16 v[212:215], a[136:139], a[100:103], v[212:215]
    ds_read_b64_tr_b16 a[176:177], v22 offset:57344
    v_mfma_f32_16x16x32_bf16 v[212:215], a[140:143], a[108:111], v[212:215]
    ds_read_b64_tr_b16 a[178:179], v22 offset:59392
    s_waitcnt lgkmcnt(10)
    v_mfma_f32_16x16x32_bf16 v[200:203], a[144:147], a[96:99], v[200:203]
    ds_read_b64_tr_b16 a[180:181], v22 offset:61440
    ds_read_b64_tr_b16 a[182:183], v22 offset:63488
    v_mfma_f32_16x16x32_bf16 v[200:203], a[148:151], a[104:107], v[200:203]
    ds_read_b64_tr_b16 a[184:185], v23 offset:57344
    buffer_load_dwordx4 a[64:67], v52, s[28:31], s39 offen offset:0 sc1
    v_mfma_f32_16x16x32_bf16 v[216:219], a[144:147], a[100:103], v[216:219]
    ds_read_b64_tr_b16 a[186:187], v23 offset:59392
    v_mfma_f32_16x16x32_bf16 v[216:219], a[148:151], a[108:111], v[216:219]
    ds_read_b64_tr_b16 a[188:189], v23 offset:61440
    buffer_load_dwordx4 a[68:71], v52, s[28:31], s39 offen offset:1024 sc1
    v_mfma_f32_16x16x32_bf16 v[204:207], a[152:155], a[96:99], v[204:207]
    ds_read_b64_tr_b16 a[190:191], v23 offset:63488
    v_mfma_f32_16x16x32_bf16 v[204:207], a[156:159], a[104:107], v[204:207]
    v_mfma_f32_16x16x32_bf16 v[220:223], a[152:155], a[100:103], v[220:223]
    buffer_load_dwordx4 a[72:75], v53, s[28:31], s39 offen offset:0 sc1
    v_mfma_f32_16x16x32_bf16 v[220:223], a[156:159], a[108:111], v[220:223]
    s_waitcnt vmcnt(31) lgkmcnt(0)
    s_barrier
    v_mfma_f32_16x16x32_bf16 v[192:195], a[160:163], a[112:115], v[192:195]
    ds_read_b64_tr_b16 a[128:129], v20 offset:0
    s_add_u32 s75, s74, 4096
    v_cvt_pk_bf16_f32 v112, v112, v113
    v_cvt_pk_bf16_f32 v113, v114, v115
    v_cvt_pk_bf16_f32 v114, v116, v117
    v_cvt_pk_bf16_f32 v115, v118, v119
    v_mfma_f32_16x16x32_bf16 v[192:195], a[164:167], a[120:123], v[192:195]
    ds_read_b64_tr_b16 a[130:131], v20 offset:2048
    buffer_store_dwordx4 v[112:115], v15, s[20:23], s75 offen offset:2048 sc1
    v_mfma_f32_16x16x32_bf16 v[208:211], a[160:163], a[116:119], v[208:211]
    ds_read_b64_tr_b16 a[132:133], v20 offset:4096
    v_mfma_f32_16x16x32_bf16 v[208:211], a[164:167], a[124:127], v[208:211]
    ds_read_b64_tr_b16 a[134:135], v20 offset:6144
    v_mfma_f32_16x16x32_bf16 v[196:199], a[168:171], a[112:115], v[196:199]
    ds_read_b64_tr_b16 a[136:137], v21 offset:0
    buffer_load_dwordx4 a[76:79], v53, s[28:31], s39 offen offset:1024 sc1
    v_mfma_f32_16x16x32_bf16 v[196:199], a[172:175], a[120:123], v[196:199]
    ds_read_b64_tr_b16 a[138:139], v21 offset:2048
    v_mfma_f32_16x16x32_bf16 v[212:215], a[168:171], a[116:119], v[212:215]
    ds_read_b64_tr_b16 a[140:141], v21 offset:4096
    v_mfma_f32_16x16x32_bf16 v[212:215], a[172:175], a[124:127], v[212:215]
    ds_read_b64_tr_b16 a[142:143], v21 offset:6144
    v_mfma_f32_16x16x32_bf16 v[200:203], a[176:179], a[112:115], v[200:203]
    ds_read_b64_tr_b16 a[144:145], v22 offset:0
    buffer_load_dwordx4 a[80:83], v54, s[28:31], s39 offen offset:0 sc1
    v_mfma_f32_16x16x32_bf16 v[200:203], a[180:183], a[120:123], v[200:203]
    ds_read_b64_tr_b16 a[146:147], v22 offset:2048
    v_mfma_f32_16x16x32_bf16 v[216:219], a[176:179], a[116:119], v[216:219]
    ds_read_b64_tr_b16 a[148:149], v22 offset:4096
    v_mfma_f32_16x16x32_bf16 v[216:219], a[180:183], a[124:127], v[216:219]
    ds_read_b64_tr_b16 a[150:151], v22 offset:6144
    buffer_load_dwordx4 a[84:87], v54, s[28:31], s39 offen offset:1024 sc1
    v_mfma_f32_16x16x32_bf16 v[204:207], a[184:187], a[112:115], v[204:207]
    ds_read_b64_tr_b16 a[152:153], v23 offset:0
    v_mfma_f32_16x16x32_bf16 v[204:207], a[188:191], a[120:123], v[204:207]
    ds_read_b64_tr_b16 a[154:155], v23 offset:2048
    v_mfma_f32_16x16x32_bf16 v[220:223], a[184:187], a[116:119], v[220:223]
    ds_read_b64_tr_b16 a[156:157], v23 offset:4096
    buffer_load_dwordx4 a[88:91], v55, s[28:31], s39 offen offset:0 sc1
    v_mfma_f32_16x16x32_bf16 v[220:223], a[188:191], a[124:127], v[220:223]
    ds_read_b64_tr_b16 a[158:159], v23 offset:6144
    s_waitcnt lgkmcnt(8)
    s_waitcnt vmcnt(18)
    buffer_store_dword v7, v6, s[84:87], s88 offen sc1
    v_mfma_f32_16x16x32_bf16 v[192:195], a[128:131], a[192:195], v[192:195]
    ds_read_b64_tr_b16 a[160:161], v20 offset:8192
    v_cvt_pk_bf16_f32 v120, v120, v121
    v_cvt_pk_bf16_f32 v121, v122, v123
    v_cvt_pk_bf16_f32 v122, v124, v125
    v_cvt_pk_bf16_f32 v123, v126, v127
    v_mfma_f32_16x16x32_bf16 v[192:195], a[132:135], a[200:203], v[192:195]
    ds_read_b64_tr_b16 a[162:163], v20 offset:10240
    buffer_store_dwordx4 v[120:123], v15, s[20:23], s75 offen offset:3072 sc1
    v_mfma_f32_16x16x32_bf16 v[208:211], a[128:131], a[196:199], v[208:211]
    ds_read_b64_tr_b16 a[164:165], v20 offset:12288
    v_mfma_f32_16x16x32_bf16 v[208:211], a[132:135], a[204:207], v[208:211]
    ds_read_b64_tr_b16 a[166:167], v20 offset:14336
    v_mfma_f32_16x16x32_bf16 v[196:199], a[136:139], a[192:195], v[196:199]
    ds_read_b64_tr_b16 a[168:169], v21 offset:8192
    buffer_load_dwordx4 a[92:95], v55, s[28:31], s39 offen offset:1024 sc1
    v_mfma_f32_16x16x32_bf16 v[196:199], a[140:143], a[200:203], v[196:199]
    ds_read_b64_tr_b16 a[170:171], v21 offset:10240
    s_bfe_u32 s39, s80, 0x4001c
    s_lshl_b32 s39, s39, 15
    s_add_u32 s39, s39, s81
    v_mfma_f32_16x16x32_bf16 v[212:215], a[136:139], a[196:199], v[212:215]
    ds_read_b64_tr_b16 a[172:173], v21 offset:12288
    v_mfma_f32_16x16x32_bf16 v[212:215], a[140:143], a[204:207], v[212:215]
    ds_read_b64_tr_b16 a[174:175], v21 offset:14336
    s_waitcnt lgkmcnt(8)
    v_mfma_f32_16x16x32_bf16 v[200:203], a[144:147], a[192:195], v[200:203]
    ds_read_b64_tr_b16 a[176:177], v22 offset:8192
    buffer_load_dwordx4 a[96:99], v52, s[28:31], s39 offen offset:0 sc1
    v_mfma_f32_16x16x32_bf16 v[200:203], a[148:151], a[200:203], v[200:203]
    ds_read_b64_tr_b16 a[178:179], v22 offset:10240
    v_mfma_f32_16x16x32_bf16 v[216:219], a[144:147], a[196:199], v[216:219]
    ds_read_b64_tr_b16 a[180:181], v22 offset:12288
    v_mfma_f32_16x16x32_bf16 v[216:219], a[148:151], a[204:207], v[216:219]
    ds_read_b64_tr_b16 a[182:183], v22 offset:14336
    buffer_load_dwordx4 a[100:103], v52, s[28:31], s39 offen offset:1024 sc1
    v_mfma_f32_16x16x32_bf16 v[204:207], a[152:155], a[192:195], v[204:207]
    ds_read_b64_tr_b16 a[184:185], v23 offset:8192
    v_mfma_f32_16x16x32_bf16 v[204:207], a[156:159], a[200:203], v[204:207]
    ds_read_b64_tr_b16 a[186:187], v23 offset:10240
    v_mfma_f32_16x16x32_bf16 v[220:223], a[152:155], a[196:199], v[220:223]
    ds_read_b64_tr_b16 a[188:189], v23 offset:12288
    buffer_load_dwordx4 a[104:107], v53, s[28:31], s39 offen offset:0 sc1
    v_mfma_f32_16x16x32_bf16 v[220:223], a[156:159], a[204:207], v[220:223]
    ds_read_b64_tr_b16 a[190:191], v23 offset:14336
    s_waitcnt lgkmcnt(8)
    v_mfma_f32_16x16x32_bf16 v[192:195], a[160:163], a[208:211], v[192:195]
    ds_read_b64_tr_b16 a[128:129], v44 offset:0
    s_add_u32 s75, s74, 8192
    v_cvt_pk_bf16_f32 v144, v144, v145
    v_cvt_pk_bf16_f32 v145, v146, v147
    v_cvt_pk_bf16_f32 v146, v148, v149
    v_cvt_pk_bf16_f32 v147, v150, v151
    v_mfma_f32_16x16x32_bf16 v[192:195], a[164:167], a[216:219], v[192:195]
    ds_read_b64_tr_b16 a[130:131], v44 offset:2048
    buffer_store_dwordx4 v[144:147], v15, s[20:23], s75 offen offset:2048 sc1
    v_mfma_f32_16x16x32_bf16 v[208:211], a[160:163], a[212:215], v[208:211]
    ds_read_b64_tr_b16 a[132:133], v44 offset:4096
    v_mfma_f32_16x16x32_bf16 v[208:211], a[164:167], a[220:223], v[208:211]
    ds_read_b64_tr_b16 a[134:135], v44 offset:6144
    v_mfma_f32_16x16x32_bf16 v[196:199], a[168:171], a[208:211], v[196:199]
    ds_read_b64_tr_b16 a[136:137], v45 offset:0
    buffer_load_dwordx4 a[108:111], v53, s[28:31], s39 offen offset:1024 sc1
    v_mfma_f32_16x16x32_bf16 v[196:199], a[172:175], a[216:219], v[196:199]
    ds_read_b64_tr_b16 a[138:139], v45 offset:2048
    v_mfma_f32_16x16x32_bf16 v[212:215], a[168:171], a[212:215], v[212:215]
    ds_read_b64_tr_b16 a[140:141], v45 offset:4096
    v_mfma_f32_16x16x32_bf16 v[212:215], a[172:175], a[220:223], v[212:215]
    ds_read_b64_tr_b16 a[142:143], v45 offset:6144
    s_waitcnt lgkmcnt(8)
    v_mfma_f32_16x16x32_bf16 v[200:203], a[176:179], a[208:211], v[200:203]
    ds_read_b64_tr_b16 a[144:145], v46 offset:0
    buffer_load_dwordx4 a[112:115], v54, s[28:31], s39 offen offset:0 sc1
    v_mfma_f32_16x16x32_bf16 v[200:203], a[180:183], a[216:219], v[200:203]
    ds_read_b64_tr_b16 a[146:147], v46 offset:2048
    v_mfma_f32_16x16x32_bf16 v[216:219], a[176:179], a[212:215], v[216:219]
    ds_read_b64_tr_b16 a[148:149], v46 offset:4096
    v_mfma_f32_16x16x32_bf16 v[216:219], a[180:183], a[220:223], v[216:219]
    ds_read_b64_tr_b16 a[150:151], v46 offset:6144
    buffer_load_dwordx4 a[116:119], v54, s[28:31], s39 offen offset:1024 sc1
    v_mfma_f32_16x16x32_bf16 v[204:207], a[184:187], a[208:211], v[204:207]
    ds_read_b64_tr_b16 a[152:153], v47 offset:0
    v_mfma_f32_16x16x32_bf16 v[204:207], a[188:191], a[216:219], v[204:207]
    ds_read_b64_tr_b16 a[154:155], v47 offset:2048
    v_mfma_f32_16x16x32_bf16 v[220:223], a[184:187], a[212:215], v[220:223]
    ds_read_b64_tr_b16 a[156:157], v47 offset:4096
    buffer_load_dwordx4 a[120:123], v55, s[28:31], s39 offen offset:0 sc1
    v_mfma_f32_16x16x32_bf16 v[220:223], a[188:191], a[220:223], v[220:223]
    ds_read_b64_tr_b16 a[158:159], v47 offset:6144
    s_waitcnt lgkmcnt(8)
    v_mfma_f32_16x16x32_bf16 v[192:195], a[128:131], a[224:227], v[192:195]
    ds_read_b64_tr_b16 a[160:161], v44 offset:8192
    v_cvt_pk_bf16_f32 v152, v152, v153
    v_mfma_f32_16x16x32_bf16 v[192:195], a[132:135], a[232:235], v[192:195]
    ds_read_b64_tr_b16 a[162:163], v44 offset:10240
    v_cvt_pk_bf16_f32 v153, v154, v155
    v_mfma_f32_16x16x32_bf16 v[208:211], a[128:131], a[228:231], v[208:211]
    ds_read_b64_tr_b16 a[164:165], v44 offset:12288
    v_cvt_pk_bf16_f32 v154, v156, v157
    v_mfma_f32_16x16x32_bf16 v[208:211], a[132:135], a[236:239], v[208:211]
    ds_read_b64_tr_b16 a[166:167], v44 offset:14336
    v_cvt_pk_bf16_f32 v155, v158, v159
    v_mfma_f32_16x16x32_bf16 v[196:199], a[136:139], a[224:227], v[196:199]
    ds_read_b64_tr_b16 a[168:169], v45 offset:8192
    buffer_store_dwordx4 v[152:155], v15, s[20:23], s75 offen offset:3072 sc1
    v_mfma_f32_16x16x32_bf16 v[196:199], a[140:143], a[232:235], v[196:199]
    ds_read_b64_tr_b16 a[170:171], v45 offset:10240
    v_mfma_f32_16x16x32_bf16 v[212:215], a[136:139], a[228:231], v[212:215]
    ds_read_b64_tr_b16 a[172:173], v45 offset:12288
    v_mfma_f32_16x16x32_bf16 v[212:215], a[140:143], a[236:239], v[212:215]
    ds_read_b64_tr_b16 a[174:175], v45 offset:14336
    s_waitcnt lgkmcnt(8)
    v_mfma_f32_16x16x32_bf16 v[200:203], a[144:147], a[224:227], v[200:203]
    ds_read_b64_tr_b16 a[176:177], v46 offset:8192
    v_mfma_f32_16x16x32_bf16 v[200:203], a[148:151], a[232:235], v[200:203]
    ds_read_b64_tr_b16 a[178:179], v46 offset:10240
    v_mfma_f32_16x16x32_bf16 v[216:219], a[144:147], a[228:231], v[216:219]
    ds_read_b64_tr_b16 a[180:181], v46 offset:12288
    v_mfma_f32_16x16x32_bf16 v[216:219], a[148:151], a[236:239], v[216:219]
    ds_read_b64_tr_b16 a[182:183], v46 offset:14336
    v_mfma_f32_16x16x32_bf16 v[204:207], a[152:155], a[224:227], v[204:207]
    ds_read_b64_tr_b16 a[184:185], v47 offset:8192
    buffer_load_dwordx4 a[124:127], v55, s[28:31], s39 offen offset:1024 sc1
    v_mfma_f32_16x16x32_bf16 v[204:207], a[156:159], a[232:235], v[204:207]
    ds_read_b64_tr_b16 a[186:187], v47 offset:10240
    v_mfma_f32_16x16x32_bf16 v[220:223], a[152:155], a[228:231], v[220:223]
    ds_read_b64_tr_b16 a[188:189], v47 offset:12288
    v_mfma_f32_16x16x32_bf16 v[220:223], a[156:159], a[236:239], v[220:223]
    ds_read_b64_tr_b16 a[190:191], v47 offset:14336
    s_waitcnt lgkmcnt(8)
    v_mfma_f32_16x16x32_bf16 v[192:195], a[160:163], a[240:243], v[192:195]
    ds_read_b64_tr_b16 a[128:129], v40 offset:16384
    v_mfma_f32_16x16x32_bf16 v[192:195], a[164:167], a[248:251], v[192:195]
    ds_read_b64_tr_b16 a[130:131], v40 offset:18432
    v_mfma_f32_16x16x32_bf16 v[208:211], a[160:163], a[244:247], v[208:211]
    ds_read_b64_tr_b16 a[132:133], v40 offset:20480
    v_mfma_f32_16x16x32_bf16 v[208:211], a[164:167], a[252:255], v[208:211]
    ds_read_b64_tr_b16 a[134:135], v40 offset:22528
    v_mfma_f32_16x16x32_bf16 v[196:199], a[168:171], a[240:243], v[196:199]
    ds_read_b64_tr_b16 a[136:137], v41 offset:16384
    v_mfma_f32_16x16x32_bf16 v[196:199], a[172:175], a[248:251], v[196:199]
    ds_read_b64_tr_b16 a[138:139], v41 offset:18432
    v_mfma_f32_16x16x32_bf16 v[212:215], a[168:171], a[244:247], v[212:215]
    ds_read_b64_tr_b16 a[140:141], v41 offset:20480
    v_mfma_f32_16x16x32_bf16 v[212:215], a[172:175], a[252:255], v[212:215]
    ds_read_b64_tr_b16 a[142:143], v41 offset:22528
    s_waitcnt lgkmcnt(8)
    v_mfma_f32_16x16x32_bf16 v[200:203], a[176:179], a[240:243], v[200:203]
    ds_read_b64_tr_b16 a[144:145], v42 offset:16384
    v_mfma_f32_16x16x32_bf16 v[200:203], a[180:183], a[248:251], v[200:203]
    ds_read_b64_tr_b16 a[146:147], v42 offset:18432
    v_mfma_f32_16x16x32_bf16 v[216:219], a[176:179], a[244:247], v[216:219]
    ds_read_b64_tr_b16 a[148:149], v42 offset:20480
    v_mfma_f32_16x16x32_bf16 v[216:219], a[180:183], a[252:255], v[216:219]
    ds_read_b64_tr_b16 a[150:151], v42 offset:22528
    v_mfma_f32_16x16x32_bf16 v[204:207], a[184:187], a[240:243], v[204:207]
    ds_read_b64_tr_b16 a[152:153], v43 offset:16384
    v_mfma_f32_16x16x32_bf16 v[204:207], a[188:191], a[248:251], v[204:207]
    ds_read_b64_tr_b16 a[154:155], v43 offset:18432
    v_mfma_f32_16x16x32_bf16 v[220:223], a[184:187], a[244:247], v[220:223]
    ds_read_b64_tr_b16 a[156:157], v43 offset:20480
    v_mfma_f32_16x16x32_bf16 v[220:223], a[188:191], a[252:255], v[220:223]
    ds_read_b64_tr_b16 a[158:159], v43 offset:22528
    s_waitcnt lgkmcnt(8)
    v_mfma_f32_16x16x32_bf16 v[192:195], a[128:131], a[0:3], v[192:195]
    ds_read_b64_tr_b16 a[160:161], v40 offset:24576
    v_mfma_f32_16x16x32_bf16 v[192:195], a[132:135], a[8:11], v[192:195]
    ds_read_b64_tr_b16 a[162:163], v40 offset:26624
    v_mfma_f32_16x16x32_bf16 v[208:211], a[128:131], a[4:7], v[208:211]
    ds_read_b64_tr_b16 a[164:165], v40 offset:28672
    v_mfma_f32_16x16x32_bf16 v[208:211], a[132:135], a[12:15], v[208:211]
    ds_read_b64_tr_b16 a[166:167], v40 offset:30720
    v_mfma_f32_16x16x32_bf16 v[196:199], a[136:139], a[0:3], v[196:199]
    ds_read_b64_tr_b16 a[168:169], v41 offset:24576
    v_mfma_f32_16x16x32_bf16 v[196:199], a[140:143], a[8:11], v[196:199]
    ds_read_b64_tr_b16 a[170:171], v41 offset:26624
    v_mfma_f32_16x16x32_bf16 v[212:215], a[136:139], a[4:7], v[212:215]
    ds_read_b64_tr_b16 a[172:173], v41 offset:28672
    v_mfma_f32_16x16x32_bf16 v[212:215], a[140:143], a[12:15], v[212:215]
    ds_read_b64_tr_b16 a[174:175], v41 offset:30720
    s_waitcnt lgkmcnt(8)
    v_mfma_f32_16x16x32_bf16 v[200:203], a[144:147], a[0:3], v[200:203]
    ds_read_b64_tr_b16 a[176:177], v42 offset:24576
    buffer_load_dword v3, v14, s[84:87], 0 offen sc1
    v_mfma_f32_16x16x32_bf16 v[200:203], a[148:151], a[8:11], v[200:203]
    ds_read_b64_tr_b16 a[178:179], v42 offset:26624
    v_mfma_f32_16x16x32_bf16 v[216:219], a[144:147], a[4:7], v[216:219]
    ds_read_b64_tr_b16 a[180:181], v42 offset:28672
    v_mfma_f32_16x16x32_bf16 v[216:219], a[148:151], a[12:15], v[216:219]
    ds_read_b64_tr_b16 a[182:183], v42 offset:30720
    v_mfma_f32_16x16x32_bf16 v[204:207], a[152:155], a[0:3], v[204:207]
    ds_read_b64_tr_b16 a[184:185], v43 offset:24576
    v_mfma_f32_16x16x32_bf16 v[204:207], a[156:159], a[8:11], v[204:207]
    ds_read_b64_tr_b16 a[186:187], v43 offset:26624
    v_mfma_f32_16x16x32_bf16 v[220:223], a[152:155], a[4:7], v[220:223]
    ds_read_b64_tr_b16 a[188:189], v43 offset:28672
    v_mfma_f32_16x16x32_bf16 v[220:223], a[156:159], a[12:15], v[220:223]
    ds_read_b64_tr_b16 a[190:191], v43 offset:30720
    s_waitcnt lgkmcnt(8)
    v_mfma_f32_16x16x32_bf16 v[192:195], a[160:163], a[16:19], v[192:195]
    ds_read_b64_tr_b16 a[128:129], v44 offset:16384
    s_waitcnt vmcnt(2)
    buffer_store_dword v7, v6, s[84:87], s89 offen sc1
    v_mfma_f32_16x16x32_bf16 v[192:195], a[164:167], a[24:27], v[192:195]
    ds_read_b64_tr_b16 a[130:131], v44 offset:18432
    v_mfma_f32_16x16x32_bf16 v[208:211], a[160:163], a[20:23], v[208:211]
    ds_read_b64_tr_b16 a[132:133], v44 offset:20480
    v_mfma_f32_16x16x32_bf16 v[208:211], a[164:167], a[28:31], v[208:211]
    ds_read_b64_tr_b16 a[134:135], v44 offset:22528
    v_mfma_f32_16x16x32_bf16 v[196:199], a[168:171], a[16:19], v[196:199]
    ds_read_b64_tr_b16 a[136:137], v45 offset:16384
    v_mfma_f32_16x16x32_bf16 v[196:199], a[172:175], a[24:27], v[196:199]
    ds_read_b64_tr_b16 a[138:139], v45 offset:18432
    v_mfma_f32_16x16x32_bf16 v[212:215], a[168:171], a[20:23], v[212:215]
    ds_read_b64_tr_b16 a[140:141], v45 offset:20480
    v_mfma_f32_16x16x32_bf16 v[212:215], a[172:175], a[28:31], v[212:215]
    ds_read_b64_tr_b16 a[142:143], v45 offset:22528
    s_waitcnt lgkmcnt(8)
    v_mfma_f32_16x16x32_bf16 v[200:203], a[176:179], a[16:19], v[200:203]
    ds_read_b64_tr_b16 a[144:145], v46 offset:16384
    v_mfma_f32_16x16x32_bf16 v[200:203], a[180:183], a[24:27], v[200:203]
    ds_read_b64_tr_b16 a[146:147], v46 offset:18432
    v_mfma_f32_16x16x32_bf16 v[216:219], a[176:179], a[20:23], v[216:219]
    ds_read_b64_tr_b16 a[148:149], v46 offset:20480
    v_mfma_f32_16x16x32_bf16 v[216:219], a[180:183], a[28:31], v[216:219]
    ds_read_b64_tr_b16 a[150:151], v46 offset:22528
    v_mfma_f32_16x16x32_bf16 v[204:207], a[184:187], a[16:19], v[204:207]
    ds_read_b64_tr_b16 a[152:153], v47 offset:16384
    v_mfma_f32_16x16x32_bf16 v[204:207], a[188:191], a[24:27], v[204:207]
    ds_read_b64_tr_b16 a[154:155], v47 offset:18432
    v_mfma_f32_16x16x32_bf16 v[220:223], a[184:187], a[20:23], v[220:223]
    ds_read_b64_tr_b16 a[156:157], v47 offset:20480
    v_mfma_f32_16x16x32_bf16 v[220:223], a[188:191], a[28:31], v[220:223]
    ds_read_b64_tr_b16 a[158:159], v47 offset:22528
    s_waitcnt lgkmcnt(8)
    s_waitcnt vmcnt(1)
    v_cmp_ne_u32 vcc, s96, v3
    s_cbranch_vccz L_f30_ok
    s_mov_b32 s97, 0
L_f30_spin:
    s_sleep 1
    buffer_load_dword v3, v14, s[84:87], 0 offen sc1
    s_add_u32 s97, s97, 1
    s_waitcnt vmcnt(0)
    s_cmp_gt_u32 s97, 0x80000
    s_cbranch_scc1 L_f30_ok
    v_cmp_ne_u32 vcc, s96, v3
    s_cbranch_vccnz L_f30_spin
L_f30_ok:
    v_mfma_f32_16x16x32_bf16 v[192:195], a[128:131], a[32:35], v[192:195]
    ds_read_b64_tr_b16 a[160:161], v44 offset:24576
    s_xor_b32 s40, s74, 0x20000
    v_mfma_f32_16x16x32_bf16 v[192:195], a[132:135], a[40:43], v[192:195]
    ds_read_b64_tr_b16 a[162:163], v44 offset:26624
    s_xor_b32 s41, s74, 0x61000
    s_xor_b32 s42, s74, 0x42000
    v_mfma_f32_16x16x32_bf16 v[208:211], a[128:131], a[36:39], v[208:211]
    ds_read_b64_tr_b16 a[164:165], v44 offset:28672
    buffer_load_dwordx4 v[64:67], v15, s[20:23], s40 offen offset:0 sc1
    v_mfma_f32_16x16x32_bf16 v[208:211], a[132:135], a[44:47], v[208:211]
    ds_read_b64_tr_b16 a[166:167], v44 offset:30720
    v_mfma_f32_16x16x32_bf16 v[196:199], a[136:139], a[32:35], v[196:199]
    ds_read_b64_tr_b16 a[168:169], v45 offset:24576
    v_mfma_f32_16x16x32_bf16 v[196:199], a[140:143], a[40:43], v[196:199]
    ds_read_b64_tr_b16 a[170:171], v45 offset:26624
    v_mfma_f32_16x16x32_bf16 v[212:215], a[136:139], a[36:39], v[212:215]
    ds_read_b64_tr_b16 a[172:173], v45 offset:28672
    v_mfma_f32_16x16x32_bf16 v[212:215], a[140:143], a[44:47], v[212:215]
    ds_read_b64_tr_b16 a[174:175], v45 offset:30720
    s_waitcnt lgkmcnt(8)
    v_mfma_f32_16x16x32_bf16 v[200:203], a[144:147], a[32:35], v[200:203]
    ds_read_b64_tr_b16 a[176:177], v46 offset:24576
    buffer_load_dwordx4 v[96:99], v15, s[20:23], s41 offen offset:0 sc1
    v_mfma_f32_16x16x32_bf16 v[200:203], a[148:151], a[40:43], v[200:203]
    ds_read_b64_tr_b16 a[178:179], v46 offset:26624
    v_mfma_f32_16x16x32_bf16 v[216:219], a[144:147], a[36:39], v[216:219]
    ds_read_b64_tr_b16 a[180:181], v46 offset:28672
    v_mfma_f32_16x16x32_bf16 v[216:219], a[148:151], a[44:47], v[216:219]
    ds_read_b64_tr_b16 a[182:183], v46 offset:30720
    v_mfma_f32_16x16x32_bf16 v[204:207], a[152:155], a[32:35], v[204:207]
    ds_read_b64_tr_b16 a[184:185], v47 offset:24576
    v_mfma_f32_16x16x32_bf16 v[204:207], a[156:159], a[40:43], v[204:207]
    ds_read_b64_tr_b16 a[186:187], v47 offset:26624
    buffer_load_dwordx4 v[128:131], v15, s[20:23], s42 offen offset:0 sc1
    v_mfma_f32_16x16x32_bf16 v[220:223], a[152:155], a[36:39], v[220:223]
    ds_read_b64_tr_b16 a[188:189], v47 offset:28672
    v_mfma_f32_16x16x32_bf16 v[220:223], a[156:159], a[44:47], v[220:223]
    ds_read_b64_tr_b16 a[190:191], v47 offset:30720
    s_waitcnt lgkmcnt(8)
    v_mfma_f32_16x16x32_bf16 v[192:195], a[160:163], a[48:51], v[192:195]
    ds_read_b64_tr_b16 a[128:129], v44 offset:32768
    v_mfma_f32_16x16x32_bf16 v[192:195], a[164:167], a[56:59], v[192:195]
    ds_read_b64_tr_b16 a[130:131], v44 offset:34816
    v_mfma_f32_16x16x32_bf16 v[208:211], a[160:163], a[52:55], v[208:211]
    ds_read_b64_tr_b16 a[132:133], v44 offset:36864
    buffer_load_dwordx4 v[68:71], v15, s[20:23], s40 offen offset:1024 sc1
    v_mfma_f32_16x16x32_bf16 v[208:211], a[164:167], a[60:63], v[208:211]
    ds_read_b64_tr_b16 a[134:135], v44 offset:38912
    v_mfma_f32_16x16x32_bf16 v[196:199], a[168:171], a[48:51], v[196:199]
    ds_read_b64_tr_b16 a[136:137], v45 offset:32768
    v_mfma_f32_16x16x32_bf16 v[196:199], a[172:175], a[56:59], v[196:199]
    ds_read_b64_tr_b16 a[138:139], v45 offset:34816
    v_mfma_f32_16x16x32_bf16 v[212:215], a[168:171], a[52:55], v[212:215]
    ds_read_b64_tr_b16 a[140:141], v45 offset:36864
    v_mfma_f32_16x16x32_bf16 v[212:215], a[172:175], a[60:63], v[212:215]
    ds_read_b64_tr_b16 a[142:143], v45 offset:38912
    s_waitcnt lgkmcnt(8)
    v_mfma_f32_16x16x32_bf16 v[200:203], a[176:179], a[48:51], v[200:203]
    ds_read_b64_tr_b16 a[144:145], v46 offset:32768
    buffer_load_dwordx4 v[100:103], v15, s[20:23], s41 offen offset:1024 sc1
    v_mfma_f32_16x16x32_bf16 v[200:203], a[180:183], a[56:59], v[200:203]
    ds_read_b64_tr_b16 a[146:147], v46 offset:34816
    v_mfma_f32_16x16x32_bf16 v[216:219], a[176:179], a[52:55], v[216:219]
    ds_read_b64_tr_b16 a[148:149], v46 offset:36864
    v_mfma_f32_16x16x32_bf16 v[216:219], a[180:183], a[60:63], v[216:219]
    ds_read_b64_tr_b16 a[150:151], v46 offset:38912
    v_mfma_f32_16x16x32_bf16 v[204:207], a[184:187], a[48:51], v[204:207]
    ds_read_b64_tr_b16 a[152:153], v47 offset:32768
    v_mfma_f32_16x16x32_bf16 v[204:207], a[188:191], a[56:59], v[204:207]
    ds_read_b64_tr_b16 a[154:155], v47 offset:34816
    buffer_load_dwordx4 v[132:135], v15, s[20:23], s42 offen offset:1024 sc1
    v_mfma_f32_16x16x32_bf16 v[220:223], a[184:187], a[52:55], v[220:223]
    ds_read_b64_tr_b16 a[156:157], v47 offset:36864
    v_mfma_f32_16x16x32_bf16 v[220:223], a[188:191], a[60:63], v[220:223]
    ds_read_b64_tr_b16 a[158:159], v47 offset:38912
    s_waitcnt lgkmcnt(8)
    v_mfma_f32_16x16x32_bf16 v[192:195], a[128:131], a[64:67], v[192:195]
    ds_read_b64_tr_b16 a[160:161], v44 offset:40960
    v_mov_b32 v8, 0x3f80
    v_mfma_f32_16x16x32_bf16 v[192:195], a[132:135], a[72:75], v[192:195]
    ds_read_b64_tr_b16 a[162:163], v44 offset:43008
    v_mov_b32 v9, 1.0
    v_mfma_f32_16x16x32_bf16 v[208:211], a[128:131], a[68:71], v[208:211]
    ds_read_b64_tr_b16 a[164:165], v44 offset:45056
    v_permlane16_swap_b32 v240, v242
    v_permlane16_swap_b32 v241, v243
    v_mfma_f32_16x16x32_bf16 v[208:211], a[132:135], a[76:79], v[208:211]
    ds_read_b64_tr_b16 a[166:167], v44 offset:47104
    v_permlane16_swap_b32 v244, v246
    v_mfma_f32_16x16x32_bf16 v[196:199], a[136:139], a[64:67], v[196:199]
    ds_read_b64_tr_b16 a[168:169], v45 offset:40960
    v_permlane16_swap_b32 v245, v247
    v_mfma_f32_16x16x32_bf16 v[196:199], a[140:143], a[72:75], v[196:199]
    ds_read_b64_tr_b16 a[170:171], v45 offset:43008
    v_permlane16_swap_b32 v248, v250
    v_permlane16_swap_b32 v249, v251
    v_mfma_f32_16x16x32_bf16 v[212:215], a[136:139], a[68:71], v[212:215]
    ds_read_b64_tr_b16 a[172:173], v45 offset:45056
    v_permlane16_swap_b32 v252, v254
    v_mfma_f32_16x16x32_bf16 v[212:215], a[140:143], a[76:79], v[212:215]
    ds_read_b64_tr_b16 a[174:175], v45 offset:47104
    s_waitcnt lgkmcnt(8)
    v_permlane16_swap_b32 v253, v255
    v_mfma_f32_16x16x32_bf16 v[200:203], a[144:147], a[64:67], v[200:203]
    ds_read_b64_tr_b16 a[176:177], v46 offset:40960
    v_lshlrev_b32 v80, 16, v240
    v_and_b32 v81, s54, v240
    v_mfma_f32_16x16x32_bf16 v[200:203], a[148:151], a[72:75], v[200:203]
    ds_read_b64_tr_b16 a[178:179], v46 offset:43008
    v_lshlrev_b32 v82, 16, v241
    v_mfma_f32_16x16x32_bf16 v[216:219], a[144:147], a[68:71], v[216:219]
    ds_read_b64_tr_b16 a[180:181], v46 offset:45056
    v_and_b32 v83, s54, v241
    v_mfma_f32_16x16x32_bf16 v[216:219], a[148:151], a[76:79], v[216:219]
    ds_read_b64_tr_b16 a[182:183], v46 offset:47104
    v_lshlrev_b32 v84, 16, v242
    v_and_b32 v85, s54, v242
    v_mfma_f32_16x16x32_bf16 v[204:207], a[152:155], a[64:67], v[204:207]
    ds_read_b64_tr_b16 a[184:185], v47 offset:40960
    v_lshlrev_b32 v86, 16, v243
    v_mfma_f32_16x16x32_bf16 v[204:207], a[156:159], a[72:75], v[204:207]
    ds_read_b64_tr_b16 a[186:187], v47 offset:43008
    v_and_b32 v87, s54, v243
    v_mfma_f32_16x16x32_bf16 v[220:223], a[152:155], a[68:71], v[220:223]
    ds_read_b64_tr_b16 a[188:189], v47 offset:45056
    v_lshlrev_b32 v88, 16, v244
    v_and_b32 v89, s54, v244
    v_mfma_f32_16x16x32_bf16 v[220:223], a[156:159], a[76:79], v[220:223]
    ds_read_b64_tr_b16 a[190:191], v47 offset:47104
    s_waitcnt lgkmcnt(8)
    v_lshlrev_b32 v90, 16, v245
    v_mfma_f32_16x16x32_bf16 v[192:195], a[160:163], a[80:83], v[192:195]
    ds_read_b64_tr_b16 a[128:129], v40 offset:0
    v_and_b32 v91, s54, v245
    v_mfma_f32_16x16x32_bf16 v[192:195], a[164:167], a[88:91], v[192:195]
    ds_read_b64_tr_b16 a[130:131], v40 offset:2048
    v_lshlrev_b32 v92, 16, v246
    v_and_b32 v93, s54, v246
    v_mfma_f32_16x16x32_bf16 v[208:211], a[160:163], a[84:87], v[208:211]
    ds_read_b64_tr_b16 a[132:133], v40 offset:4096
    v_lshlrev_b32 v94, 16, v247
    v_mfma_f32_16x16x32_bf16 v[208:211], a[164:167], a[92:95], v[208:211]
    ds_read_b64_tr_b16 a[134:135], v40 offset:6144
    v_and_b32 v95, s54, v247
    v_mfma_f32_16x16x32_bf16 v[196:199], a[168:171], a[80:83], v[196:199]
    ds_read_b64_tr_b16 a[136:137], v41 offset:0
    v_lshlrev_b32 v112, 16, v248
    v_and_b32 v113, s54, v248
    v_mfma_f32_16x16x32_bf16 v[196:199], a[172:175], a[88:91], v[196:199]
    ds_read_b64_tr_b16 a[138:139], v41 offset:2048
    v_lshlrev_b32 v114, 16, v249
    v_mfma_f32_16x16x32_bf16 v[212:215], a[168:171], a[84:87], v[212:215]
    ds_read_b64_tr_b16 a[140:141], v41 offset:4096
    v_and_b32 v115, s54, v249
    v_mfma_f32_16x16x32_bf16 v[212:215], a[172:175], a[92:95], v[212:215]
    ds_read_b64_tr_b16 a[142:143], v41 offset:6144
    s_waitcnt lgkmcnt(8)
    v_lshlrev_b32 v116, 16, v250
    v_and_b32 v117, s54, v250
    v_mfma_f32_16x16x32_bf16 v[200:203], a[176:179], a[80:83], v[200:203]
    ds_read_b64_tr_b16 a[144:145], v42 offset:0
    v_lshlrev_b32 v118, 16, v251
    v_mfma_f32_16x16x32_bf16 v[200:203], a[180:183], a[88:91], v[200:203]
    ds_read_b64_tr_b16 a[146:147], v42 offset:2048
    v_and_b32 v119, s54, v251
    v_mfma_f32_16x16x32_bf16 v[216:219], a[176:179], a[84:87], v[216:219]
    ds_read_b64_tr_b16 a[148:149], v42 offset:4096
    v_lshlrev_b32 v120, 16, v252
    v_and_b32 v121, s54, v252
    v_mfma_f32_16x16x32_bf16 v[216:219], a[180:183], a[92:95], v[216:219]
    ds_read_b64_tr_b16 a[150:151], v42 offset:6144
    v_lshlrev_b32 v122, 16, v253
    v_mfma_f32_16x16x32_bf16 v[204:207], a[184:187], a[80:83], v[204:207]
    ds_read_b64_tr_b16 a[152:153], v43 offset:0
    v_and_b32 v123, s54, v253
    v_mfma_f32_16x16x32_bf16 v[204:207], a[188:191], a[88:91], v[204:207]
    ds_read_b64_tr_b16 a[154:155], v43 offset:2048
    v_lshlrev_b32 v124, 16, v254
    v_and_b32 v125, s54, v254
    v_mfma_f32_16x16x32_bf16 v[220:223], a[184:187], a[84:87], v[220:223]
    ds_read_b64_tr_b16 a[156:157], v43 offset:4096
    v_lshlrev_b32 v126, 16, v255
    v_mfma_f32_16x16x32_bf16 v[220:223], a[188:191], a[92:95], v[220:223]
    ds_read_b64_tr_b16 a[158:159], v43 offset:6144
    s_waitcnt lgkmcnt(8)
    v_and_b32 v127, s54, v255
    v_mfma_f32_16x16x32_bf16 v[192:195], a[128:131], a[96:99], v[192:195]
    ds_read_b64_tr_b16 a[160:161], v40 offset:8192
    v_mfma_f32_16x16x32_bf16 v[192:195], a[132:135], a[104:107], v[192:195]
    ds_read_b64_tr_b16 a[162:163], v40 offset:10240
    v_mfma_f32_16x16x32_bf16 v[208:211], a[128:131], a[100:103], v[208:211]
    ds_read_b64_tr_b16 a[164:165], v40 offset:12288
    v_mfma_f32_16x16x32_bf16 v[208:211], a[132:135], a[108:111], v[208:211]
    ds_read_b64_tr_b16 a[166:167], v40 offset:14336
    v_mfma_f32_16x16x32_bf16 v[196:199], a[136:139], a[96:99], v[196:199]
    ds_read_b64_tr_b16 a[168:169], v41 offset:8192
    v_mfma_f32_16x16x32_bf16 v[196:199], a[140:143], a[104:107], v[196:199]
    ds_read_b64_tr_b16 a[170:171], v41 offset:10240
    v_mfma_f32_16x16x32_bf16 v[212:215], a[136:139], a[100:103], v[212:215]
    ds_read_b64_tr_b16 a[172:173], v41 offset:12288
    v_mfma_f32_16x16x32_bf16 v[212:215], a[140:143], a[108:111], v[212:215]
    ds_read_b64_tr_b16 a[174:175], v41 offset:14336
    s_waitcnt lgkmcnt(8)
    v_mfma_f32_16x16x32_bf16 v[200:203], a[144:147], a[96:99], v[200:203]
    ds_read_b64_tr_b16 a[176:177], v42 offset:8192
    buffer_load_dword v12, v14, s[84:87], s94 offen sc1
    v_mfma_f32_16x16x32_bf16 v[200:203], a[148:151], a[104:107], v[200:203]
    ds_read_b64_tr_b16 a[178:179], v42 offset:10240
    v_mfma_f32_16x16x32_bf16 v[216:219], a[144:147], a[100:103], v[216:219]
    ds_read_b64_tr_b16 a[180:181], v42 offset:12288
    v_mfma_f32_16x16x32_bf16 v[216:219], a[148:151], a[108:111], v[216:219]
    ds_read_b64_tr_b16 a[182:183], v42 offset:14336
    v_mfma_f32_16x16x32_bf16 v[204:207], a[152:155], a[96:99], v[204:207]
    ds_read_b64_tr_b16 a[184:185], v43 offset:8192
    v_mfma_f32_16x16x32_bf16 v[204:207], a[156:159], a[104:107], v[204:207]
    ds_read_b64_tr_b16 a[186:187], v43 offset:10240
    v_mfma_f32_16x16x32_bf16 v[220:223], a[152:155], a[100:103], v[220:223]
    ds_read_b64_tr_b16 a[188:189], v43 offset:12288
    v_mfma_f32_16x16x32_bf16 v[220:223], a[156:159], a[108:111], v[220:223]
    ds_read_b64_tr_b16 a[190:191], v43 offset:14336
    s_waitcnt lgkmcnt(8)
    v_mfma_f32_16x16x32_bf16 v[192:195], a[160:163], a[112:115], v[192:195]
    v_mfma_f32_16x16x32_bf16 v[192:195], a[164:167], a[120:123], v[192:195]
    v_mfma_f32_16x16x32_bf16 v[208:211], a[160:163], a[116:119], v[208:211]
    v_mfma_f32_16x16x32_bf16 v[208:211], a[164:167], a[124:127], v[208:211]
    v_mfma_f32_16x16x32_bf16 v[196:199], a[168:171], a[112:115], v[196:199]
    v_mfma_f32_16x16x32_bf16 v[196:199], a[172:175], a[120:123], v[196:199]
    v_mfma_f32_16x16x32_bf16 v[212:215], a[168:171], a[116:119], v[212:215]
    v_mfma_f32_16x16x32_bf16 v[212:215], a[172:175], a[124:127], v[212:215]
    s_waitcnt lgkmcnt(0)
    v_mfma_f32_16x16x32_bf16 v[200:203], a[176:179], a[112:115], v[200:203]
    v_mfma_f32_16x16x32_bf16 v[200:203], a[180:183], a[120:123], v[200:203]
    v_mfma_f32_16x16x32_bf16 v[216:219], a[176:179], a[116:119], v[216:219]
    v_mfma_f32_16x16x32_bf16 v[216:219], a[180:183], a[124:127], v[216:219]
    v_mfma_f32_16x16x32_bf16 v[204:207], a[184:187], a[112:115], v[204:207]
    v_mfma_f32_16x16x32_bf16 v[204:207], a[188:191], a[120:123], v[204:207]
    v_mfma_f32_16x16x32_bf16 v[220:223], a[184:187], a[116:119], v[220:223]
    v_mfma_f32_16x16x32_bf16 v[220:223], a[188:191], a[124:127], v[220:223]
    s_waitcnt vmcnt(0)
    v_cmp_ne_u32 vcc, s96, v12
    s_nop 0
    s_cmp_eq_u64 vcc, 0
    s_cselect_b32 s46, 0, 1073741824
    s_add_u32 s43, s40, s46
    s_add_u32 s44, s41, s46
    s_add_u32 s45, s42, s46
    buffer_load_dwordx4 v[72:75], v15, s[20:23], s43 offen offset:2048 sc1
    buffer_load_dwordx4 v[104:107], v15, s[20:23], s44 offen offset:2048 sc1
    buffer_load_dwordx4 v[136:139], v15, s[20:23], s45 offen offset:2048 sc1
    buffer_load_dwordx4 v[76:79], v15, s[20:23], s43 offen offset:3072 sc1
    buffer_load_dwordx4 v[108:111], v15, s[20:23], s44 offen offset:3072 sc1
    buffer_load_dwordx4 v[140:143], v15, s[20:23], s45 offen offset:3072 sc1
    s_nop 7
    v_cvt_pk_bf16_f32 v48, v192, v193
    v_cvt_pk_bf16_f32 v49, v194, v195
    v_lshlrev_b32 v192, 16, v48
    v_and_b32 v193, s54, v48
    v_lshlrev_b32 v194, 16, v49
    v_and_b32 v195, s54, v49
    v_cvt_pk_bf16_f32 v50, v196, v197
    v_cvt_pk_bf16_f32 v51, v198, v199
    v_lshlrev_b32 v196, 16, v50
    v_and_b32 v197, s54, v50
    v_lshlrev_b32 v198, 16, v51
    v_and_b32 v199, s54, v51
    v_cvt_pk_bf16_f32 v48, v200, v201
    v_cvt_pk_bf16_f32 v49, v202, v203
    v_lshlrev_b32 v200, 16, v48
    v_and_b32 v201, s54, v48
    v_lshlrev_b32 v202, 16, v49
    v_and_b32 v203, s54, v49
    v_cvt_pk_bf16_f32 v50, v204, v205
    v_cvt_pk_bf16_f32 v51, v206, v207
    v_lshlrev_b32 v204, 16, v50
    v_and_b32 v205, s54, v50
    v_lshlrev_b32 v206, 16, v51
    v_and_b32 v207, s54, v51
    v_cvt_pk_bf16_f32 v48, v208, v209
    v_cvt_pk_bf16_f32 v49, v210, v211
    v_lshlrev_b32 v208, 16, v48
    v_and_b32 v209, s54, v48
    v_lshlrev_b32 v210, 16, v49
    v_and_b32 v211, s54, v49
    v_cvt_pk_bf16_f32 v50, v212, v213
    v_cvt_pk_bf16_f32 v51, v214, v215
    v_lshlrev_b32 v212, 16, v50
    v_and_b32 v213, s54, v50
    v_lshlrev_b32 v214, 16, v51
    v_and_b32 v215, s54, v51
    v_cvt_pk_bf16_f32 v48, v216, v217
    v_cvt_pk_bf16_f32 v49, v218, v219
    v_lshlrev_b32 v216, 16, v48
    v_and_b32 v217, s54, v48
    v_lshlrev_b32 v218, 16, v49
    v_and_b32 v219, s54, v49
    v_cvt_pk_bf16_f32 v50, v220, v221
    v_cvt_pk_bf16_f32 v51, v222, v223
    v_lshlrev_b32 v220, 16, v50
    v_and_b32 v221, s54, v50
    v_lshlrev_b32 v222, 16, v51
    v_and_b32 v223, s54, v51
    v_dot2_f32_bf16 v160, v64, v8, v160
    v_dot2_f32_bf16 v161, v64, v9, v161
    v_dot2_f32_bf16 v162, v65, v8, v162
    v_dot2_f32_bf16 v163, v65, v9, v163
    v_dot2_f32_bf16 v164, v66, v8, v164
    v_dot2_f32_bf16 v165, v66, v9, v165
    v_dot2_f32_bf16 v166, v67, v8, v166
    v_dot2_f32_bf16 v167, v67, v9, v167
    v_dot2_f32_bf16 v160, v96, v8, v160
    v_dot2_f32_bf16 v161, v96, v9, v161
    v_dot2_f32_bf16 v162, v97, v8, v162
    v_dot2_f32_bf16 v163, v97, v9, v163
    v_dot2_f32_bf16 v164, v98, v8, v164
    v_dot2_f32_bf16 v165, v98, v9, v165
    v_dot2_f32_bf16 v166, v99, v8, v166
    v_dot2_f32_bf16 v167, v99, v9, v167
    v_dot2_f32_bf16 v160, v128, v8, v160
    v_dot2_f32_bf16 v161, v128, v9, v161
    v_dot2_f32_bf16 v162, v129, v8, v162
    v_dot2_f32_bf16 v163, v129, v9, v163
    v_dot2_f32_bf16 v164, v130, v8, v164
    v_dot2_f32_bf16 v165, v130, v9, v165
    v_dot2_f32_bf16 v166, v131, v8, v166
    v_dot2_f32_bf16 v167, v131, v9, v167
    v_dot2_f32_bf16 v168, v68, v8, v168
    v_dot2_f32_bf16 v169, v68, v9, v169
    v_dot2_f32_bf16 v170, v69, v8, v170
    v_dot2_f32_bf16 v171, v69, v9, v171
    v_dot2_f32_bf16 v172, v70, v8, v172
    v_dot2_f32_bf16 v173, v70, v9, v173
    v_dot2_f32_bf16 v174, v71, v8, v174
    v_dot2_f32_bf16 v175, v71, v9, v175
    v_dot2_f32_bf16 v168, v100, v8, v168
    v_dot2_f32_bf16 v169, v100, v9, v169
    v_dot2_f32_bf16 v170, v101, v8, v170
    v_dot2_f32_bf16 v171, v101, v9, v171
    v_dot2_f32_bf16 v172, v102, v8, v172
    v_dot2_f32_bf16 v173, v102, v9, v173
    v_dot2_f32_bf16 v174, v103, v8, v174
    v_dot2_f32_bf16 v175, v103, v9, v175
    v_dot2_f32_bf16 v168, v132, v8, v168
    v_dot2_f32_bf16 v169, v132, v9, v169
    v_dot2_f32_bf16 v170, v133, v8, v170
    v_dot2_f32_bf16 v171, v133, v9, v171
    v_dot2_f32_bf16 v172, v134, v8, v172
    v_dot2_f32_bf16 v173, v134, v9, v173
    v_dot2_f32_bf16 v174, v135, v8, v174
    v_dot2_f32_bf16 v175, v135, v9, v175
    v_pk_mul_f32 v[224:225], v[160:161], s[50:51]
    v_pk_mul_f32 v[226:227], v[162:163], s[50:51]
    v_pk_mul_f32 v[228:229], v[164:165], s[50:51]
    v_pk_mul_f32 v[230:231], v[166:167], s[50:51]
    v_pk_mul_f32 v[232:233], v[168:169], s[50:51]
    v_pk_mul_f32 v[234:235], v[170:171], s[50:51]
    v_pk_mul_f32 v[236:237], v[172:173], s[50:51]
    v_pk_mul_f32 v[238:239], v[174:175], s[50:51]
    v_exp_f32 v224, v224
    v_exp_f32 v225, v225
    v_exp_f32 v226, v226
    v_exp_f32 v227, v227
    v_exp_f32 v228, v228
    v_exp_f32 v229, v229
    v_exp_f32 v230, v230
    v_exp_f32 v231, v231
    v_exp_f32 v232, v232
    v_exp_f32 v233, v233
    v_exp_f32 v234, v234
    v_exp_f32 v235, v235
    v_exp_f32 v236, v236
    v_exp_f32 v237, v237
    v_exp_f32 v238, v238
    v_exp_f32 v239, v239
    v_pk_mul_f32 v[160:161], v[160:161], v[192:193]
    v_pk_mul_f32 v[162:163], v[162:163], v[194:195]
    v_pk_mul_f32 v[164:165], v[164:165], v[196:197]
    v_pk_mul_f32 v[166:167], v[166:167], v[198:199]
    v_pk_mul_f32 v[168:169], v[168:169], v[200:201]
    v_pk_mul_f32 v[170:171], v[170:171], v[202:203]
    v_pk_mul_f32 v[172:173], v[172:173], v[204:205]
    v_pk_mul_f32 v[174:175], v[174:175], v[206:207]
    v_pk_add_f32 v[224:225], v[224:225], s[52:53]
    v_pk_add_f32 v[226:227], v[226:227], s[52:53]
    v_pk_add_f32 v[228:229], v[228:229], s[52:53]
    v_pk_add_f32 v[230:231], v[230:231], s[52:53]
    v_pk_add_f32 v[232:233], v[232:233], s[52:53]
    v_pk_add_f32 v[234:235], v[234:235], s[52:53]
    v_pk_add_f32 v[236:237], v[236:237], s[52:53]
    v_pk_add_f32 v[238:239], v[238:239], s[52:53]
    v_rcp_f32 v224, v224
    v_rcp_f32 v225, v225
    v_rcp_f32 v226, v226
    v_rcp_f32 v227, v227
    v_rcp_f32 v228, v228
    v_rcp_f32 v229, v229
    v_rcp_f32 v230, v230
    v_rcp_f32 v231, v231
    v_pk_fma_f32 v[160:161], v[160:161], v[224:225], v[80:81]
    v_pk_fma_f32 v[162:163], v[162:163], v[226:227], v[82:83]
    v_pk_fma_f32 v[164:165], v[164:165], v[228:229], v[84:85]
    v_pk_fma_f32 v[166:167], v[166:167], v[230:231], v[86:87]
    v_cvt_pk_bf16_f32 v32, v160, v161
    v_cvt_pk_bf16_f32 v33, v162, v163
    v_cvt_pk_bf16_f32 v34, v164, v165
    v_cvt_pk_bf16_f32 v35, v166, v167
    s_nop 0
    v_permlane16_swap_b32 v32, v34
    v_permlane16_swap_b32 v33, v35
    s_nop 0
    buffer_store_dwordx4 v[32:35], v2, s[24:27], s72 offen offset:0 sc1
    v_rcp_f32 v232, v232
    v_rcp_f32 v233, v233
    v_rcp_f32 v234, v234
    v_rcp_f32 v235, v235
    v_rcp_f32 v236, v236
    v_rcp_f32 v237, v237
    v_rcp_f32 v238, v238
    v_rcp_f32 v239, v239
    v_pk_fma_f32 v[168:169], v[168:169], v[232:233], v[88:89]
    v_pk_fma_f32 v[170:171], v[170:171], v[234:235], v[90:91]
    v_pk_fma_f32 v[172:173], v[172:173], v[236:237], v[92:93]
    v_pk_fma_f32 v[174:175], v[174:175], v[238:239], v[94:95]
    v_cvt_pk_bf16_f32 v36, v168, v169
    v_cvt_pk_bf16_f32 v37, v170, v171
    v_cvt_pk_bf16_f32 v38, v172, v173
    v_cvt_pk_bf16_f32 v39, v174, v175
    s_nop 0
    v_permlane16_swap_b32 v36, v38
    v_permlane16_swap_b32 v37, v39
    s_nop 0
    buffer_store_dwordx4 v[36:39], v2, s[24:27], s72 offen offset:64 sc1
    s_cmp_eq_u32 s46, 0
    s_cbranch_scc1 L_nbok
    buffer_load_dword v12, v14, s[84:87], s94 offen sc1
    s_waitcnt vmcnt(0)
    v_cmp_ne_u32 vcc, s96, v12
    s_cbranch_vccz L_f31_ok
    s_mov_b32 s97, 0
L_f31_spin:
    s_sleep 1
    buffer_load_dword v12, v14, s[84:87], s94 offen sc1
    s_add_u32 s97, s97, 1
    s_waitcnt vmcnt(0)
    s_cmp_gt_u32 s97, 0x80000
    s_cbranch_scc1 L_f31_ok
    v_cmp_ne_u32 vcc, s96, v12
    s_cbranch_vccnz L_f31_spin
L_f31_ok:
    buffer_load_dwordx4 v[72:75], v15, s[20:23], s40 offen offset:2048 sc1
    buffer_load_dwordx4 v[104:107], v15, s[20:23], s41 offen offset:2048 sc1
    buffer_load_dwordx4 v[136:139], v15, s[20:23], s42 offen offset:2048 sc1
    buffer_load_dwordx4 v[76:79], v15, s[20:23], s40 offen offset:3072 sc1
    buffer_load_dwordx4 v[108:111], v15, s[20:23], s41 offen offset:3072 sc1
    buffer_load_dwordx4 v[140:143], v15, s[20:23], s42 offen offset:3072 sc1
    s_waitcnt vmcnt(0)
L_nbok:
    s_waitcnt vmcnt(5)
    v_dot2_f32_bf16 v176, v72, v8, v176
    v_dot2_f32_bf16 v177, v72, v9, v177
    v_dot2_f32_bf16 v178, v73, v8, v178
    v_dot2_f32_bf16 v179, v73, v9, v179
    v_dot2_f32_bf16 v180, v74, v8, v180
    v_dot2_f32_bf16 v181, v74, v9, v181
    v_dot2_f32_bf16 v182, v75, v8, v182
    v_dot2_f32_bf16 v183, v75, v9, v183
    v_dot2_f32_bf16 v176, v104, v8, v176
    v_dot2_f32_bf16 v177, v104, v9, v177
    v_dot2_f32_bf16 v178, v105, v8, v178
    v_dot2_f32_bf16 v179, v105, v9, v179
    v_dot2_f32_bf16 v180, v106, v8, v180
    v_dot2_f32_bf16 v181, v106, v9, v181
    v_dot2_f32_bf16 v182, v107, v8, v182
    v_dot2_f32_bf16 v183, v107, v9, v183
    v_dot2_f32_bf16 v176, v136, v8, v176
    v_dot2_f32_bf16 v177, v136, v9, v177
    v_dot2_f32_bf16 v178, v137, v8, v178
    v_dot2_f32_bf16 v179, v137, v9, v179
    v_dot2_f32_bf16 v180, v138, v8, v180
    v_dot2_f32_bf16 v181, v138, v9, v181
    v_dot2_f32_bf16 v182, v139, v8, v182
    v_dot2_f32_bf16 v183, v139, v9, v183
    s_waitcnt vmcnt(2)
    v_dot2_f32_bf16 v184, v76, v8, v184
    v_dot2_f32_bf16 v185, v76, v9, v185
    v_dot2_f32_bf16 v186, v77, v8, v186
    v_dot2_f32_bf16 v187, v77, v9, v187
    v_dot2_f32_bf16 v188, v78, v8, v188
    v_dot2_f32_bf16 v189, v78, v9, v189
    v_dot2_f32_bf16 v190, v79, v8, v190
    v_dot2_f32_bf16 v191, v79, v9, v191
    v_dot2_f32_bf16 v184, v108, v8, v184
    v_dot2_f32_bf16 v185, v108, v9, v185
    v_dot2_f32_bf16 v186, v109, v8, v186
    v_dot2_f32_bf16 v187, v109, v9, v187
    v_dot2_f32_bf16 v188, v110, v8, v188
    v_dot2_f32_bf16 v189, v110, v9, v189
    v_dot2_f32_bf16 v190, v111, v8, v190
    v_dot2_f32_bf16 v191, v111, v9, v191
    v_dot2_f32_bf16 v184, v140, v8, v184
    v_dot2_f32_bf16 v185, v140, v9, v185
    v_dot2_f32_bf16 v186, v141, v8, v186
    v_dot2_f32_bf16 v187, v141, v9, v187
    v_dot2_f32_bf16 v188, v142, v8, v188
    v_dot2_f32_bf16 v189, v142, v9, v189
    v_dot2_f32_bf16 v190, v143, v8, v190
    v_dot2_f32_bf16 v191, v143, v9, v191
    v_pk_mul_f32 v[240:241], v[176:177], s[50:51]
    v_pk_mul_f32 v[242:243], v[178:179], s[50:51]
    v_pk_mul_f32 v[244:245], v[180:181], s[50:51]
    v_pk_mul_f32 v[246:247], v[182:183], s[50:51]
    v_pk_mul_f32 v[248:249], v[184:185], s[50:51]
    v_pk_mul_f32 v[250:251], v[186:187], s[50:51]
    v_pk_mul_f32 v[252:253], v[188:189], s[50:51]
    v_pk_mul_f32 v[254:255], v[190:191], s[50:51]
    v_exp_f32 v240, v240
    v_exp_f32 v241, v241
    v_exp_f32 v242, v242
    v_exp_f32 v243, v243
    v_exp_f32 v244, v244
    v_exp_f32 v245, v245
    v_exp_f32 v246, v246
    v_exp_f32 v247, v247
    v_exp_f32 v248, v248
    v_exp_f32 v249, v249
    v_exp_f32 v250, v250
    v_exp_f32 v251, v251
    v_exp_f32 v252, v252
    v_exp_f32 v253, v253
    v_exp_f32 v254, v254
    v_exp_f32 v255, v255
    v_pk_mul_f32 v[176:177], v[176:177], v[208:209]
    v_pk_mul_f32 v[178:179], v[178:179], v[210:211]
    v_pk_mul_f32 v[180:181], v[180:181], v[212:213]
    v_pk_mul_f32 v[182:183], v[182:183], v[214:215]
    v_pk_mul_f32 v[184:185], v[184:185], v[216:217]
    v_pk_mul_f32 v[186:187], v[186:187], v[218:219]
    v_pk_mul_f32 v[188:189], v[188:189], v[220:221]
    v_pk_mul_f32 v[190:191], v[190:191], v[222:223]
    v_pk_add_f32 v[240:241], v[240:241], s[52:53]
    v_pk_add_f32 v[242:243], v[242:243], s[52:53]
    v_pk_add_f32 v[244:245], v[244:245], s[52:53]
    v_pk_add_f32 v[246:247], v[246:247], s[52:53]
    v_pk_add_f32 v[248:249], v[248:249], s[52:53]
    v_pk_add_f32 v[250:251], v[250:251], s[52:53]
    v_pk_add_f32 v[252:253], v[252:253], s[52:53]
    v_pk_add_f32 v[254:255], v[254:255], s[52:53]
    v_rcp_f32 v240, v240
    v_rcp_f32 v241, v241
    v_rcp_f32 v242, v242
    v_rcp_f32 v243, v243
    v_rcp_f32 v244, v244
    v_rcp_f32 v245, v245
    v_rcp_f32 v246, v246
    v_rcp_f32 v247, v247
    v_pk_fma_f32 v[176:177], v[176:177], v[240:241], v[112:113]
    v_pk_fma_f32 v[178:179], v[178:179], v[242:243], v[114:115]
    v_pk_fma_f32 v[180:181], v[180:181], v[244:245], v[116:117]
    v_pk_fma_f32 v[182:183], v[182:183], v[246:247], v[118:119]
    v_cvt_pk_bf16_f32 v40, v176, v177
    v_cvt_pk_bf16_f32 v41, v178, v179
    v_cvt_pk_bf16_f32 v42, v180, v181
    v_cvt_pk_bf16_f32 v43, v182, v183
    s_nop 0
    v_permlane16_swap_b32 v40, v42
    v_permlane16_swap_b32 v41, v43
    s_nop 0
    buffer_store_dwordx4 v[40:43], v2, s[24:27], s73 offen offset:0
    v_rcp_f32 v248, v248
    v_rcp_f32 v249, v249
    v_rcp_f32 v250, v250
    v_rcp_f32 v251, v251
    v_rcp_f32 v252, v252
    v_rcp_f32 v253, v253
    v_rcp_f32 v254, v254
    v_rcp_f32 v255, v255
    v_pk_fma_f32 v[184:185], v[184:185], v[248:249], v[120:121]
    v_pk_fma_f32 v[186:187], v[186:187], v[250:251], v[122:123]
    v_pk_fma_f32 v[188:189], v[188:189], v[252:253], v[124:125]
    v_pk_fma_f32 v[190:191], v[190:191], v[254:255], v[126:127]
    v_cvt_pk_bf16_f32 v44, v184, v185
    v_cvt_pk_bf16_f32 v45, v186, v187
    v_cvt_pk_bf16_f32 v46, v188, v189
    v_cvt_pk_bf16_f32 v47, v190, v191
    s_nop 0
    v_permlane16_swap_b32 v44, v46
    v_permlane16_swap_b32 v45, v47
    s_nop 0
    buffer_store_dwordx4 v[44:47], v2, s[24:27], s73 offen offset:64
L_end:
    s_endpgm
.section .rodata,"a"
.p2align 6
.amdhsa_kernel recurrent_scan__sliding_local_dilated__swiglu_ffn__prompt_kernel
  .amdhsa_next_free_vgpr 512
  .amdhsa_next_free_sgpr 100
  .amdhsa_accum_offset 256
  .amdhsa_group_segment_fixed_size 0
  .amdhsa_kernarg_size 80
  .amdhsa_user_sgpr_count 2
  .amdhsa_user_sgpr_kernarg_segment_ptr 1
  .amdhsa_system_sgpr_workgroup_id_x 1
.end_amdhsa_kernel
```
